```python
import torch

def _softmax(x, axis=-1):
    return torch.softmax(x, dim=axis)

def _gelu(x):
    return torch.nn.functional.gelu(x, approximate='tanh')

def _silu(x):
    return torch.nn.functional.silu(x)

def _sigmoid(x):
    return torch.sigmoid(x)

def _layernorm(x, axis=-1, eps=1e-05):
    m = x.mean(dim=axis, keepdim=True)
    v = x.var(dim=axis, keepdim=True, unbiased=False)
    return (x - m) / torch.sqrt(v + eps)

def _scatter_add(tgt, idx, src, axis=0):
    return tgt.clone().index_add_(axis, idx, src)

def _segment_sum(src, seg, n):
    out = torch.zeros((n,) + src.shape[1:], dtype=src.dtype)
    return out.index_add_(0, seg, src)

def _pad(x, pw):
    flat = tuple((v for pair in reversed(pw) for v in pair))
    return torch.nn.functional.pad(x, flat)
kernel_name = 'adaLN_cond__sliding_block_cached__geglu_ffn__prompt'

def setup_inputs():

    _w = lambda a: (lambda t: t.to(torch.bfloat16) if t.is_floating_point() else t)(torch.as_tensor(a))

    def _A_setup():
        B, Sq, D = (1, 2048, 512)
        Hq, Hkv, Sk, Dh = (32, 8, 2048, 128)
        assert Hq % Hkv == 0, (Hq, Hkv)
        return {'x': _w((lambda *s: torch.randn(*s, dtype=torch.bfloat16) * 0.1)(B, Sq, D)), 'k_cache': _w((lambda *s: torch.randn(*s, dtype=torch.bfloat16) * 0.8)(B, Hkv, Sk, Dh)), 'v_cache': _w((lambda *s: torch.randn(*s, dtype=torch.bfloat16) * 1.6)(B, Hkv, Sk, Dh)), 'wq': _w((lambda *s: torch.randn(*s, dtype=torch.bfloat16) * 0.8)(D, Hq * Dh) * D ** (-0.5)), 'wo': _w((lambda *s: torch.randn(*s, dtype=torch.bfloat16) * 1.6)(Hq * Dh, D) * (Hq * Dh) ** (-0.5))}
    _A_in = _A_setup()

    def _B_setup():
        B, S, D, F = (1, 2048, 512, 1792)
        return {'x': _w((lambda *s: torch.randn(*s, dtype=torch.bfloat16) * 0.1)(B, S, D)), 'w_gate': _w((lambda *s: torch.randn(*s, dtype=torch.bfloat16) * 0.2)(D, F)), 'w_up': _w((lambda *s: torch.randn(*s, dtype=torch.bfloat16) * 0.2)(D, F)), 'w_down': _w((lambda *s: torch.randn(*s, dtype=torch.bfloat16) * 0.2)(F, D))}
    _B_in = _B_setup()
    return {'A_x': _A_in['x'], 'A_k_cache': _A_in['k_cache'], 'A_v_cache': _A_in['v_cache'], 'A_wq': _A_in['wq'], 'A_wo': _A_in['wo'], 'B_x': _B_in['x'], 'B_w_gate': _B_in['w_gate'], 'B_w_up': _B_in['w_up'], 'B_w_down': _B_in['w_down'], 'c': _w((lambda *s: torch.randn(*s, dtype=torch.bfloat16) * 0.8)(1, 512) * 8.0), 'w_mod': _w((lambda *s: torch.randn(*s, dtype=torch.bfloat16) * 0.8)(512, 6 * 512) * 512 ** (-0.5) * 8.0)}

def reference(A_x, A_k_cache, A_v_cache, A_wq, A_wo, B_x, B_w_gate, B_w_up, B_w_down, c, w_mod):

    def _A_ref(x, k_cache, v_cache, wq, wo):
        B, Sq, D = x.shape
        Hq, Dh = (32, 128)
        Hkv, Sk = (k_cache.shape[1], k_cache.shape[2])
        W = min(4096, max(256, Sk // 4))
        rep = Hq // Hkv
        q = (lambda x, *d: x.permute(*d))((x @ wq).reshape(B, Sq, Hq, Dh), 0, 2, 1, 3)
        k = (lambda x, n, axis: torch.repeat_interleave(x, n, dim=axis))(k_cache[:, :, Sk - W:, :], rep, axis=1)
        v = (lambda x, n, axis: torch.repeat_interleave(x, n, dim=axis))(v_cache[:, :, Sk - W:, :], rep, axis=1)
        scores = torch.einsum('bhqd,bhkd->bhqk', q, k) * Dh ** (-0.5)
        p = _softmax(scores, axis=-1)
        o = torch.einsum('bhqk,bhkd->bhqd', p, v)
        return (lambda x, *d: x.permute(*d))(o, 0, 2, 1, 3).reshape(B, Sq, Hq * Dh) @ wo

    def _B_ref(x, w_gate, w_up, w_down):
        return _gelu(x @ w_gate) * (x @ w_up) @ w_down
    x = A_x
    mod = (_silu(c) @ w_mod).reshape(c.shape[0], 6, 1, -1)
    sa, ca, ga, sb, cb, gb = (mod[:, 0].clone(), mod[:, 1].clone(), mod[:, 2].clone(), mod[:, 3].clone(), mod[:, 4].clone(), mod[:, 5].clone())
    h = _layernorm(x, axis=-1) * (1 + ca) + sa
    x = x + ga * _A_ref(h, A_k_cache, A_v_cache, A_wq, A_wo)
    h = _layernorm(x, axis=-1) * (1 + cb) + sb
    x = x + gb * _B_ref(h, B_w_gate, B_w_up, B_w_down)
    return x
```

```asm
; @launch grid=(256,1,1) block=(256,1,1) lds=163840
.amdgcn_target "amdgcn-amd-amdhsa--gfx950"
.text
.globl adaLN_cond__sliding_block_cached__geglu_ffn__prompt_kernel
.p2align 8
.type adaLN_cond__sliding_block_cached__geglu_ffn__prompt_kernel,@function
adaLN_cond__sliding_block_cached__geglu_ffn__prompt_kernel:
    s_cmp_ge_u32 s2, 256
    s_cbranch_scc1 KM_END
    s_load_dwordx16 s[64:79], s[0:1], 0
    s_load_dwordx8 s[80:87], s[0:1], 64
    s_load_dwordx4 s[88:91], s[0:1], 96
    v_and_b32 v232, 63, v0
    v_lshrrev_b32 v233, 6, v0
    v_lshlrev_b32 v220, 4, v232
    v_readfirstlane_b32 s20, v233
    s_and_b32 s38, s2, 7
    s_lshr_b32 s39, s2, 3
    s_and_b32 s3, s2, 6
    s_and_b32 s44, s39, 1
    s_add_u32 s3, s3, s44
    s_and_b32 s37, s2, 1
    s_lshl_b32 s37, s37, 4
    s_lshr_b32 s44, s2, 4
    s_add_u32 s37, s37, s44
    v_lshrrev_b32 v234, 2, v232
    v_lshlrev_b32 v234, 7, v234
    v_bfe_u32 v235, v232, 3, 2
    v_lshl_add_u32 v234, v235, 5, v234
    v_and_b32 v235, 3, v232
    v_lshl_add_u32 v252, v235, 3, v234
    v_lshrrev_b32 v234, 3, v232
    v_and_b32 v235, 7, v232
    v_bfe_u32 v236, v232, 4, 2
    v_lshlrev_b32 v236, 1, v236
    v_xor_b32 v235, v235, v236
    v_lshlrev_b32 v235, 4, v235
    v_lshl_add_u32 v248, v234, 10, v235
    v_add_u32 v249, 7168, v248
    v_add_u32 v250, 14336, v248
    v_add_u32 v251, 21504, v248
    v_lshrrev_b32 v234, 4, v232
    v_and_b32 v235, 15, v232
    v_lshlrev_b32 v236, 2, v234
    v_xor_b32 v235, v235, v236
    v_lshlrev_b32 v235, 4, v235
    v_lshl_add_u32 v225, v234, 13, v235
    v_add_u32 v226, 31744, v225
    v_add_u32 v227, 63488, v225
    v_add_u32 v228, 95232, v225
    s_movk_i32 s60, 0x3ff
    v_lshrrev_b32 v238, 3, v232
    v_and_b32 v239, 7, v232
    v_lshlrev_b32 v237, 10, v238
    s_mov_b32 s43, 0
    s_lshl_b32 s44, s43, 7
    v_lshl_add_u32 v236, v239, 4, s44
    v_add_u32 v235, 0, v236
    v_and_or_b32 v208, v235, s60, v237
    v_add_u32 v235, 128, v236
    v_and_or_b32 v209, v235, s60, v237
    v_add_u32 v235, 256, v236
    v_and_or_b32 v210, v235, s60, v237
    v_add_u32 v235, 384, v236
    v_and_or_b32 v211, v235, s60, v237
    v_add_u32 v235, 512, v236
    v_and_or_b32 v212, v235, s60, v237
    v_add_u32 v235, 640, v236
    v_and_or_b32 v213, v235, s60, v237
    v_add_u32 v235, 768, v236
    v_and_or_b32 v214, v235, s60, v237
    v_add_u32 v235, 896, v236
    v_and_or_b32 v215, v235, s60, v237
    s_lshl_b32 s40, s37, 16
    s_lshl_b32 s41, s20, 14
    s_add_u32 s40, s40, s41
    s_add_u32 s41, s40, 8192
    s_lshl_b32 s23, s20, 14
    s_add_u32 s23, s23, 98304
    s_lshl_b32 s29, s20, 13
    s_lshl_b32 s44, s3, 10
    s_lshl_b32 s45, s20, 8
    s_add_u32 s21, s44, s45
    s_lshl_b32 s44, s43, 19
    s_add_u32 s21, s21, s44
    s_mov_b32 s62, 0x05040100
    s_mov_b32 s63, 0x07060302
    s_getpc_b64 s[6:7]
KF_PC:
    s_sub_u32 s6, s6, KF_PC-adaLN_cond__sliding_block_cached__geglu_ffn__prompt_kernel
    s_subb_u32 s7, s7, 0
    v_lshlrev_b32 v254, 3, v0
    s_lshl_b32 s44, s39, 11
    v_add_u32 v254, s44, v254
    v_min_u32 v254, CODE_END-adaLN_cond__sliding_block_cached__geglu_ffn__prompt_kernel-8, v254
    global_load_dwordx2 a[240:241], v254, s[6:7]
    s_cmp_ge_u32 s2, 192
    s_cbranch_scc1 KF_KV
    s_lshr_b32 s44, s39, 2
    s_lshl_b32 s44, s44, 5
    s_lshl_b32 s45, s38, 2
    s_add_u32 s44, s44, s45
    s_and_b32 s45, s39, 3
    s_add_u32 s44, s44, s45
    s_lshl_b32 s42, s44, 5
    s_mul_i32 s45, s20, 786432
    s_add_u32 s30, s42, s45
    s_add_u32 s31, s30, 6144
    s_add_u32 s32, s30, 393216
    s_add_u32 s33, s30, 399360
    v_lshrrev_b32 v0, 1, v232
    v_mul_u32_u24 v1, 12288, v0
    v_and_b32 v2, 1, v232
    v_lshl_add_u32 v1, v2, 4, v1
    v_lshlrev_b32 v0, 2, v0
    s_lshl_b32 s34, s20, 8
    s_waitcnt lgkmcnt(0)
    s_load_dwordx2 s[4:5], s[90:91], 0x3c000
    s_mov_b32 s12, s90
    s_mov_b32 s13, s91
    s_mov_b32 s14, 0x10000000
    s_mov_b32 s15, 0x20000
    s_mov_b32 s48, s84
    s_mov_b32 s49, s85
    s_mov_b32 s50, 0x300000
    s_mov_b32 s51, 0x20000
    s_mov_b32 s52, s82
    s_mov_b32 s53, s83
    s_mov_b32 s54, 0x400
    s_mov_b32 s55, 0x20000
    buffer_load_dword v4, v0, s[52:55], s34 offen
    buffer_load_dword v5, v0, s[52:55], s34 offen offset:128
    buffer_load_dwordx4 v[8:11], v1, s[48:51], s30 offen
    buffer_load_dwordx4 v[12:15], v1, s[48:51], s31 offen
    buffer_load_dwordx4 v[16:19], v1, s[48:51], s32 offen
    buffer_load_dwordx4 v[20:23], v1, s[48:51], s33 offen
    s_mov_b32 s16, s64
    s_mov_b32 s17, s65
    s_mov_b32 s18, 0x200000
    s_mov_b32 s19, 0x20000
    s_cmp_lt_u32 s2, 64
    s_cbranch_scc1 KF_W0
    buffer_load_dwordx4 v[128:131], v208, s[16:19], s40 offen
    buffer_load_dwordx4 v[132:135], v209, s[16:19], s40 offen
    buffer_load_dwordx4 v[136:139], v210, s[16:19], s40 offen
    buffer_load_dwordx4 v[140:143], v211, s[16:19], s40 offen
    buffer_load_dwordx4 v[144:147], v212, s[16:19], s40 offen
    buffer_load_dwordx4 v[148:151], v213, s[16:19], s40 offen
    buffer_load_dwordx4 v[152:155], v214, s[16:19], s40 offen
    buffer_load_dwordx4 v[156:159], v215, s[16:19], s40 offen
    buffer_load_dwordx4 v[160:163], v208, s[16:19], s41 offen
    buffer_load_dwordx4 v[164:167], v209, s[16:19], s41 offen
    buffer_load_dwordx4 v[168:171], v210, s[16:19], s41 offen
    buffer_load_dwordx4 v[172:175], v211, s[16:19], s41 offen
    buffer_load_dwordx4 v[176:179], v212, s[16:19], s41 offen
    buffer_load_dwordx4 v[180:183], v213, s[16:19], s41 offen
    buffer_load_dwordx4 v[184:187], v214, s[16:19], s41 offen
    buffer_load_dwordx4 v[188:191], v215, s[16:19], s41 offen
    s_branch KF_W1
KF_W0:
    s_waitcnt vmcnt(0)
KF_W1:
    s_waitcnt vmcnt(20)
    v_lshlrev_b32 v24, 16, v4
    v_and_b32 v25, 0xffff0000, v4
    v_lshlrev_b32 v26, 16, v5
    v_and_b32 v27, 0xffff0000, v5
    v_mul_f32 v28, 0xbfb8aa3b, v24
    v_mul_f32 v29, 0xbfb8aa3b, v25
    v_mul_f32 v30, 0xbfb8aa3b, v26
    v_mul_f32 v31, 0xbfb8aa3b, v27
    v_exp_f32 v28, v28
    v_exp_f32 v29, v29
    v_exp_f32 v30, v30
    v_exp_f32 v31, v31
    s_nop 0
    v_add_f32 v28, 1.0, v28
    v_add_f32 v29, 1.0, v29
    v_add_f32 v30, 1.0, v30
    v_add_f32 v31, 1.0, v31
    v_rcp_f32 v28, v28
    v_rcp_f32 v29, v29
    v_rcp_f32 v30, v30
    v_rcp_f32 v31, v31
    s_nop 0
    v_mul_f32 v24, v24, v28
    v_mul_f32 v25, v25, v29
    v_mul_f32 v26, v26, v30
    v_mul_f32 v27, v27, v31
    v_cvt_pk_bf16_f32 v32, v24, v25
    v_cvt_pk_bf16_f32 v33, v26, v27
    s_waitcnt vmcnt(18)
    v_perm_b32 v24, v12, v8, s62
    v_perm_b32 v25, v12, v8, s63
    v_perm_b32 v26, v13, v9, s62
    v_perm_b32 v27, v13, v9, s63
    v_perm_b32 v28, v14, v10, s62
    v_perm_b32 v29, v14, v10, s63
    v_perm_b32 v30, v15, v11, s62
    v_perm_b32 v31, v15, v11, s63
    v_dot2_f32_bf16 v40, v24, v32, 0
    v_dot2_f32_bf16 v41, v25, v32, 0
    v_dot2_f32_bf16 v42, v26, v32, 0
    v_dot2_f32_bf16 v43, v27, v32, 0
    v_dot2_f32_bf16 v44, v28, v32, 0
    v_dot2_f32_bf16 v45, v29, v32, 0
    v_dot2_f32_bf16 v46, v30, v32, 0
    v_dot2_f32_bf16 v47, v31, v32, 0
    s_waitcnt vmcnt(16)
    v_perm_b32 v24, v20, v16, s62
    v_perm_b32 v25, v20, v16, s63
    v_perm_b32 v26, v21, v17, s62
    v_perm_b32 v27, v21, v17, s63
    v_perm_b32 v28, v22, v18, s62
    v_perm_b32 v29, v22, v18, s63
    v_perm_b32 v30, v23, v19, s62
    v_perm_b32 v31, v23, v19, s63
    v_dot2_f32_bf16 v40, v24, v33, v40
    v_dot2_f32_bf16 v41, v25, v33, v41
    v_dot2_f32_bf16 v42, v26, v33, v42
    v_dot2_f32_bf16 v43, v27, v33, v43
    v_dot2_f32_bf16 v44, v28, v33, v44
    v_dot2_f32_bf16 v45, v29, v33, v45
    v_dot2_f32_bf16 v46, v30, v33, v46
    v_dot2_f32_bf16 v47, v31, v33, v47
    s_nop 2
    v_permlane32_swap_b32 v40, v44
    v_permlane32_swap_b32 v41, v45
    v_permlane32_swap_b32 v42, v46
    v_permlane32_swap_b32 v43, v47
    s_nop 0
    v_add_f32 v40, v40, v44
    v_add_f32 v41, v41, v45
    v_add_f32 v42, v42, v46
    v_add_f32 v43, v43, v47
    s_nop 1
    v_permlane16_swap_b32 v40, v42
    v_permlane16_swap_b32 v41, v43
    s_nop 0
    v_add_f32 v40, v40, v42
    v_add_f32 v41, v41, v43
    s_nop 1
    v_add_f32_dpp v40, v40, v40 row_ror:8 row_mask:0xf bank_mask:0xf
    v_add_f32_dpp v41, v41, v41 row_ror:8 row_mask:0xf bank_mask:0xf
    s_nop 1
    v_add_f32_dpp v40, v40, v40 row_ror:4 row_mask:0xf bank_mask:0xf
    v_add_f32_dpp v41, v41, v41 row_ror:4 row_mask:0xf bank_mask:0xf
    s_nop 1
    v_add_f32_dpp v40, v40, v40 row_ror:2 row_mask:0xf bank_mask:0xf
    v_add_f32_dpp v41, v41, v41 row_ror:2 row_mask:0xf bank_mask:0xf
    v_lshlrev_b32 v34, 5, v2
    v_lshrrev_b32 v35, 5, v232
    v_lshl_add_u32 v34, v35, 4, v34
    v_bfe_u32 v35, v232, 4, 1
    v_lshl_add_u32 v34, v35, 3, v34
    s_lshl_b32 s45, s20, 6
    s_add_u32 s45, s45, 110592
    v_add_u32 v34, s45, v34
    ds_write_b64 v34, v[40:41]
    v_and_b32 v36, 15, v232
    v_lshlrev_b32 v36, 2, v36
    v_add_u32 v37, 110592, v36
    s_waitcnt lgkmcnt(0)
    s_barrier
    s_cmp_lg_u32 s20, 0
    s_cbranch_scc1 KF_X1
    ds_read_b32 v40, v37
    ds_read_b32 v41, v37 offset:64
    ds_read_b32 v42, v37 offset:128
    ds_read_b32 v43, v37 offset:192
    s_lshl_b32 s42, s42, 1
    s_waitcnt lgkmcnt(0)
    v_add_f32 v40, v40, v41
    v_add_f32 v42, v42, v43
    v_add_f32 v40, v40, v42
    v_cvt_pk_bf16_f32 v40, v40, v40
    v_and_b32 v40, 0xffff0000, v40
    s_mov_b64 exec, 0xffff
    s_cmp_lt_u32 s2, 64
    s_cbranch_scc1 KF_CRIT
    buffer_store_dword v40, v36, s[12:15], s42 offen sc1
    s_mov_b64 exec, -1
    s_branch KF_JOIN
KF_CRIT:
    s_add_u32 s45, s4, 1
    v_mov_b32 v41, s45
    v_lshlrev_b32 v36, 1, v36
    s_lshl_b32 s42, s42, 1
    s_add_u32 s42, s42, 0x3a000
    buffer_store_dwordx2 v[40:41], v36, s[12:15], s42 offen sc1
    s_mov_b64 exec, -1
KF_X1:
    s_cmp_ge_u32 s2, 64
    s_cbranch_scc1 KF_JOIN
    buffer_load_dwordx4 v[128:131], v208, s[16:19], s40 offen
    buffer_load_dwordx4 v[132:135], v209, s[16:19], s40 offen
    buffer_load_dwordx4 v[136:139], v210, s[16:19], s40 offen
    buffer_load_dwordx4 v[140:143], v211, s[16:19], s40 offen
    buffer_load_dwordx4 v[144:147], v212, s[16:19], s40 offen
    buffer_load_dwordx4 v[148:151], v213, s[16:19], s40 offen
    buffer_load_dwordx4 v[152:155], v214, s[16:19], s40 offen
    buffer_load_dwordx4 v[156:159], v215, s[16:19], s40 offen
    buffer_load_dwordx4 v[160:163], v208, s[16:19], s41 offen
    buffer_load_dwordx4 v[164:167], v209, s[16:19], s41 offen
    buffer_load_dwordx4 v[168:171], v210, s[16:19], s41 offen
    buffer_load_dwordx4 v[172:175], v211, s[16:19], s41 offen
    buffer_load_dwordx4 v[176:179], v212, s[16:19], s41 offen
    buffer_load_dwordx4 v[180:183], v213, s[16:19], s41 offen
    buffer_load_dwordx4 v[184:187], v214, s[16:19], s41 offen
    buffer_load_dwordx4 v[188:191], v215, s[16:19], s41 offen
    s_branch KF_JOIN
KF_KV:
    s_sub_u32 s44, s39, 24
    s_lshl_b32 s44, s44, 1
    s_lshr_b32 s45, s20, 1
    s_add_u32 s44, s44, s45
    s_and_b32 s45, s20, 1
    s_lshl_b32 s30, s38, 19
    s_lshl_b32 s31, s44, 13
    s_add_u32 s30, s30, s31
    s_add_u32 s30, s30, 393216
    s_lshl_b32 s31, s45, 12
    s_add_u32 s31, s31, s30
    s_lshl_b32 s32, s45, 7
    s_add_u32 s30, s30, s32
    s_lshl_b32 s32, s38, 18
    s_lshl_b32 s33, s44, 14
    s_add_u32 s32, s32, s33
    s_lshl_b32 s33, s45, 12
    s_add_u32 s32, s32, s33
    s_add_u32 s32, s32, 0x40000
    s_add_u32 s33, s32, 8192
    v_and_b32 v4, 31, v232
    v_lshrrev_b32 v5, 5, v232
    v_lshlrev_b32 v6, 8, v4
    v_lshl_add_u32 v6, v5, 4, v6
    v_and_b32 v0, 7, v4
    v_and_b32 v1, 8, v4
    v_lshl_or_b32 v0, v1, 1, v0
    v_and_b32 v1, 16, v4
    v_lshrrev_b32 v1, 1, v1
    v_or_b32 v0, v0, v1
    v_lshlrev_b32 v0, 1, v0
    v_lshl_add_u32 v0, v5, 10, v0
    s_waitcnt lgkmcnt(0)
    s_load_dwordx2 s[4:5], s[90:91], 0x3c000
    s_mov_b32 s12, s90
    s_mov_b32 s13, s91
    s_mov_b32 s14, 0x10000000
    s_mov_b32 s15, 0x20000
    s_mov_b32 s48, s66
    s_mov_b32 s49, s67
    s_mov_b32 s50, 0x400000
    s_mov_b32 s51, 0x20000
    s_mov_b32 s52, s68
    s_mov_b32 s53, s69
    s_mov_b32 s54, 0x400000
    s_mov_b32 s55, 0x20000
    s_mov_b32 s16, s64
    s_mov_b32 s17, s65
    s_mov_b32 s18, 0x200000
    s_mov_b32 s19, 0x20000
    buffer_load_dwordx4 v[128:131], v208, s[16:19], s40 offen
    buffer_load_dwordx4 v[132:135], v209, s[16:19], s40 offen
    buffer_load_dwordx4 v[136:139], v210, s[16:19], s40 offen
    buffer_load_dwordx4 v[140:143], v211, s[16:19], s40 offen
    buffer_load_dwordx4 v[144:147], v212, s[16:19], s40 offen
    buffer_load_dwordx4 v[148:151], v213, s[16:19], s40 offen
    buffer_load_dwordx4 v[152:155], v214, s[16:19], s40 offen
    buffer_load_dwordx4 v[156:159], v215, s[16:19], s40 offen
    buffer_load_dwordx4 v[160:163], v208, s[16:19], s41 offen
    buffer_load_dwordx4 v[164:167], v209, s[16:19], s41 offen
    buffer_load_dwordx4 v[168:171], v210, s[16:19], s41 offen
    buffer_load_dwordx4 v[172:175], v211, s[16:19], s41 offen
    buffer_load_dwordx4 v[176:179], v212, s[16:19], s41 offen
    buffer_load_dwordx4 v[180:183], v213, s[16:19], s41 offen
    buffer_load_dwordx4 v[184:187], v214, s[16:19], s41 offen
    buffer_load_dwordx4 v[188:191], v215, s[16:19], s41 offen
    buffer_load_dwordx4 v[96:99], v6, s[48:51], s30 offen offset:0
    buffer_load_dwordx4 v[100:103], v6, s[48:51], s30 offen offset:32
    buffer_load_dwordx4 v[104:107], v6, s[48:51], s30 offen offset:64
    buffer_load_dwordx4 v[108:111], v6, s[48:51], s30 offen offset:96
    buffer_load_ushort v64, v0, s[52:55], s31 offen offset:0
    buffer_load_ushort v65, v0, s[52:55], s31 offen offset:256
    buffer_load_ushort v66, v0, s[52:55], s31 offen offset:512
    buffer_load_ushort v67, v0, s[52:55], s31 offen offset:768
    buffer_load_ushort v68, v0, s[52:55], s31 offen offset:2048
    buffer_load_ushort v69, v0, s[52:55], s31 offen offset:2304
    buffer_load_ushort v70, v0, s[52:55], s31 offen offset:2560
    buffer_load_ushort v71, v0, s[52:55], s31 offen offset:2816
    buffer_load_ushort v72, v0, s[52:55], s31 offen offset:64
    buffer_load_ushort v73, v0, s[52:55], s31 offen offset:320
    buffer_load_ushort v74, v0, s[52:55], s31 offen offset:576
    buffer_load_ushort v75, v0, s[52:55], s31 offen offset:832
    buffer_load_ushort v76, v0, s[52:55], s31 offen offset:2112
    buffer_load_ushort v77, v0, s[52:55], s31 offen offset:2368
    buffer_load_ushort v78, v0, s[52:55], s31 offen offset:2624
    buffer_load_ushort v79, v0, s[52:55], s31 offen offset:2880
    buffer_load_ushort v80, v0, s[52:55], s31 offen offset:128
    buffer_load_ushort v81, v0, s[52:55], s31 offen offset:384
    buffer_load_ushort v82, v0, s[52:55], s31 offen offset:640
    buffer_load_ushort v83, v0, s[52:55], s31 offen offset:896
    buffer_load_ushort v84, v0, s[52:55], s31 offen offset:2176
    buffer_load_ushort v85, v0, s[52:55], s31 offen offset:2432
    buffer_load_ushort v86, v0, s[52:55], s31 offen offset:2688
    buffer_load_ushort v87, v0, s[52:55], s31 offen offset:2944
    buffer_load_ushort v88, v0, s[52:55], s31 offen offset:192
    buffer_load_ushort v89, v0, s[52:55], s31 offen offset:448
    buffer_load_ushort v90, v0, s[52:55], s31 offen offset:704
    buffer_load_ushort v91, v0, s[52:55], s31 offen offset:960
    buffer_load_ushort v92, v0, s[52:55], s31 offen offset:2240
    buffer_load_ushort v93, v0, s[52:55], s31 offen offset:2496
    buffer_load_ushort v94, v0, s[52:55], s31 offen offset:2752
    buffer_load_ushort v95, v0, s[52:55], s31 offen offset:3008
    s_mov_b32 s62, s32
    s_mov_b32 s63, s33
KF_JOIN:
    s_waitcnt lgkmcnt(0)
    s_add_u32 s4, s4, 1
    s_add_u32 s5, s5, 1
    s_mov_b32 s8, s70
    s_mov_b32 s9, s71
    s_mov_b32 s10, 0x400000
    s_mov_b32 s11, 0x20000
    s_lshr_b32 s44, s2, 4
    s_lshl_b32 s44, s44, 13
    s_lshl_b32 s45, s3, 10
    s_add_u32 s44, s44, s45
    s_lshl_b32 s45, s20, 8
    s_add_u32 s44, s44, s45
    v_lshrrev_b32 v234, 1, v232
    v_lshlrev_b32 v234, 17, v234
    v_and_b32 v235, 1, v232
    v_lshl_add_u32 v234, v235, 7, v234
    s_add_u32 m0, s23, 0
    s_add_u32 s22, s21, 0
    s_and_b32 s22, s22, 0x3fffff
    buffer_load_dwordx4 v225, s[8:11], s22 offen offset:0 lds
    buffer_load_dwordx4 v226, s[8:11], s22 offen offset:1024 lds
    buffer_load_dwordx4 v227, s[8:11], s22 offen offset:2048 lds
    buffer_load_dwordx4 v228, s[8:11], s22 offen offset:3072 lds
    s_add_u32 m0, s23, 4096
    s_add_u32 s22, s21, 131072
    s_and_b32 s22, s22, 0x3fffff
    buffer_load_dwordx4 v225, s[8:11], s22 offen offset:0 lds
    buffer_load_dwordx4 v226, s[8:11], s22 offen offset:1024 lds
    buffer_load_dwordx4 v227, s[8:11], s22 offen offset:2048 lds
    buffer_load_dwordx4 v228, s[8:11], s22 offen offset:3072 lds
    buffer_load_dword a242, v234, s[8:11], s44 offen
    v_lshrrev_b32 v234, 5, v232
    v_lshlrev_b32 v234, 11, v234
    v_bfe_u32 v235, v232, 2, 2
    v_lshl_add_u32 v234, v235, 8, v234
    v_and_b32 v236, 16, v232
    v_lshl_add_u32 v234, v236, 1, v234
    v_and_b32 v236, 1, v232
    v_lshl_add_u32 v234, v236, 4, v234
    v_and_b32 v236, 2, v232
    v_lshl_add_u32 v234, v236, 2, v234
    v_xor_b32 v236, 0, v235
    v_lshl_add_u32 v236, v236, 6, v234
    v_add_u32 v221, s23, v236
    v_xor_b32 v236, 1, v235
    v_lshl_add_u32 v236, v236, 6, v234
    v_add_u32 v222, s23, v236
    v_xor_b32 v236, 2, v235
    v_lshl_add_u32 v236, v236, 6, v234
    v_add_u32 v223, s23, v236
    v_xor_b32 v236, 3, v235
    v_lshl_add_u32 v236, v236, 6, v234
    v_add_u32 v224, s23, v236
    v_lshrrev_b32 v234, 5, v232
    v_or_b32 v235, 0, v234
    v_xor_b32 v235, v235, v232
    v_lshlrev_b32 v192, 4, v235
    v_or_b32 v235, 2, v234
    v_xor_b32 v235, v235, v232
    v_lshlrev_b32 v193, 4, v235
    v_or_b32 v235, 4, v234
    v_xor_b32 v235, v235, v232
    v_lshlrev_b32 v194, 4, v235
    v_or_b32 v235, 6, v234
    v_xor_b32 v235, v235, v232
    v_lshlrev_b32 v195, 4, v235
    v_xor_b32 v234, v238, v239
    v_lshlrev_b32 v234, 4, v234
    v_lshrrev_b32 v235, 1, v239
    v_lshl_add_u32 v234, v235, 11, v234
    v_and_b32 v235, 1, v239
    v_lshl_add_u32 v234, v235, 9, v234
    s_lshr_b32 s44, s20, 1
    s_lshl_b32 s44, s44, 10
    s_and_b32 s45, s20, 1
    s_lshl_b32 s45, s45, 8
    s_add_u32 s44, s44, s45
    v_add_u32 v196, s44, v234
    s_mov_b32 s61, 0x3f803f80
    s_waitcnt vmcnt(9)
    v_dot2_f32_bf16 v198, v128, s61, 0
    v_dot2_f32_bf16 v199, v128, v128, 0
    v_dot2_f32_bf16 v198, v129, s61, v198
    v_dot2_f32_bf16 v199, v129, v129, v199
    v_dot2_f32_bf16 v198, v130, s61, v198
    v_dot2_f32_bf16 v199, v130, v130, v199
    v_dot2_f32_bf16 v198, v131, s61, v198
    v_dot2_f32_bf16 v199, v131, v131, v199
    v_dot2_f32_bf16 v198, v132, s61, v198
    v_dot2_f32_bf16 v199, v132, v132, v199
    v_dot2_f32_bf16 v198, v133, s61, v198
    v_dot2_f32_bf16 v199, v133, v133, v199
    v_dot2_f32_bf16 v198, v134, s61, v198
    v_dot2_f32_bf16 v199, v134, v134, v199
    v_dot2_f32_bf16 v198, v135, s61, v198
    v_dot2_f32_bf16 v199, v135, v135, v199
    v_dot2_f32_bf16 v198, v136, s61, v198
    v_dot2_f32_bf16 v199, v136, v136, v199
    v_dot2_f32_bf16 v198, v137, s61, v198
    v_dot2_f32_bf16 v199, v137, v137, v199
    v_dot2_f32_bf16 v198, v138, s61, v198
    v_dot2_f32_bf16 v199, v138, v138, v199
    v_dot2_f32_bf16 v198, v139, s61, v198
    v_dot2_f32_bf16 v199, v139, v139, v199
    v_dot2_f32_bf16 v198, v140, s61, v198
    v_dot2_f32_bf16 v199, v140, v140, v199
    v_dot2_f32_bf16 v198, v141, s61, v198
    v_dot2_f32_bf16 v199, v141, v141, v199
    v_dot2_f32_bf16 v198, v142, s61, v198
    v_dot2_f32_bf16 v199, v142, v142, v199
    v_dot2_f32_bf16 v198, v143, s61, v198
    v_dot2_f32_bf16 v199, v143, v143, v199
    s_add_u32 m0, s23, 8192
    s_add_u32 s22, s21, 262144
    s_and_b32 s22, s22, 0x3fffff
    buffer_load_dwordx4 v225, s[8:11], s22 offen offset:0 lds
    buffer_load_dwordx4 v226, s[8:11], s22 offen offset:1024 lds
    buffer_load_dwordx4 v227, s[8:11], s22 offen offset:2048 lds
    buffer_load_dwordx4 v228, s[8:11], s22 offen offset:3072 lds
    v_dot2_f32_bf16 v198, v144, s61, v198
    v_dot2_f32_bf16 v199, v144, v144, v199
    v_dot2_f32_bf16 v198, v145, s61, v198
    v_dot2_f32_bf16 v199, v145, v145, v199
    v_dot2_f32_bf16 v198, v146, s61, v198
    v_dot2_f32_bf16 v199, v146, v146, v199
    v_dot2_f32_bf16 v198, v147, s61, v198
    v_dot2_f32_bf16 v199, v147, v147, v199
    v_dot2_f32_bf16 v198, v148, s61, v198
    v_dot2_f32_bf16 v199, v148, v148, v199
    v_dot2_f32_bf16 v198, v149, s61, v198
    v_dot2_f32_bf16 v199, v149, v149, v199
    v_dot2_f32_bf16 v198, v150, s61, v198
    v_dot2_f32_bf16 v199, v150, v150, v199
    v_dot2_f32_bf16 v198, v151, s61, v198
    v_dot2_f32_bf16 v199, v151, v151, v199
    v_dot2_f32_bf16 v198, v152, s61, v198
    v_dot2_f32_bf16 v199, v152, v152, v199
    v_dot2_f32_bf16 v198, v153, s61, v198
    v_dot2_f32_bf16 v199, v153, v153, v199
    v_dot2_f32_bf16 v198, v154, s61, v198
    v_dot2_f32_bf16 v199, v154, v154, v199
    v_dot2_f32_bf16 v198, v155, s61, v198
    v_dot2_f32_bf16 v199, v155, v155, v199
    v_dot2_f32_bf16 v198, v156, s61, v198
    v_dot2_f32_bf16 v199, v156, v156, v199
    v_dot2_f32_bf16 v198, v157, s61, v198
    v_dot2_f32_bf16 v199, v157, v157, v199
    v_dot2_f32_bf16 v198, v158, s61, v198
    v_dot2_f32_bf16 v199, v158, v158, v199
    v_dot2_f32_bf16 v198, v159, s61, v198
    v_dot2_f32_bf16 v199, v159, v159, v199
    v_dot2_f32_bf16 v200, v160, s61, 0
    v_dot2_f32_bf16 v201, v160, v160, 0
    v_dot2_f32_bf16 v200, v161, s61, v200
    v_dot2_f32_bf16 v201, v161, v161, v201
    v_dot2_f32_bf16 v200, v162, s61, v200
    v_dot2_f32_bf16 v201, v162, v162, v201
    v_dot2_f32_bf16 v200, v163, s61, v200
    v_dot2_f32_bf16 v201, v163, v163, v201
    v_dot2_f32_bf16 v200, v164, s61, v200
    v_dot2_f32_bf16 v201, v164, v164, v201
    v_dot2_f32_bf16 v200, v165, s61, v200
    v_dot2_f32_bf16 v201, v165, v165, v201
    v_dot2_f32_bf16 v200, v166, s61, v200
    v_dot2_f32_bf16 v201, v166, v166, v201
    v_dot2_f32_bf16 v200, v167, s61, v200
    v_dot2_f32_bf16 v201, v167, v167, v201
    v_dot2_f32_bf16 v200, v168, s61, v200
    v_dot2_f32_bf16 v201, v168, v168, v201
    v_dot2_f32_bf16 v200, v169, s61, v200
    v_dot2_f32_bf16 v201, v169, v169, v201
    v_dot2_f32_bf16 v200, v170, s61, v200
    v_dot2_f32_bf16 v201, v170, v170, v201
    v_dot2_f32_bf16 v200, v171, s61, v200
    v_dot2_f32_bf16 v201, v171, v171, v201
    v_dot2_f32_bf16 v200, v172, s61, v200
    v_dot2_f32_bf16 v201, v172, v172, v201
    v_dot2_f32_bf16 v200, v173, s61, v200
    v_dot2_f32_bf16 v201, v173, v173, v201
    v_dot2_f32_bf16 v200, v174, s61, v200
    v_dot2_f32_bf16 v201, v174, v174, v201
    v_dot2_f32_bf16 v200, v175, s61, v200
    v_dot2_f32_bf16 v201, v175, v175, v201
    s_add_u32 m0, s23, 12288
    s_add_u32 s22, s21, 393216
    s_and_b32 s22, s22, 0x3fffff
    buffer_load_dwordx4 v225, s[8:11], s22 offen offset:0 lds
    buffer_load_dwordx4 v226, s[8:11], s22 offen offset:1024 lds
    buffer_load_dwordx4 v227, s[8:11], s22 offen offset:2048 lds
    buffer_load_dwordx4 v228, s[8:11], s22 offen offset:3072 lds
    v_dot2_f32_bf16 v200, v176, s61, v200
    v_dot2_f32_bf16 v201, v176, v176, v201
    v_dot2_f32_bf16 v200, v177, s61, v200
    v_dot2_f32_bf16 v201, v177, v177, v201
    v_dot2_f32_bf16 v200, v178, s61, v200
    v_dot2_f32_bf16 v201, v178, v178, v201
    v_dot2_f32_bf16 v200, v179, s61, v200
    v_dot2_f32_bf16 v201, v179, v179, v201
    v_dot2_f32_bf16 v200, v180, s61, v200
    v_dot2_f32_bf16 v201, v180, v180, v201
    v_dot2_f32_bf16 v200, v181, s61, v200
    v_dot2_f32_bf16 v201, v181, v181, v201
    v_dot2_f32_bf16 v200, v182, s61, v200
    v_dot2_f32_bf16 v201, v182, v182, v201
    v_dot2_f32_bf16 v200, v183, s61, v200
    v_dot2_f32_bf16 v201, v183, v183, v201
    v_dot2_f32_bf16 v200, v184, s61, v200
    v_dot2_f32_bf16 v201, v184, v184, v201
    v_dot2_f32_bf16 v200, v185, s61, v200
    v_dot2_f32_bf16 v201, v185, v185, v201
    v_dot2_f32_bf16 v200, v186, s61, v200
    v_dot2_f32_bf16 v201, v186, v186, v201
    v_dot2_f32_bf16 v200, v187, s61, v200
    v_dot2_f32_bf16 v201, v187, v187, v201
    v_dot2_f32_bf16 v200, v188, s61, v200
    v_dot2_f32_bf16 v201, v188, v188, v201
    v_dot2_f32_bf16 v200, v189, s61, v200
    v_dot2_f32_bf16 v201, v189, v189, v201
    v_dot2_f32_bf16 v200, v190, s61, v200
    v_dot2_f32_bf16 v201, v190, v190, v201
    v_dot2_f32_bf16 v200, v191, s61, v200
    v_dot2_f32_bf16 v201, v191, v191, v201
    v_add_f32_dpp v198, v198, v198 quad_perm:[1,0,3,2] row_mask:0xf bank_mask:0xf
    v_add_f32_dpp v199, v199, v199 quad_perm:[1,0,3,2] row_mask:0xf bank_mask:0xf
    v_add_f32_dpp v200, v200, v200 quad_perm:[1,0,3,2] row_mask:0xf bank_mask:0xf
    v_add_f32_dpp v201, v201, v201 quad_perm:[1,0,3,2] row_mask:0xf bank_mask:0xf
    v_add_f32_dpp v198, v198, v198 quad_perm:[2,3,0,1] row_mask:0xf bank_mask:0xf
    v_add_f32_dpp v199, v199, v199 quad_perm:[2,3,0,1] row_mask:0xf bank_mask:0xf
    v_add_f32_dpp v200, v200, v200 quad_perm:[2,3,0,1] row_mask:0xf bank_mask:0xf
    v_add_f32_dpp v201, v201, v201 quad_perm:[2,3,0,1] row_mask:0xf bank_mask:0xf
    v_add_f32_dpp v198, v198, v198 row_half_mirror row_mask:0xf bank_mask:0xf
    v_add_f32_dpp v199, v199, v199 row_half_mirror row_mask:0xf bank_mask:0xf
    v_add_f32_dpp v200, v200, v200 row_half_mirror row_mask:0xf bank_mask:0xf
    v_add_f32_dpp v201, v201, v201 row_half_mirror row_mask:0xf bank_mask:0xf
    v_mul_f32 v234, 0x3b000000, v198
    v_mul_f32 v199, 0x3b000000, v199
    v_fma_f32 v199, -v234, v234, v199
    v_max_f32 v199, 0, v199
    v_add_f32 v199, 0x3727c5ac, v199
    v_rsq_f32 v198, v199
    s_nop 0
    v_mul_f32 v199, v234, v198
    v_sub_f32 v199, 0, v199
    v_mul_f32 v234, 0x3b000000, v200
    v_mul_f32 v201, 0x3b000000, v201
    v_fma_f32 v201, -v234, v234, v201
    v_max_f32 v201, 0, v201
    v_add_f32 v201, 0x3727c5ac, v201
    v_rsq_f32 v200, v201
    s_nop 0
    v_mul_f32 v201, v234, v200
    v_sub_f32 v201, 0, v201
    v_lshlrev_b32 v0, 16, v128
    v_and_b32 v1, 0xffff0000, v128
    v_lshlrev_b32 v2, 16, v129
    v_and_b32 v3, 0xffff0000, v129
    v_lshlrev_b32 v4, 16, v130
    v_and_b32 v5, 0xffff0000, v130
    v_lshlrev_b32 v6, 16, v131
    v_and_b32 v7, 0xffff0000, v131
    v_pk_fma_f32 v[0:1], v[0:1], v[198:199], v[198:199] op_sel:[0,0,1] op_sel_hi:[1,0,1]
    v_pk_fma_f32 v[2:3], v[2:3], v[198:199], v[198:199] op_sel:[0,0,1] op_sel_hi:[1,0,1]
    v_pk_fma_f32 v[4:5], v[4:5], v[198:199], v[198:199] op_sel:[0,0,1] op_sel_hi:[1,0,1]
    v_pk_fma_f32 v[6:7], v[6:7], v[198:199], v[198:199] op_sel:[0,0,1] op_sel_hi:[1,0,1]
    v_lshlrev_b32 v8, 16, v160
    v_and_b32 v9, 0xffff0000, v160
    v_lshlrev_b32 v10, 16, v161
    v_and_b32 v11, 0xffff0000, v161
    v_lshlrev_b32 v12, 16, v162
    v_and_b32 v13, 0xffff0000, v162
    v_lshlrev_b32 v14, 16, v163
    v_and_b32 v15, 0xffff0000, v163
    v_pk_fma_f32 v[8:9], v[8:9], v[200:201], v[200:201] op_sel:[0,0,1] op_sel_hi:[1,0,1]
    v_pk_fma_f32 v[10:11], v[10:11], v[200:201], v[200:201] op_sel:[0,0,1] op_sel_hi:[1,0,1]
    v_pk_fma_f32 v[12:13], v[12:13], v[200:201], v[200:201] op_sel:[0,0,1] op_sel_hi:[1,0,1]
    v_pk_fma_f32 v[14:15], v[14:15], v[200:201], v[200:201] op_sel:[0,0,1] op_sel_hi:[1,0,1]
    s_lshl_b32 s44, s3, 19
    s_add_u32 s16, s72, s44
    s_addc_u32 s17, s73, 0
    s_mov_b32 s18, 0x80000
    s_mov_b32 s19, 0x20000
    s_mov_b32 s30, 0x5f800000
    s_lshl_b32 s44, s3, 18
    s_lshl_b32 s45, s20, 12
    s_add_u32 s27, s44, s45
    s_add_u32 s27, s27, 0x40000
    s_mov_b32 s26, s45
    s_lshl_b32 s44, s39, 1
    s_and_b32 s45, s20, 1
    s_add_u32 s44, s44, s45
    s_mul_i32 s44, s44, 28672
    s_lshr_b32 s45, s38, 1
    s_mul_i32 s45, s45, 896
    s_add_u32 s54, s44, s45
    s_lshl_b32 s44, s39, 2
    s_add_u32 s44, s44, s20
    s_mul_i32 s55, s44, 14336
    v_add_u32 v230, 65536, v220
    s_lshl_b32 s34, s3, 3
    s_add_u32 s34, s34, 0x38600
    s_mov_b32 s35, 0x38200
    s_mov_b32 s36, 0x38400
    v_lshlrev_b32 v244, 2, v220
    v_min_u32 v244, 448, v244
    s_lshl_b32 s42, s2, 3
    s_add_u32 s42, s42, 0x38000
    v_lshrrev_b32 v245, 2, v220
    s_mov_b32 s47, 32768
    s_lshl_b32 s44, s20, 10
    v_add_u32 v234, s44, v220
    s_lshl_b32 s45, s43, 8
    v_subrev_u32 v235, s45, v234
    v_and_b32 v235, 0x7ff, v235
    v_and_b32 v234, 0x800, v234
    v_or_b32 v234, v234, v235
    v_lshlrev_b32 v197, 5, v239
    v_add_u32 v197, 57344, v197
    v_add_u32 v234, 57344, v234
    v_lshlrev_b32 v245, 1, v220
    s_lshl_b32 s44, s20, 11
    s_add_u32 s44, s44, 0x3a000
KF_POLL:
    buffer_load_dwordx4 v[40:43], v245, s[12:15], s44 offen sc1
    buffer_load_dwordx4 v[44:47], v245, s[12:15], s44 offen offset:16 sc1
    s_sub_u32 s47, s47, 1
    s_waitcnt vmcnt(0)
    v_xor_b32 v41, s4, v41
    v_xor_b32 v43, s4, v43
    v_xor_b32 v45, s4, v45
    v_xor_b32 v47, s4, v47
    v_or3_b32 v41, v41, v43, v45
    v_or_b32 v41, v41, v47
    v_cmp_ne_u32 vcc, 0, v41
    s_cbranch_vccz KF_GO
    s_sleep 2
    s_cmp_lg_u32 s47, 0
    s_cbranch_scc1 KF_POLL
KF_GO:
    v_mov_b32 v32, v40
    v_mov_b32 v33, v42
    v_mov_b32 v34, v44
    v_mov_b32 v35, v46
    s_cmp_lt_u32 s20, 2
    s_cbranch_scc1 KF_SA
    v_add_f32 v32, 1.0, v32
    v_add_f32 v33, 1.0, v33
    v_add_f32 v34, 1.0, v34
    v_add_f32 v35, 1.0, v35
    v_cvt_pk_bf16_f32 v36, v32, v33
    v_cvt_pk_bf16_f32 v37, v34, v35
    v_lshlrev_b32 v32, 16, v36
    v_and_b32 v33, 0xffff0000, v36
    v_lshlrev_b32 v34, 16, v37
    v_and_b32 v35, 0xffff0000, v37
KF_SA:
    v_mul_f32 v32, 0x3e0293ee, v32
    v_mul_f32 v33, 0x3e0293ee, v33
    v_mul_f32 v34, 0x3e0293ee, v34
    v_mul_f32 v35, 0x3e0293ee, v35
    ds_write_b128 v234, v[32:35]
    s_cmp_lt_u32 s2, 192
    s_cbranch_scc1 KF_NKV
    buffer_store_dwordx4 v[96:99], v220, s[12:15], s62 offen offset:0 sc1
    buffer_store_dwordx4 v[100:103], v220, s[12:15], s62 offen offset:1024 sc1
    buffer_store_dwordx4 v[104:107], v220, s[12:15], s62 offen offset:2048 sc1
    buffer_store_dwordx4 v[108:111], v220, s[12:15], s62 offen offset:3072 sc1
    v_lshl_or_b32 v112, v65, 16, v64
    v_lshl_or_b32 v113, v67, 16, v66
    v_lshl_or_b32 v114, v69, 16, v68
    v_lshl_or_b32 v115, v71, 16, v70
    buffer_store_dwordx4 v[112:115], v220, s[12:15], s63 offen offset:0 sc1
    v_lshl_or_b32 v116, v73, 16, v72
    v_lshl_or_b32 v117, v75, 16, v74
    v_lshl_or_b32 v118, v77, 16, v76
    v_lshl_or_b32 v119, v79, 16, v78
    buffer_store_dwordx4 v[116:119], v220, s[12:15], s63 offen offset:1024 sc1
    v_lshl_or_b32 v120, v81, 16, v80
    v_lshl_or_b32 v121, v83, 16, v82
    v_lshl_or_b32 v122, v85, 16, v84
    v_lshl_or_b32 v123, v87, 16, v86
    buffer_store_dwordx4 v[120:123], v220, s[12:15], s63 offen offset:2048 sc1
    v_lshl_or_b32 v124, v89, 16, v88
    v_lshl_or_b32 v125, v91, 16, v90
    v_lshl_or_b32 v126, v93, 16, v92
    v_lshl_or_b32 v127, v95, 16, v94
    buffer_store_dwordx4 v[124:127], v220, s[12:15], s63 offen offset:3072 sc1
KF_NKV:
    s_add_u32 m0, s29, 65536
    s_add_u32 s22, s21, 524288
    s_and_b32 s22, s22, 0x3fffff
    buffer_load_dwordx4 v225, s[8:11], s22 offen offset:0 lds
    buffer_load_dwordx4 v226, s[8:11], s22 offen offset:1024 lds
    buffer_load_dwordx4 v227, s[8:11], s22 offen offset:2048 lds
    buffer_load_dwordx4 v228, s[8:11], s22 offen offset:3072 lds
    s_add_u32 m0, s29, 69632
    s_add_u32 s22, s21, 655360
    s_and_b32 s22, s22, 0x3fffff
    buffer_load_dwordx4 v225, s[8:11], s22 offen offset:0 lds
    buffer_load_dwordx4 v226, s[8:11], s22 offen offset:1024 lds
    buffer_load_dwordx4 v227, s[8:11], s22 offen offset:2048 lds
    buffer_load_dwordx4 v228, s[8:11], s22 offen offset:3072 lds
    s_sub_u32 s45, s29, s23
    s_waitcnt lgkmcnt(0)
    s_barrier
    ds_read_b128 v[16:19], v197
    ds_read_b128 v[20:23], v197 offset:16
    ds_read_b128 v[24:27], v197 offset:2048
    ds_read_b128 v[28:31], v197 offset:2064
    ds_read_b128 v[208:211], v197 offset:256
    ds_read_b128 v[212:215], v197 offset:2304
    v_add_u32 v232, s45, v221
    v_add_u32 v233, s45, v222
    v_add_u32 v234, s45, v223
    v_add_u32 v235, s45, v224
    v_add_u32 v128, 65536, v232
    v_add_u32 v129, 65536, v233
    v_add_u32 v130, 65536, v234
    v_add_u32 v131, 65536, v235
    s_waitcnt lgkmcnt(2)
    v_pk_fma_f32 v[0:1], v[0:1], v[24:25], v[16:17]
    v_pk_fma_f32 v[2:3], v[2:3], v[26:27], v[18:19]
    v_pk_fma_f32 v[4:5], v[4:5], v[28:29], v[20:21]
    v_pk_fma_f32 v[6:7], v[6:7], v[30:31], v[22:23]
    v_cvt_pk_bf16_f32 v0, v0, v1
    v_cvt_pk_bf16_f32 v1, v2, v3
    v_cvt_pk_bf16_f32 v2, v4, v5
    v_cvt_pk_bf16_f32 v3, v6, v7
    ds_write_b128 v196, v[0:3] offset:0
    v_pk_fma_f32 v[8:9], v[8:9], v[24:25], v[16:17]
    v_pk_fma_f32 v[10:11], v[10:11], v[26:27], v[18:19]
    v_pk_fma_f32 v[12:13], v[12:13], v[28:29], v[20:21]
    v_pk_fma_f32 v[14:15], v[14:15], v[30:31], v[22:23]
    v_cvt_pk_bf16_f32 v8, v8, v9
    v_cvt_pk_bf16_f32 v9, v10, v11
    v_cvt_pk_bf16_f32 v10, v12, v13
    v_cvt_pk_bf16_f32 v11, v14, v15
    ds_write_b128 v196, v[8:11] offset:128
    s_add_u32 m0, s29, 24576
    s_add_u32 s22, s21, 1835008
    s_and_b32 s22, s22, 0x3fffff
    buffer_load_dwordx4 v225, s[8:11], s22 offen offset:0 lds
    buffer_load_dwordx4 v226, s[8:11], s22 offen offset:1024 lds
    buffer_load_dwordx4 v227, s[8:11], s22 offen offset:2048 lds
    buffer_load_dwordx4 v228, s[8:11], s22 offen offset:3072 lds
    s_add_u32 m0, s29, 28672
    s_add_u32 s22, s21, 3145728
    s_and_b32 s22, s22, 0x3fffff
    buffer_load_dwordx4 v225, s[8:11], s22 offen offset:0 lds
    buffer_load_dwordx4 v226, s[8:11], s22 offen offset:1024 lds
    buffer_load_dwordx4 v227, s[8:11], s22 offen offset:2048 lds
    buffer_load_dwordx4 v228, s[8:11], s22 offen offset:3072 lds
    s_waitcnt lgkmcnt(0)
    s_barrier
    ds_read_b128 a[224:227], v192 offset:0
    ds_read_b128 a[228:231], v192 offset:1024
    ds_read_b64_tr_b16 a[192:193], v221 offset:0
    ds_read_b64_tr_b16 a[194:195], v221 offset:1024
    ds_read_b64_tr_b16 a[196:197], v222 offset:0
    ds_read_b64_tr_b16 a[198:199], v222 offset:1024
    ds_read_b64_tr_b16 a[200:201], v223 offset:0
    ds_read_b64_tr_b16 a[202:203], v223 offset:1024
    ds_read_b64_tr_b16 a[204:205], v224 offset:0
    ds_read_b64_tr_b16 a[206:207], v224 offset:1024
    s_waitcnt lgkmcnt(0)
    v_mfma_f32_32x32x16_bf16 v[0:15], a[192:195], a[224:227], 0
    ds_read_b128 a[232:235], v193 offset:2048
    s_add_u32 m0, s23, 0
    s_add_u32 s22, s21, 786432
    s_and_b32 s22, s22, 0x3fffff
    v_lshlrev_b32 v216, 16, v132
    v_and_b32 v217, 0xffff0000, v132
    v_lshlrev_b32 v218, 16, v133
    v_and_b32 v219, 0xffff0000, v133
    v_fma_f32 v216, v216, v198, v199
    v_mfma_f32_32x32x16_bf16 v[16:31], a[192:195], a[228:231], 0
    buffer_load_dwordx4 v225, s[8:11], s22 offen offset:0 lds
    ds_read_b64_tr_b16 a[208:209], v221 offset:4096
    ds_read_b64_tr_b16 a[210:211], v221 offset:5120
    v_fma_f32 v217, v217, v198, v199
    v_fma_f32 v218, v218, v198, v199
    v_mfma_f32_32x32x16_bf16 v[32:47], a[196:199], a[224:227], 0
    ds_read_b128 a[236:239], v193 offset:3072
    ds_read_b64_tr_b16 a[212:213], v222 offset:4096
    ds_read_b64_tr_b16 a[214:215], v222 offset:5120
    v_fma_f32 v219, v219, v198, v199
    v_fma_f32 v216, v216, v212, v208
    v_fma_f32 v217, v217, v213, v209
    v_mfma_f32_32x32x16_bf16 v[48:63], a[196:199], a[228:231], 0
    buffer_load_dwordx4 v226, s[8:11], s22 offen offset:1024 lds
    ds_read_b64_tr_b16 a[216:217], v223 offset:4096
    ds_read_b128 v[236:239], v197 offset:272
    ds_read_b128 v[240:243], v197 offset:2320
    v_fma_f32 v218, v218, v214, v210
    v_fma_f32 v219, v219, v215, v211
    v_mfma_f32_32x32x16_bf16 v[64:79], a[200:203], a[224:227], 0
    ds_read_b64_tr_b16 a[218:219], v223 offset:5120
    ds_read_b64_tr_b16 a[220:221], v224 offset:4096
    ds_read_b64_tr_b16 a[222:223], v224 offset:5120
    v_cvt_pk_bf16_f32 v132, v216, v217
    v_cvt_pk_bf16_f32 v133, v218, v219
    v_lshlrev_b32 v216, 16, v164
    v_mfma_f32_32x32x16_bf16 v[80:95], a[200:203], a[228:231], 0
    buffer_load_dwordx4 v227, s[8:11], s22 offen offset:2048 lds
    v_and_b32 v217, 0xffff0000, v164
    v_lshlrev_b32 v218, 16, v165
    v_and_b32 v219, 0xffff0000, v165
    v_fma_f32 v216, v216, v200, v201
    v_mfma_f32_32x32x16_bf16 v[96:111], a[204:207], a[224:227], 0
    v_fma_f32 v217, v217, v200, v201
    v_fma_f32 v218, v218, v200, v201
    v_fma_f32 v219, v219, v200, v201
    v_fma_f32 v216, v216, v212, v208
    v_fma_f32 v217, v217, v213, v209
    v_mfma_f32_32x32x16_bf16 v[112:127], a[204:207], a[228:231], 0
    s_waitcnt lgkmcnt(0)
    buffer_load_dwordx4 v228, s[8:11], s22 offen offset:3072 lds
    v_fma_f32 v218, v218, v214, v210
    v_fma_f32 v219, v219, v215, v211
    v_cvt_pk_bf16_f32 v164, v216, v217
    v_cvt_pk_bf16_f32 v165, v218, v219
    v_mfma_f32_32x32x16_bf16 v[0:15], a[208:211], a[232:235], v[0:15]
    ds_read_b128 a[224:227], v194 offset:4096
    s_add_u32 m0, s23, 4096
    s_add_u32 s22, s21, 917504
    s_and_b32 s22, s22, 0x3fffff
    v_lshlrev_b32 v216, 16, v134
    v_and_b32 v217, 0xffff0000, v134
    v_lshlrev_b32 v218, 16, v135
    v_and_b32 v219, 0xffff0000, v135
    v_fma_f32 v216, v216, v198, v199
    v_mfma_f32_32x32x16_bf16 v[16:31], a[208:211], a[236:239], v[16:31]
    buffer_load_dwordx4 v225, s[8:11], s22 offen offset:0 lds
    ds_read_b64_tr_b16 a[192:193], v221 offset:8192
    ds_read_b64_tr_b16 a[194:195], v221 offset:9216
    v_fma_f32 v217, v217, v198, v199
    v_fma_f32 v218, v218, v198, v199
    v_mfma_f32_32x32x16_bf16 v[32:47], a[212:215], a[232:235], v[32:47]
    ds_read_b128 a[228:231], v194 offset:5120
    ds_read_b64_tr_b16 a[196:197], v222 offset:8192
    ds_read_b64_tr_b16 a[198:199], v222 offset:9216
    v_fma_f32 v219, v219, v198, v199
    v_fma_f32 v216, v216, v240, v236
    v_fma_f32 v217, v217, v241, v237
    v_mfma_f32_32x32x16_bf16 v[48:63], a[212:215], a[236:239], v[48:63]
    buffer_load_dwordx4 v226, s[8:11], s22 offen offset:1024 lds
    ds_read_b64_tr_b16 a[200:201], v223 offset:8192
    ds_read_b128 v[208:211], v197 offset:512
    ds_read_b128 v[212:215], v197 offset:2560
    v_fma_f32 v218, v218, v242, v238
    v_fma_f32 v219, v219, v243, v239
    v_mfma_f32_32x32x16_bf16 v[64:79], a[216:219], a[232:235], v[64:79]
    ds_read_b64_tr_b16 a[202:203], v223 offset:9216
    ds_read_b64_tr_b16 a[204:205], v224 offset:8192
    ds_read_b64_tr_b16 a[206:207], v224 offset:9216
    v_cvt_pk_bf16_f32 v134, v216, v217
    v_cvt_pk_bf16_f32 v135, v218, v219
    v_lshlrev_b32 v216, 16, v166
    v_mfma_f32_32x32x16_bf16 v[80:95], a[216:219], a[236:239], v[80:95]
    buffer_load_dwordx4 v227, s[8:11], s22 offen offset:2048 lds
    v_and_b32 v217, 0xffff0000, v166
    v_lshlrev_b32 v218, 16, v167
    v_and_b32 v219, 0xffff0000, v167
    v_fma_f32 v216, v216, v200, v201
    v_mfma_f32_32x32x16_bf16 v[96:111], a[220:223], a[232:235], v[96:111]
    v_fma_f32 v217, v217, v200, v201
    v_fma_f32 v218, v218, v200, v201
    v_fma_f32 v219, v219, v200, v201
    v_fma_f32 v216, v216, v240, v236
    v_fma_f32 v217, v217, v241, v237
    v_mfma_f32_32x32x16_bf16 v[112:127], a[220:223], a[236:239], v[112:127]
    s_waitcnt lgkmcnt(0)
    buffer_load_dwordx4 v228, s[8:11], s22 offen offset:3072 lds
    v_fma_f32 v218, v218, v242, v238
    v_fma_f32 v219, v219, v243, v239
    v_cvt_pk_bf16_f32 v166, v216, v217
    v_cvt_pk_bf16_f32 v167, v218, v219
    v_mfma_f32_32x32x16_bf16 v[0:15], a[192:195], a[224:227], v[0:15]
    ds_read_b128 a[232:235], v195 offset:6144
    s_add_u32 m0, s23, 8192
    s_add_u32 s22, s21, 1048576
    s_and_b32 s22, s22, 0x3fffff
    ds_write_b128 v196, v[132:135] offset:8192
    v_lshlrev_b32 v216, 16, v136
    v_and_b32 v217, 0xffff0000, v136
    v_lshlrev_b32 v218, 16, v137
    v_mfma_f32_32x32x16_bf16 v[16:31], a[192:195], a[228:231], v[16:31]
    buffer_load_dwordx4 v225, s[8:11], s22 offen offset:0 lds
    ds_read_b64_tr_b16 a[208:209], v221 offset:12288
    ds_read_b64_tr_b16 a[210:211], v221 offset:13312
    v_and_b32 v219, 0xffff0000, v137
    v_fma_f32 v216, v216, v198, v199
    v_fma_f32 v217, v217, v198, v199
    v_mfma_f32_32x32x16_bf16 v[32:47], a[196:199], a[224:227], v[32:47]
    ds_read_b128 a[236:239], v195 offset:7168
    ds_read_b64_tr_b16 a[212:213], v222 offset:12288
    ds_read_b64_tr_b16 a[214:215], v222 offset:13312
    ds_write_b128 v196, v[164:167] offset:8320
    v_fma_f32 v218, v218, v198, v199
    v_mfma_f32_32x32x16_bf16 v[48:63], a[196:199], a[228:231], v[48:63]
    buffer_load_dwordx4 v226, s[8:11], s22 offen offset:1024 lds
    ds_read_b64_tr_b16 a[216:217], v223 offset:12288
    ds_read_b128 v[236:239], v197 offset:528
    ds_read_b128 v[240:243], v197 offset:2576
    v_fma_f32 v219, v219, v198, v199
    v_fma_f32 v216, v216, v212, v208
    v_mfma_f32_32x32x16_bf16 v[64:79], a[200:203], a[224:227], v[64:79]
    ds_read_b64_tr_b16 a[218:219], v223 offset:13312
    ds_read_b64_tr_b16 a[220:221], v224 offset:12288
    ds_read_b64_tr_b16 a[222:223], v224 offset:13312
    v_fma_f32 v217, v217, v213, v209
    v_fma_f32 v218, v218, v214, v210
    v_fma_f32 v219, v219, v215, v211
    v_cvt_pk_bf16_f32 v136, v216, v217
    v_mfma_f32_32x32x16_bf16 v[80:95], a[200:203], a[228:231], v[80:95]
    buffer_load_dwordx4 v227, s[8:11], s22 offen offset:2048 lds
    v_cvt_pk_bf16_f32 v137, v218, v219
    v_lshlrev_b32 v216, 16, v168
    v_and_b32 v217, 0xffff0000, v168
    v_lshlrev_b32 v218, 16, v169
    v_and_b32 v219, 0xffff0000, v169
    v_mfma_f32_32x32x16_bf16 v[96:111], a[204:207], a[224:227], v[96:111]
    v_fma_f32 v216, v216, v200, v201
    v_fma_f32 v217, v217, v200, v201
    v_fma_f32 v218, v218, v200, v201
    v_fma_f32 v219, v219, v200, v201
    v_fma_f32 v216, v216, v212, v208
    v_mfma_f32_32x32x16_bf16 v[112:127], a[204:207], a[228:231], v[112:127]
    s_waitcnt lgkmcnt(0)
    buffer_load_dwordx4 v228, s[8:11], s22 offen offset:3072 lds
    v_fma_f32 v217, v217, v213, v209
    v_fma_f32 v218, v218, v214, v210
    v_fma_f32 v219, v219, v215, v211
    v_cvt_pk_bf16_f32 v168, v216, v217
    v_cvt_pk_bf16_f32 v169, v218, v219
    v_mfma_f32_32x32x16_bf16 v[0:15], a[208:211], a[232:235], v[0:15]
    s_barrier
    s_waitcnt vmcnt(24)
    s_add_u32 m0, s23, 12288
    s_add_u32 s22, s21, 1179648
    s_and_b32 s22, s22, 0x3fffff
    ds_read_b128 a[224:227], v192 offset:8192
    v_lshlrev_b32 v216, 16, v138
    v_and_b32 v217, 0xffff0000, v138
    v_lshlrev_b32 v218, 16, v139
    v_and_b32 v219, 0xffff0000, v139
    v_fma_f32 v216, v216, v198, v199
    v_mfma_f32_32x32x16_bf16 v[16:31], a[208:211], a[236:239], v[16:31]
    buffer_load_dwordx4 v225, s[8:11], s22 offen offset:0 lds
    ds_read_b64_tr_b16 a[192:193], v128 offset:0
    ds_read_b64_tr_b16 a[194:195], v128 offset:1024
    v_fma_f32 v217, v217, v198, v199
    v_fma_f32 v218, v218, v198, v199
    v_mfma_f32_32x32x16_bf16 v[32:47], a[212:215], a[232:235], v[32:47]
    ds_read_b128 a[228:231], v192 offset:9216
    ds_read_b64_tr_b16 a[196:197], v129 offset:0
    ds_read_b64_tr_b16 a[198:199], v129 offset:1024
    v_fma_f32 v219, v219, v198, v199
    v_fma_f32 v216, v216, v240, v236
    v_fma_f32 v217, v217, v241, v237
    v_mfma_f32_32x32x16_bf16 v[48:63], a[212:215], a[236:239], v[48:63]
    buffer_load_dwordx4 v226, s[8:11], s22 offen offset:1024 lds
    ds_read_b64_tr_b16 a[200:201], v130 offset:0
    ds_read_b128 v[208:211], v197 offset:768
    ds_read_b128 v[212:215], v197 offset:2816
    v_fma_f32 v218, v218, v242, v238
    v_fma_f32 v219, v219, v243, v239
    v_mfma_f32_32x32x16_bf16 v[64:79], a[216:219], a[232:235], v[64:79]
    ds_read_b64_tr_b16 a[202:203], v130 offset:1024
    ds_read_b64_tr_b16 a[204:205], v131 offset:0
    ds_read_b64_tr_b16 a[206:207], v131 offset:1024
    v_cvt_pk_bf16_f32 v138, v216, v217
    v_cvt_pk_bf16_f32 v139, v218, v219
    v_lshlrev_b32 v216, 16, v170
    v_mfma_f32_32x32x16_bf16 v[80:95], a[216:219], a[236:239], v[80:95]
    buffer_load_dwordx4 v227, s[8:11], s22 offen offset:2048 lds
    v_and_b32 v217, 0xffff0000, v170
    v_lshlrev_b32 v218, 16, v171
    v_and_b32 v219, 0xffff0000, v171
    v_fma_f32 v216, v216, v200, v201
    v_mfma_f32_32x32x16_bf16 v[96:111], a[220:223], a[232:235], v[96:111]
    v_fma_f32 v217, v217, v200, v201
    v_fma_f32 v218, v218, v200, v201
    v_fma_f32 v219, v219, v200, v201
    v_fma_f32 v216, v216, v240, v236
    v_fma_f32 v217, v217, v241, v237
    v_mfma_f32_32x32x16_bf16 v[112:127], a[220:223], a[236:239], v[112:127]
    s_waitcnt lgkmcnt(0)
    buffer_load_dwordx4 v228, s[8:11], s22 offen offset:3072 lds
    v_fma_f32 v218, v218, v242, v238
    v_fma_f32 v219, v219, v243, v239
    v_cvt_pk_bf16_f32 v170, v216, v217
    v_cvt_pk_bf16_f32 v171, v218, v219
    v_mfma_f32_32x32x16_bf16 v[0:15], a[192:195], a[224:227], v[0:15]
    s_waitcnt vmcnt(24)
    s_add_u32 m0, s29, 65536
    s_add_u32 s22, s21, 1310720
    s_and_b32 s22, s22, 0x3fffff
    ds_read_b128 a[232:235], v193 offset:10240
    ds_write_b128 v196, v[136:139] offset:16384
    v_lshlrev_b32 v216, 16, v140
    v_mfma_f32_32x32x16_bf16 v[16:31], a[192:195], a[228:231], v[16:31]
    buffer_load_dwordx4 v225, s[8:11], s22 offen offset:0 lds
    ds_read_b64_tr_b16 a[208:209], v128 offset:4096
    ds_read_b64_tr_b16 a[210:211], v128 offset:5120
    v_and_b32 v217, 0xffff0000, v140
    v_mfma_f32_32x32x16_bf16 v[32:47], a[196:199], a[224:227], v[32:47]
    ds_read_b128 a[236:239], v193 offset:11264
    ds_read_b64_tr_b16 a[212:213], v129 offset:4096
    ds_read_b64_tr_b16 a[214:215], v129 offset:5120
    ds_write_b128 v196, v[168:171] offset:16512
    v_mfma_f32_32x32x16_bf16 v[48:63], a[196:199], a[228:231], v[48:63]
    buffer_load_dwordx4 v226, s[8:11], s22 offen offset:1024 lds
    ds_read_b64_tr_b16 a[216:217], v130 offset:4096
    v_lshlrev_b32 v218, 16, v141
    v_mfma_f32_32x32x16_bf16 v[64:79], a[200:203], a[224:227], v[64:79]
    ds_read_b64_tr_b16 a[218:219], v130 offset:5120
    ds_read_b64_tr_b16 a[220:221], v131 offset:4096
    ds_read_b64_tr_b16 a[222:223], v131 offset:5120
    v_and_b32 v219, 0xffff0000, v141
    v_fma_f32 v216, v216, v198, v199
    v_mfma_f32_32x32x16_bf16 v[80:95], a[200:203], a[228:231], v[80:95]
    buffer_load_dwordx4 v227, s[8:11], s22 offen offset:2048 lds
    v_fma_f32 v217, v217, v198, v199
    v_fma_f32 v218, v218, v198, v199
    v_mfma_f32_32x32x16_bf16 v[96:111], a[204:207], a[224:227], v[96:111]
    v_fma_f32 v219, v219, v198, v199
    v_fma_f32 v216, v216, v212, v208
    v_fma_f32 v217, v217, v213, v209
    v_fma_f32 v218, v218, v214, v210
    v_mfma_f32_32x32x16_bf16 v[112:127], a[204:207], a[228:231], v[112:127]
    s_waitcnt lgkmcnt(0)
    buffer_load_dwordx4 v228, s[8:11], s22 offen offset:3072 lds
    v_fma_f32 v219, v219, v215, v211
    v_cvt_pk_bf16_f32 v140, v216, v217
    v_cvt_pk_bf16_f32 v141, v218, v219
    v_mfma_f32_32x32x16_bf16 v[0:15], a[208:211], a[232:235], v[0:15]
    s_waitcnt vmcnt(16)
    s_add_u32 m0, s29, 69632
    s_add_u32 s22, s21, 1441792
    s_and_b32 s22, s22, 0x3fffff
    ds_read_b128 a[224:227], v194 offset:12288
    v_lshlrev_b32 v216, 16, v172
    v_and_b32 v217, 0xffff0000, v172
    v_lshlrev_b32 v218, 16, v173
    v_and_b32 v219, 0xffff0000, v173
    v_mfma_f32_32x32x16_bf16 v[16:31], a[208:211], a[236:239], v[16:31]
    buffer_load_dwordx4 v225, s[8:11], s22 offen offset:0 lds
    ds_read_b64_tr_b16 a[192:193], v221 offset:0
    ds_read_b64_tr_b16 a[194:195], v221 offset:1024
    v_fma_f32 v216, v216, v200, v201
    v_mfma_f32_32x32x16_bf16 v[32:47], a[212:215], a[232:235], v[32:47]
    ds_read_b128 a[228:231], v194 offset:13312
    ds_read_b64_tr_b16 a[196:197], v222 offset:0
    ds_read_b64_tr_b16 a[198:199], v222 offset:1024
    ds_read_b64_tr_b16 a[64:65], v232 offset:24576
    ds_read_b64_tr_b16 a[66:67], v232 offset:25600
    v_fma_f32 v217, v217, v200, v201
    v_mfma_f32_32x32x16_bf16 v[48:63], a[212:215], a[236:239], v[48:63]
    buffer_load_dwordx4 v226, s[8:11], s22 offen offset:1024 lds
    ds_read_b64_tr_b16 a[200:201], v223 offset:0
    ds_read_b64_tr_b16 a[68:69], v233 offset:24576
    ds_read_b64_tr_b16 a[70:71], v233 offset:25600
    ds_read_b128 v[236:239], v197 offset:784
    ds_read_b128 v[240:243], v197 offset:2832
    v_mfma_f32_32x32x16_bf16 v[64:79], a[216:219], a[232:235], v[64:79]
    ds_read_b64_tr_b16 a[202:203], v223 offset:1024
    ds_read_b64_tr_b16 a[204:205], v224 offset:0
    ds_read_b64_tr_b16 a[206:207], v224 offset:1024
    ds_read_b64_tr_b16 a[72:73], v234 offset:24576
    ds_read_b64_tr_b16 a[74:75], v234 offset:25600
    v_mfma_f32_32x32x16_bf16 v[80:95], a[216:219], a[236:239], v[80:95]
    buffer_load_dwordx4 v227, s[8:11], s22 offen offset:2048 lds
    ds_read_b64_tr_b16 a[76:77], v235 offset:24576
    ds_read_b64_tr_b16 a[78:79], v235 offset:25600
    v_fma_f32 v218, v218, v200, v201
    v_mfma_f32_32x32x16_bf16 v[96:111], a[220:223], a[232:235], v[96:111]
    v_fma_f32 v219, v219, v200, v201
    v_fma_f32 v216, v216, v212, v208
    v_fma_f32 v217, v217, v213, v209
    v_fma_f32 v218, v218, v214, v210
    v_mfma_f32_32x32x16_bf16 v[112:127], a[220:223], a[236:239], v[112:127]
    s_waitcnt lgkmcnt(0)
    buffer_load_dwordx4 v228, s[8:11], s22 offen offset:3072 lds
    v_fma_f32 v219, v219, v215, v211
    v_cvt_pk_bf16_f32 v172, v216, v217
    v_cvt_pk_bf16_f32 v173, v218, v219
    v_mfma_f32_32x32x16_bf16 v[0:15], a[192:195], a[224:227], v[0:15]
    s_waitcnt vmcnt(16)
    s_add_u32 m0, s23, 0
    s_add_u32 s22, s21, 1572864
    s_and_b32 s22, s22, 0x3fffff
    ds_read_b128 a[232:235], v195 offset:14336
    v_lshlrev_b32 v216, 16, v142
    v_and_b32 v217, 0xffff0000, v142
    v_lshlrev_b32 v218, 16, v143
    v_and_b32 v219, 0xffff0000, v143
    v_mfma_f32_32x32x16_bf16 v[16:31], a[192:195], a[228:231], v[16:31]
    buffer_load_dwordx4 v225, s[8:11], s22 offen offset:0 lds
    ds_read_b64_tr_b16 a[208:209], v221 offset:4096
    ds_read_b64_tr_b16 a[210:211], v221 offset:5120
    v_fma_f32 v216, v216, v198, v199
    v_mfma_f32_32x32x16_bf16 v[32:47], a[196:199], a[224:227], v[32:47]
    ds_read_b128 a[236:239], v195 offset:15360
    ds_read_b64_tr_b16 a[212:213], v222 offset:4096
    ds_read_b64_tr_b16 a[214:215], v222 offset:5120
    ds_read_b64_tr_b16 a[80:81], v232 offset:28672
    ds_read_b64_tr_b16 a[82:83], v232 offset:29696
    v_mfma_f32_32x32x16_bf16 v[48:63], a[196:199], a[228:231], v[48:63]
    buffer_load_dwordx4 v226, s[8:11], s22 offen offset:1024 lds
    ds_read_b64_tr_b16 a[216:217], v223 offset:4096
    ds_read_b64_tr_b16 a[84:85], v233 offset:28672
    ds_read_b64_tr_b16 a[86:87], v233 offset:29696
    v_fma_f32 v217, v217, v198, v199
    v_mfma_f32_32x32x16_bf16 v[64:79], a[200:203], a[224:227], v[64:79]
    ds_read_b64_tr_b16 a[218:219], v223 offset:5120
    ds_read_b64_tr_b16 a[220:221], v224 offset:4096
    ds_read_b64_tr_b16 a[222:223], v224 offset:5120
    ds_read_b64_tr_b16 a[88:89], v234 offset:28672
    ds_read_b64_tr_b16 a[90:91], v234 offset:29696
    v_mfma_f32_32x32x16_bf16 v[80:95], a[200:203], a[228:231], v[80:95]
    buffer_load_dwordx4 v227, s[8:11], s22 offen offset:2048 lds
    ds_read_b64_tr_b16 a[92:93], v235 offset:28672
    ds_read_b64_tr_b16 a[94:95], v235 offset:29696
    v_fma_f32 v218, v218, v198, v199
    v_mfma_f32_32x32x16_bf16 v[96:111], a[204:207], a[224:227], v[96:111]
    v_fma_f32 v219, v219, v198, v199
    v_fma_f32 v216, v216, v240, v236
    v_fma_f32 v217, v217, v241, v237
    v_fma_f32 v218, v218, v242, v238
    v_mfma_f32_32x32x16_bf16 v[112:127], a[204:207], a[228:231], v[112:127]
    s_waitcnt lgkmcnt(0)
    buffer_load_dwordx4 v228, s[8:11], s22 offen offset:3072 lds
    v_fma_f32 v219, v219, v243, v239
    v_cvt_pk_bf16_f32 v142, v216, v217
    v_cvt_pk_bf16_f32 v143, v218, v219
    v_mfma_f32_32x32x16_bf16 v[0:15], a[208:211], a[232:235], v[0:15]
    s_barrier
    s_waitcnt vmcnt(16)
    s_add_u32 m0, s23, 4096
    s_add_u32 s22, s21, 1703936
    s_and_b32 s22, s22, 0x3fffff
    ds_read_b128 a[224:227], v192 offset:16384
    ds_write_b128 v196, v[140:143] offset:24576
    v_lshlrev_b32 v216, 16, v174
    v_mfma_f32_32x32x16_bf16 v[16:31], a[208:211], a[236:239], v[16:31]
    buffer_load_dwordx4 v225, s[8:11], s22 offen offset:0 lds
    ds_read_b64_tr_b16 a[192:193], v221 offset:8192
    ds_read_b64_tr_b16 a[194:195], v221 offset:9216
    v_and_b32 v217, 0xffff0000, v174
    v_lshlrev_b32 v218, 16, v175
    v_mfma_f32_32x32x16_bf16 v[32:47], a[212:215], a[232:235], v[32:47]
    ds_read_b128 a[228:231], v192 offset:17408
    ds_read_b64_tr_b16 a[196:197], v222 offset:8192
    ds_read_b64_tr_b16 a[198:199], v222 offset:9216
    v_and_b32 v219, 0xffff0000, v175
    v_fma_f32 v216, v216, v200, v201
    v_mfma_f32_32x32x16_bf16 v[48:63], a[212:215], a[236:239], v[48:63]
    buffer_load_dwordx4 v226, s[8:11], s22 offen offset:1024 lds
    ds_read_b64_tr_b16 a[200:201], v223 offset:8192
    ds_read_b128 v[208:211], v197 offset:1024
    ds_read_b128 v[212:215], v197 offset:3072
    v_fma_f32 v217, v217, v200, v201
    v_mfma_f32_32x32x16_bf16 v[64:79], a[216:219], a[232:235], v[64:79]
    ds_read_b64_tr_b16 a[202:203], v223 offset:9216
    ds_read_b64_tr_b16 a[204:205], v224 offset:8192
    ds_read_b64_tr_b16 a[206:207], v224 offset:9216
    v_fma_f32 v218, v218, v200, v201
    v_fma_f32 v219, v219, v200, v201
    v_mfma_f32_32x32x16_bf16 v[80:95], a[216:219], a[236:239], v[80:95]
    buffer_load_dwordx4 v227, s[8:11], s22 offen offset:2048 lds
    v_fma_f32 v216, v216, v240, v236
    v_fma_f32 v217, v217, v241, v237
    v_fma_f32 v218, v218, v242, v238
    v_mfma_f32_32x32x16_bf16 v[96:111], a[220:223], a[232:235], v[96:111]
    s_cmp_lg_u32 s20, 0
    s_cbranch_scc1 KFA_PUB
    v_mov_b32 v245, 0
    v_mov_b32 v246, s4
    v_mov_b32 v247, s5
    s_mov_b64 exec, 1
    buffer_store_dwordx2 v[246:247], v245, s[12:15], s42 offen sc1
    s_mov_b64 exec, -1
KFA_PUB:
    v_mfma_f32_32x32x16_bf16 v[112:127], a[220:223], a[236:239], v[112:127]
    s_waitcnt lgkmcnt(0)
    buffer_load_dwordx4 v228, s[8:11], s22 offen offset:3072 lds
    v_fma_f32 v219, v219, v243, v239
    v_cvt_pk_bf16_f32 v174, v216, v217
    v_cvt_pk_bf16_f32 v175, v218, v219
    v_mfma_f32_32x32x16_bf16 v[0:15], a[192:195], a[224:227], v[0:15]
    s_waitcnt vmcnt(16)
    s_add_u32 m0, s23, 8192
    s_add_u32 s22, s21, 1966080
    s_and_b32 s22, s22, 0x3fffff
    ds_read_b128 a[232:235], v193 offset:18432
    ds_write_b128 v196, v[172:175] offset:24704
    v_lshlrev_b32 v216, 16, v144
    v_mfma_f32_32x32x16_bf16 v[16:31], a[192:195], a[228:231], v[16:31]
    buffer_load_dwordx4 v225, s[8:11], s22 offen offset:0 lds
    ds_read_b64_tr_b16 a[208:209], v221 offset:12288
    ds_read_b64_tr_b16 a[210:211], v221 offset:13312
    v_mfma_f32_32x32x16_bf16 v[32:47], a[196:199], a[224:227], v[32:47]
    ds_read_b128 a[236:239], v193 offset:19456
    ds_read_b64_tr_b16 a[212:213], v222 offset:12288
    ds_read_b64_tr_b16 a[214:215], v222 offset:13312
    v_and_b32 v217, 0xffff0000, v144
    v_lshlrev_b32 v218, 16, v145
    v_mfma_f32_32x32x16_bf16 v[48:63], a[196:199], a[228:231], v[48:63]
    buffer_load_dwordx4 v226, s[8:11], s22 offen offset:1024 lds
    ds_read_b64_tr_b16 a[216:217], v223 offset:12288
    v_and_b32 v219, 0xffff0000, v145
    v_mfma_f32_32x32x16_bf16 v[64:79], a[200:203], a[224:227], v[64:79]
    ds_read_b64_tr_b16 a[218:219], v223 offset:13312
    ds_read_b64_tr_b16 a[220:221], v224 offset:12288
    ds_read_b64_tr_b16 a[222:223], v224 offset:13312
    v_fma_f32 v216, v216, v198, v199
    v_fma_f32 v217, v217, v198, v199
    v_mfma_f32_32x32x16_bf16 v[80:95], a[200:203], a[228:231], v[80:95]
    buffer_load_dwordx4 v227, s[8:11], s22 offen offset:2048 lds
    v_fma_f32 v218, v218, v198, v199
    v_fma_f32 v219, v219, v198, v199
    v_mfma_f32_32x32x16_bf16 v[96:111], a[204:207], a[224:227], v[96:111]
    v_fma_f32 v216, v216, v212, v208
    v_fma_f32 v217, v217, v213, v209
    v_fma_f32 v218, v218, v214, v210
    v_fma_f32 v219, v219, v215, v211
    v_mfma_f32_32x32x16_bf16 v[112:127], a[204:207], a[228:231], v[112:127]
    s_waitcnt lgkmcnt(0)
    buffer_load_dwordx4 v228, s[8:11], s22 offen offset:3072 lds
    v_cvt_pk_bf16_f32 v144, v216, v217
    v_cvt_pk_bf16_f32 v145, v218, v219
    v_mfma_f32_32x32x16_bf16 v[0:15], a[208:211], a[232:235], v[0:15]
    s_waitcnt vmcnt(16)
    s_add_u32 m0, s23, 12288
    s_add_u32 s22, s21, 2097152
    s_and_b32 s22, s22, 0x3fffff
    ds_read_b128 a[224:227], v194 offset:20480
    v_lshlrev_b32 v216, 16, v176
    v_and_b32 v217, 0xffff0000, v176
    v_lshlrev_b32 v218, 16, v177
    v_mfma_f32_32x32x16_bf16 v[16:31], a[208:211], a[236:239], v[16:31]
    buffer_load_dwordx4 v225, s[8:11], s22 offen offset:0 lds
    ds_read_b64_tr_b16 a[192:193], v128 offset:0
    ds_read_b64_tr_b16 a[194:195], v128 offset:1024
    v_and_b32 v219, 0xffff0000, v177
    v_mfma_f32_32x32x16_bf16 v[32:47], a[212:215], a[232:235], v[32:47]
    ds_read_b128 a[228:231], v194 offset:21504
    ds_read_b64_tr_b16 a[196:197], v129 offset:0
    ds_read_b64_tr_b16 a[198:199], v129 offset:1024
    v_fma_f32 v216, v216, v200, v201
    v_mfma_f32_32x32x16_bf16 v[48:63], a[212:215], a[236:239], v[48:63]
    buffer_load_dwordx4 v226, s[8:11], s22 offen offset:1024 lds
    ds_read_b64_tr_b16 a[200:201], v130 offset:0
    ds_read_b128 v[236:239], v197 offset:1040
    ds_read_b128 v[240:243], v197 offset:3088
    v_mfma_f32_32x32x16_bf16 v[64:79], a[216:219], a[232:235], v[64:79]
    ds_read_b64_tr_b16 a[202:203], v130 offset:1024
    ds_read_b64_tr_b16 a[204:205], v131 offset:0
    ds_read_b64_tr_b16 a[206:207], v131 offset:1024
    v_fma_f32 v217, v217, v200, v201
    v_mfma_f32_32x32x16_bf16 v[80:95], a[216:219], a[236:239], v[80:95]
    buffer_load_dwordx4 v227, s[8:11], s22 offen offset:2048 lds
    v_fma_f32 v218, v218, v200, v201
    v_fma_f32 v219, v219, v200, v201
    v_mfma_f32_32x32x16_bf16 v[96:111], a[220:223], a[232:235], v[96:111]
    v_fma_f32 v216, v216, v212, v208
    v_fma_f32 v217, v217, v213, v209
    v_fma_f32 v218, v218, v214, v210
    v_fma_f32 v219, v219, v215, v211
    v_mfma_f32_32x32x16_bf16 v[112:127], a[220:223], a[236:239], v[112:127]
    s_waitcnt lgkmcnt(0)
    buffer_load_dwordx4 v228, s[8:11], s22 offen offset:3072 lds
    v_cvt_pk_bf16_f32 v176, v216, v217
    v_cvt_pk_bf16_f32 v177, v218, v219
    v_mfma_f32_32x32x16_bf16 v[0:15], a[192:195], a[224:227], v[0:15]
    s_waitcnt vmcnt(16)
    s_add_u32 m0, s29, 65536
    s_add_u32 s22, s21, 2228224
    s_and_b32 s22, s22, 0x3fffff
    ds_read_b128 a[232:235], v195 offset:22528
    v_lshlrev_b32 v216, 16, v146
    v_and_b32 v217, 0xffff0000, v146
    v_lshlrev_b32 v218, 16, v147
    v_mfma_f32_32x32x16_bf16 v[16:31], a[192:195], a[228:231], v[16:31]
    buffer_load_dwordx4 v225, s[8:11], s22 offen offset:0 lds
    ds_read_b64_tr_b16 a[208:209], v128 offset:4096
    ds_read_b64_tr_b16 a[210:211], v128 offset:5120
    v_mfma_f32_32x32x16_bf16 v[32:47], a[196:199], a[224:227], v[32:47]
    ds_read_b128 a[236:239], v195 offset:23552
    ds_read_b64_tr_b16 a[212:213], v129 offset:4096
    ds_read_b64_tr_b16 a[214:215], v129 offset:5120
    v_and_b32 v219, 0xffff0000, v147
    v_mfma_f32_32x32x16_bf16 v[48:63], a[196:199], a[228:231], v[48:63]
    buffer_load_dwordx4 v226, s[8:11], s22 offen offset:1024 lds
    ds_read_b64_tr_b16 a[216:217], v130 offset:4096
    v_fma_f32 v216, v216, v198, v199
    v_fma_f32 v217, v217, v198, v199
    v_mfma_f32_32x32x16_bf16 v[64:79], a[200:203], a[224:227], v[64:79]
    ds_read_b64_tr_b16 a[218:219], v130 offset:5120
    ds_read_b64_tr_b16 a[220:221], v131 offset:4096
    ds_read_b64_tr_b16 a[222:223], v131 offset:5120
    v_fma_f32 v218, v218, v198, v199
    v_mfma_f32_32x32x16_bf16 v[80:95], a[200:203], a[228:231], v[80:95]
    buffer_load_dwordx4 v227, s[8:11], s22 offen offset:2048 lds
    v_fma_f32 v219, v219, v198, v199
    v_fma_f32 v216, v216, v240, v236
    v_mfma_f32_32x32x16_bf16 v[96:111], a[204:207], a[224:227], v[96:111]
    v_fma_f32 v217, v217, v241, v237
    v_fma_f32 v218, v218, v242, v238
    v_fma_f32 v219, v219, v243, v239
    v_mfma_f32_32x32x16_bf16 v[112:127], a[204:207], a[228:231], v[112:127]
    s_waitcnt lgkmcnt(0)
    buffer_load_dwordx4 v228, s[8:11], s22 offen offset:3072 lds
    v_cvt_pk_bf16_f32 v146, v216, v217
    v_cvt_pk_bf16_f32 v147, v218, v219
    v_mfma_f32_32x32x16_bf16 v[0:15], a[208:211], a[232:235], v[0:15]
    s_barrier
    s_waitcnt vmcnt(16)
    s_add_u32 m0, s29, 69632
    s_add_u32 s22, s21, 2359296
    s_and_b32 s22, s22, 0x3fffff
    ds_read_b128 a[224:227], v192 offset:24576
    ds_write_b128 v196, v[144:147] offset:32768
    v_lshlrev_b32 v216, 16, v178
    v_mfma_f32_32x32x16_bf16 v[16:31], a[208:211], a[236:239], v[16:31]
    buffer_load_dwordx4 v225, s[8:11], s22 offen offset:0 lds
    ds_read_b64_tr_b16 a[192:193], v221 offset:0
    ds_read_b64_tr_b16 a[194:195], v221 offset:1024
    v_and_b32 v217, 0xffff0000, v178
    v_mfma_f32_32x32x16_bf16 v[32:47], a[212:215], a[232:235], v[32:47]
    ds_read_b128 a[228:231], v192 offset:25600
    ds_read_b64_tr_b16 a[196:197], v222 offset:0
    ds_read_b64_tr_b16 a[198:199], v222 offset:1024
    v_lshlrev_b32 v218, 16, v179
    v_mfma_f32_32x32x16_bf16 v[48:63], a[212:215], a[236:239], v[48:63]
    buffer_load_dwordx4 v226, s[8:11], s22 offen offset:1024 lds
    ds_read_b64_tr_b16 a[200:201], v223 offset:0
    ds_read_b128 v[208:211], v197 offset:1280
    ds_read_b128 v[212:215], v197 offset:3328
    v_and_b32 v219, 0xffff0000, v179
    v_mfma_f32_32x32x16_bf16 v[64:79], a[216:219], a[232:235], v[64:79]
    ds_read_b64_tr_b16 a[202:203], v223 offset:1024
    ds_read_b64_tr_b16 a[204:205], v224 offset:0
    ds_read_b64_tr_b16 a[206:207], v224 offset:1024
    v_fma_f32 v216, v216, v200, v201
    v_mfma_f32_32x32x16_bf16 v[80:95], a[216:219], a[236:239], v[80:95]
    buffer_load_dwordx4 v227, s[8:11], s22 offen offset:2048 lds
    v_fma_f32 v217, v217, v200, v201
    v_fma_f32 v218, v218, v200, v201
    v_fma_f32 v219, v219, v200, v201
    v_mfma_f32_32x32x16_bf16 v[96:111], a[220:223], a[232:235], v[96:111]
    v_fma_f32 v216, v216, v240, v236
    v_fma_f32 v217, v217, v241, v237
    v_fma_f32 v218, v218, v242, v238
    v_mfma_f32_32x32x16_bf16 v[112:127], a[220:223], a[236:239], v[112:127]
    s_waitcnt lgkmcnt(0)
    buffer_load_dwordx4 v228, s[8:11], s22 offen offset:3072 lds
    v_fma_f32 v219, v219, v243, v239
    v_cvt_pk_bf16_f32 v178, v216, v217
    v_cvt_pk_bf16_f32 v179, v218, v219
    v_mfma_f32_32x32x16_bf16 v[0:15], a[192:195], a[224:227], v[0:15]
    s_waitcnt vmcnt(16)
    s_add_u32 m0, s23, 0
    s_add_u32 s22, s21, 2490368
    s_and_b32 s22, s22, 0x3fffff
    ds_read_b128 a[232:235], v193 offset:26624
    ds_write_b128 v196, v[176:179] offset:32896
    v_lshlrev_b32 v216, 16, v148
    v_mfma_f32_32x32x16_bf16 v[16:31], a[192:195], a[228:231], v[16:31]
    buffer_load_dwordx4 v225, s[8:11], s22 offen offset:0 lds
    ds_read_b64_tr_b16 a[208:209], v221 offset:4096
    ds_read_b64_tr_b16 a[210:211], v221 offset:5120
    v_mfma_f32_32x32x16_bf16 v[32:47], a[196:199], a[224:227], v[32:47]
    ds_read_b128 a[236:239], v193 offset:27648
    ds_read_b64_tr_b16 a[212:213], v222 offset:4096
    ds_read_b64_tr_b16 a[214:215], v222 offset:5120
    v_and_b32 v217, 0xffff0000, v148
    v_lshlrev_b32 v218, 16, v149
    v_mfma_f32_32x32x16_bf16 v[48:63], a[196:199], a[228:231], v[48:63]
    buffer_load_dwordx4 v226, s[8:11], s22 offen offset:1024 lds
    ds_read_b64_tr_b16 a[216:217], v223 offset:4096
    v_and_b32 v219, 0xffff0000, v149
    v_mfma_f32_32x32x16_bf16 v[64:79], a[200:203], a[224:227], v[64:79]
    ds_read_b64_tr_b16 a[218:219], v223 offset:5120
    ds_read_b64_tr_b16 a[220:221], v224 offset:4096
    ds_read_b64_tr_b16 a[222:223], v224 offset:5120
    v_fma_f32 v216, v216, v198, v199
    v_fma_f32 v217, v217, v198, v199
    v_mfma_f32_32x32x16_bf16 v[80:95], a[200:203], a[228:231], v[80:95]
    buffer_load_dwordx4 v227, s[8:11], s22 offen offset:2048 lds
    v_fma_f32 v218, v218, v198, v199
    v_fma_f32 v219, v219, v198, v199
    v_mfma_f32_32x32x16_bf16 v[96:111], a[204:207], a[224:227], v[96:111]
    v_fma_f32 v216, v216, v212, v208
    v_fma_f32 v217, v217, v213, v209
    v_fma_f32 v218, v218, v214, v210
    v_fma_f32 v219, v219, v215, v211
    v_mfma_f32_32x32x16_bf16 v[112:127], a[204:207], a[228:231], v[112:127]
    s_waitcnt lgkmcnt(0)
    buffer_load_dwordx4 v228, s[8:11], s22 offen offset:3072 lds
    v_cvt_pk_bf16_f32 v148, v216, v217
    v_cvt_pk_bf16_f32 v149, v218, v219
    v_mfma_f32_32x32x16_bf16 v[0:15], a[208:211], a[232:235], v[0:15]
    ds_read_b128 a[224:227], v194 offset:28672
    s_add_u32 m0, s23, 4096
    s_add_u32 s22, s21, 2621440
    s_and_b32 s22, s22, 0x3fffff
    ds_read_b128 a[228:231], v194 offset:29696
    v_lshlrev_b32 v216, 16, v180
    v_mfma_f32_32x32x16_bf16 v[16:31], a[208:211], a[236:239], v[16:31]
    buffer_load_dwordx4 v225, s[8:11], s22 offen offset:0 lds
    v_and_b32 v217, 0xffff0000, v180
    v_lshlrev_b32 v218, 16, v181
    v_mfma_f32_32x32x16_bf16 v[32:47], a[212:215], a[232:235], v[32:47]
    v_and_b32 v219, 0xffff0000, v181
    v_fma_f32 v216, v216, v200, v201
    v_fma_f32 v217, v217, v200, v201
    v_mfma_f32_32x32x16_bf16 v[48:63], a[212:215], a[236:239], v[48:63]
    buffer_load_dwordx4 v226, s[8:11], s22 offen offset:1024 lds
    ds_read_b128 v[236:239], v197 offset:1296
    ds_read_b128 v[240:243], v197 offset:3344
    v_mfma_f32_32x32x16_bf16 v[64:79], a[216:219], a[232:235], v[64:79]
    v_fma_f32 v218, v218, v200, v201
    v_fma_f32 v219, v219, v200, v201
    v_mfma_f32_32x32x16_bf16 v[80:95], a[216:219], a[236:239], v[80:95]
    buffer_load_dwordx4 v227, s[8:11], s22 offen offset:2048 lds
    v_fma_f32 v216, v216, v212, v208
    v_fma_f32 v217, v217, v213, v209
    v_mfma_f32_32x32x16_bf16 v[96:111], a[220:223], a[232:235], v[96:111]
    v_fma_f32 v218, v218, v214, v210
    v_fma_f32 v219, v219, v215, v211
    v_cvt_pk_bf16_f32 v180, v216, v217
    v_mfma_f32_32x32x16_bf16 v[112:127], a[220:223], a[236:239], v[112:127]
    s_waitcnt lgkmcnt(0)
    buffer_load_dwordx4 v228, s[8:11], s22 offen offset:3072 lds
    v_cvt_pk_bf16_f32 v181, v218, v219
    v_mfma_f32_32x32x16_bf16 v[0:15], a[64:67], a[224:227], v[0:15]
    s_waitcnt vmcnt(20)
    ds_read_b128 a[232:235], v195 offset:30720
    v_lshlrev_b32 v216, 16, v150
    v_and_b32 v217, 0xffff0000, v150
    v_lshlrev_b32 v218, 16, v151
    v_mfma_f32_32x32x16_bf16 v[16:31], a[64:67], a[228:231], v[16:31]
    ds_read_b64_tr_b16 a[192:193], v221 offset:8192
    ds_read_b64_tr_b16 a[194:195], v221 offset:9216
    v_and_b32 v219, 0xffff0000, v151
    v_mfma_f32_32x32x16_bf16 v[32:47], a[68:71], a[224:227], v[32:47]
    ds_read_b128 a[236:239], v195 offset:31744
    ds_read_b64_tr_b16 a[196:197], v222 offset:8192
    ds_read_b64_tr_b16 a[198:199], v222 offset:9216
    v_fma_f32 v216, v216, v198, v199
    v_mfma_f32_32x32x16_bf16 v[48:63], a[68:71], a[228:231], v[48:63]
    ds_read_b64_tr_b16 a[200:201], v223 offset:8192
    v_fma_f32 v217, v217, v198, v199
    v_fma_f32 v218, v218, v198, v199
    v_mfma_f32_32x32x16_bf16 v[64:79], a[72:75], a[224:227], v[64:79]
    ds_read_b64_tr_b16 a[202:203], v223 offset:9216
    ds_read_b64_tr_b16 a[204:205], v224 offset:8192
    ds_read_b64_tr_b16 a[206:207], v224 offset:9216
    v_mfma_f32_32x32x16_bf16 v[80:95], a[72:75], a[228:231], v[80:95]
    buffer_load_dwordx4 v[204:207], v220, s[12:15], s35 offen sc1
    v_fma_f32 v219, v219, v198, v199
    v_fma_f32 v216, v216, v240, v236
    v_mfma_f32_32x32x16_bf16 v[96:111], a[76:79], a[224:227], v[96:111]
    buffer_load_dwordx2 v[202:203], v244, s[12:15], s34 offen sc1
    v_fma_f32 v217, v217, v241, v237
    v_fma_f32 v218, v218, v242, v238
    v_mfma_f32_32x32x16_bf16 v[112:127], a[76:79], a[228:231], v[112:127]
    s_waitcnt lgkmcnt(0)
    v_fma_f32 v219, v219, v243, v239
    v_cvt_pk_bf16_f32 v150, v216, v217
    v_cvt_pk_bf16_f32 v151, v218, v219
    v_mfma_f32_32x32x16_bf16 v[0:15], a[192:195], a[232:235], v[0:15]
    s_barrier
    s_waitcnt vmcnt(18)
    s_add_u32 m0, s23, 8192
    s_add_u32 s22, s21, 2752512
    s_and_b32 s22, s22, 0x3fffff
    ds_read_b128 a[224:227], v192 offset:32768
    ds_write_b128 v196, v[148:151] offset:40960
    v_lshlrev_b32 v216, 16, v182
    v_mfma_f32_32x32x16_bf16 v[16:31], a[192:195], a[236:239], v[16:31]
    buffer_load_dwordx4 v225, s[8:11], s22 offen offset:0 lds
    ds_read_b64_tr_b16 a[208:209], v221 offset:12288
    ds_read_b64_tr_b16 a[210:211], v221 offset:13312
    v_and_b32 v217, 0xffff0000, v182
    v_mfma_f32_32x32x16_bf16 v[32:47], a[196:199], a[232:235], v[32:47]
    ds_read_b128 a[228:231], v192 offset:33792
    ds_read_b64_tr_b16 a[212:213], v222 offset:12288
    ds_read_b64_tr_b16 a[214:215], v222 offset:13312
    v_lshlrev_b32 v218, 16, v183
    v_mfma_f32_32x32x16_bf16 v[48:63], a[196:199], a[236:239], v[48:63]
    buffer_load_dwordx4 v226, s[8:11], s22 offen offset:1024 lds
    ds_read_b64_tr_b16 a[216:217], v223 offset:12288
    ds_read_b128 v[208:211], v197 offset:1536
    ds_read_b128 v[212:215], v197 offset:3584
    v_and_b32 v219, 0xffff0000, v183
    v_mfma_f32_32x32x16_bf16 v[64:79], a[200:203], a[232:235], v[64:79]
    ds_read_b64_tr_b16 a[218:219], v223 offset:13312
    ds_read_b64_tr_b16 a[220:221], v224 offset:12288
    ds_read_b64_tr_b16 a[222:223], v224 offset:13312
    v_fma_f32 v216, v216, v200, v201
    v_mfma_f32_32x32x16_bf16 v[80:95], a[200:203], a[236:239], v[80:95]
    buffer_load_dwordx4 v227, s[8:11], s22 offen offset:2048 lds
    v_fma_f32 v217, v217, v200, v201
    v_fma_f32 v218, v218, v200, v201
    v_fma_f32 v219, v219, v200, v201
    v_mfma_f32_32x32x16_bf16 v[96:111], a[204:207], a[232:235], v[96:111]
    v_fma_f32 v216, v216, v240, v236
    v_fma_f32 v217, v217, v241, v237
    v_fma_f32 v218, v218, v242, v238
    v_mfma_f32_32x32x16_bf16 v[112:127], a[204:207], a[236:239], v[112:127]
    s_waitcnt lgkmcnt(0)
    buffer_load_dwordx4 v228, s[8:11], s22 offen offset:3072 lds
    v_fma_f32 v219, v219, v243, v239
    v_cvt_pk_bf16_f32 v182, v216, v217
    v_cvt_pk_bf16_f32 v183, v218, v219
    v_mfma_f32_32x32x16_bf16 v[0:15], a[208:211], a[224:227], v[0:15]
    s_waitcnt vmcnt(18)
    s_add_u32 m0, s23, 12288
    s_add_u32 s22, s21, 2883584
    s_and_b32 s22, s22, 0x3fffff
    ds_read_b128 a[232:235], v193 offset:34816
    ds_write_b128 v196, v[180:183] offset:41088
    v_lshlrev_b32 v216, 16, v152
    v_mfma_f32_32x32x16_bf16 v[16:31], a[208:211], a[228:231], v[16:31]
    buffer_load_dwordx4 v225, s[8:11], s22 offen offset:0 lds
    ds_read_b64_tr_b16 a[192:193], v128 offset:0
    ds_read_b64_tr_b16 a[194:195], v128 offset:1024
    v_mfma_f32_32x32x16_bf16 v[32:47], a[212:215], a[224:227], v[32:47]
    ds_read_b128 a[236:239], v193 offset:35840
    ds_read_b64_tr_b16 a[196:197], v129 offset:0
    ds_read_b64_tr_b16 a[198:199], v129 offset:1024
    v_and_b32 v217, 0xffff0000, v152
    v_lshlrev_b32 v218, 16, v153
    v_mfma_f32_32x32x16_bf16 v[48:63], a[212:215], a[228:231], v[48:63]
    buffer_load_dwordx4 v226, s[8:11], s22 offen offset:1024 lds
    ds_read_b64_tr_b16 a[200:201], v130 offset:0
    v_and_b32 v219, 0xffff0000, v153
    v_mfma_f32_32x32x16_bf16 v[64:79], a[216:219], a[224:227], v[64:79]
    ds_read_b64_tr_b16 a[202:203], v130 offset:1024
    ds_read_b64_tr_b16 a[204:205], v131 offset:0
    ds_read_b64_tr_b16 a[206:207], v131 offset:1024
    v_fma_f32 v216, v216, v198, v199
    v_fma_f32 v217, v217, v198, v199
    v_mfma_f32_32x32x16_bf16 v[80:95], a[216:219], a[228:231], v[80:95]
    buffer_load_dwordx4 v227, s[8:11], s22 offen offset:2048 lds
    v_fma_f32 v218, v218, v198, v199
    v_fma_f32 v219, v219, v198, v199
    v_mfma_f32_32x32x16_bf16 v[96:111], a[220:223], a[224:227], v[96:111]
    v_fma_f32 v216, v216, v212, v208
    v_fma_f32 v217, v217, v213, v209
    v_fma_f32 v218, v218, v214, v210
    v_fma_f32 v219, v219, v215, v211
    v_mfma_f32_32x32x16_bf16 v[112:127], a[220:223], a[228:231], v[112:127]
    s_waitcnt lgkmcnt(0)
    buffer_load_dwordx4 v228, s[8:11], s22 offen offset:3072 lds
    v_cvt_pk_bf16_f32 v152, v216, v217
    v_cvt_pk_bf16_f32 v153, v218, v219
    v_mfma_f32_32x32x16_bf16 v[0:15], a[192:195], a[232:235], v[0:15]
    s_waitcnt vmcnt(18)
    s_add_u32 m0, s29, 65536
    s_add_u32 s22, s21, 3014656
    s_and_b32 s22, s22, 0x3fffff
    ds_read_b128 a[224:227], v194 offset:36864
    v_lshlrev_b32 v216, 16, v184
    v_and_b32 v217, 0xffff0000, v184
    v_lshlrev_b32 v218, 16, v185
    v_mfma_f32_32x32x16_bf16 v[16:31], a[192:195], a[236:239], v[16:31]
    buffer_load_dwordx4 v225, s[8:11], s22 offen offset:0 lds
    ds_read_b64_tr_b16 a[208:209], v128 offset:4096
    ds_read_b64_tr_b16 a[210:211], v128 offset:5120
    v_and_b32 v219, 0xffff0000, v185
    v_mfma_f32_32x32x16_bf16 v[32:47], a[196:199], a[232:235], v[32:47]
    ds_read_b128 a[228:231], v194 offset:37888
    ds_read_b64_tr_b16 a[212:213], v129 offset:4096
    ds_read_b64_tr_b16 a[214:215], v129 offset:5120
    v_fma_f32 v216, v216, v200, v201
    v_mfma_f32_32x32x16_bf16 v[48:63], a[196:199], a[236:239], v[48:63]
    buffer_load_dwordx4 v226, s[8:11], s22 offen offset:1024 lds
    ds_read_b64_tr_b16 a[216:217], v130 offset:4096
    ds_read_b128 v[236:239], v197 offset:1552
    ds_read_b128 v[240:243], v197 offset:3600
    v_mfma_f32_32x32x16_bf16 v[64:79], a[200:203], a[232:235], v[64:79]
    ds_read_b64_tr_b16 a[218:219], v130 offset:5120
    ds_read_b64_tr_b16 a[220:221], v131 offset:4096
    ds_read_b64_tr_b16 a[222:223], v131 offset:5120
    v_fma_f32 v217, v217, v200, v201
    v_mfma_f32_32x32x16_bf16 v[80:95], a[200:203], a[236:239], v[80:95]
    buffer_load_dwordx4 v227, s[8:11], s22 offen offset:2048 lds
    v_fma_f32 v218, v218, v200, v201
    v_fma_f32 v219, v219, v200, v201
    v_mfma_f32_32x32x16_bf16 v[96:111], a[204:207], a[232:235], v[96:111]
    v_fma_f32 v216, v216, v212, v208
    v_fma_f32 v217, v217, v213, v209
    v_fma_f32 v218, v218, v214, v210
    v_fma_f32 v219, v219, v215, v211
    v_mfma_f32_32x32x16_bf16 v[112:127], a[204:207], a[236:239], v[112:127]
    s_waitcnt lgkmcnt(0)
    buffer_load_dwordx4 v228, s[8:11], s22 offen offset:3072 lds
    v_cvt_pk_bf16_f32 v184, v216, v217
    v_cvt_pk_bf16_f32 v185, v218, v219
    v_mfma_f32_32x32x16_bf16 v[0:15], a[208:211], a[224:227], v[0:15]
    s_waitcnt vmcnt(18)
    s_add_u32 m0, s29, 69632
    s_add_u32 s22, s21, 3276800
    s_and_b32 s22, s22, 0x3fffff
    ds_read_b128 a[232:235], v195 offset:38912
    v_lshlrev_b32 v216, 16, v154
    v_and_b32 v217, 0xffff0000, v154
    v_lshlrev_b32 v218, 16, v155
    v_mfma_f32_32x32x16_bf16 v[16:31], a[208:211], a[228:231], v[16:31]
    buffer_load_dwordx4 v225, s[8:11], s22 offen offset:0 lds
    ds_read_b64_tr_b16 a[192:193], v221 offset:0
    ds_read_b64_tr_b16 a[194:195], v221 offset:1024
    v_mfma_f32_32x32x16_bf16 v[32:47], a[212:215], a[224:227], v[32:47]
    ds_read_b128 a[236:239], v195 offset:39936
    ds_read_b64_tr_b16 a[196:197], v222 offset:0
    ds_read_b64_tr_b16 a[198:199], v222 offset:1024
    v_and_b32 v219, 0xffff0000, v155
    v_mfma_f32_32x32x16_bf16 v[48:63], a[212:215], a[228:231], v[48:63]
    buffer_load_dwordx4 v226, s[8:11], s22 offen offset:1024 lds
    ds_read_b64_tr_b16 a[200:201], v223 offset:0
    v_fma_f32 v216, v216, v198, v199
    v_fma_f32 v217, v217, v198, v199
    v_mfma_f32_32x32x16_bf16 v[64:79], a[216:219], a[224:227], v[64:79]
    ds_read_b64_tr_b16 a[202:203], v223 offset:1024
    ds_read_b64_tr_b16 a[204:205], v224 offset:0
    ds_read_b64_tr_b16 a[206:207], v224 offset:1024
    v_fma_f32 v218, v218, v198, v199
    v_mfma_f32_32x32x16_bf16 v[80:95], a[216:219], a[228:231], v[80:95]
    buffer_load_dwordx4 v227, s[8:11], s22 offen offset:2048 lds
    v_fma_f32 v219, v219, v198, v199
    v_fma_f32 v216, v216, v240, v236
    v_mfma_f32_32x32x16_bf16 v[96:111], a[220:223], a[224:227], v[96:111]
    v_fma_f32 v217, v217, v241, v237
    v_fma_f32 v218, v218, v242, v238
    v_fma_f32 v219, v219, v243, v239
    v_mfma_f32_32x32x16_bf16 v[112:127], a[220:223], a[228:231], v[112:127]
    s_waitcnt lgkmcnt(0)
    buffer_load_dwordx4 v228, s[8:11], s22 offen offset:3072 lds
    v_cvt_pk_bf16_f32 v154, v216, v217
    v_cvt_pk_bf16_f32 v155, v218, v219
    v_mfma_f32_32x32x16_bf16 v[0:15], a[192:195], a[232:235], v[0:15]
    s_barrier
    s_waitcnt vmcnt(18)
    s_add_u32 m0, s23, 0
    s_add_u32 s22, s21, 3407872
    s_and_b32 s22, s22, 0x3fffff
    ds_read_b128 a[224:227], v192 offset:40960
    ds_write_b128 v196, v[152:155] offset:49152
    v_lshlrev_b32 v216, 16, v186
    v_mfma_f32_32x32x16_bf16 v[16:31], a[192:195], a[236:239], v[16:31]
    buffer_load_dwordx4 v225, s[8:11], s22 offen offset:0 lds
    ds_read_b64_tr_b16 a[208:209], v221 offset:4096
    ds_read_b64_tr_b16 a[210:211], v221 offset:5120
    v_and_b32 v217, 0xffff0000, v186
    v_mfma_f32_32x32x16_bf16 v[32:47], a[196:199], a[232:235], v[32:47]
    ds_read_b128 a[228:231], v192 offset:41984
    ds_read_b64_tr_b16 a[212:213], v222 offset:4096
    ds_read_b64_tr_b16 a[214:215], v222 offset:5120
    v_lshlrev_b32 v218, 16, v187
    v_mfma_f32_32x32x16_bf16 v[48:63], a[196:199], a[236:239], v[48:63]
    buffer_load_dwordx4 v226, s[8:11], s22 offen offset:1024 lds
    ds_read_b64_tr_b16 a[216:217], v223 offset:4096
    ds_read_b128 v[208:211], v197 offset:1792
    ds_read_b128 v[212:215], v197 offset:3840
    v_and_b32 v219, 0xffff0000, v187
    v_mfma_f32_32x32x16_bf16 v[64:79], a[200:203], a[232:235], v[64:79]
    ds_read_b64_tr_b16 a[218:219], v223 offset:5120
    ds_read_b64_tr_b16 a[220:221], v224 offset:4096
    ds_read_b64_tr_b16 a[222:223], v224 offset:5120
    v_fma_f32 v216, v216, v200, v201
    v_mfma_f32_32x32x16_bf16 v[80:95], a[200:203], a[236:239], v[80:95]
    buffer_load_dwordx4 v227, s[8:11], s22 offen offset:2048 lds
    v_fma_f32 v217, v217, v200, v201
    v_fma_f32 v218, v218, v200, v201
    v_fma_f32 v219, v219, v200, v201
    v_mfma_f32_32x32x16_bf16 v[96:111], a[204:207], a[232:235], v[96:111]
    v_fma_f32 v216, v216, v240, v236
    v_fma_f32 v217, v217, v241, v237
    v_fma_f32 v218, v218, v242, v238
    v_mfma_f32_32x32x16_bf16 v[112:127], a[204:207], a[236:239], v[112:127]
    s_waitcnt lgkmcnt(0)
    buffer_load_dwordx4 v228, s[8:11], s22 offen offset:3072 lds
    v_fma_f32 v219, v219, v243, v239
    v_cvt_pk_bf16_f32 v186, v216, v217
    v_cvt_pk_bf16_f32 v187, v218, v219
    v_mfma_f32_32x32x16_bf16 v[0:15], a[208:211], a[224:227], v[0:15]
    s_waitcnt vmcnt(16)
    s_add_u32 m0, s23, 4096
    s_add_u32 s22, s21, 3538944
    s_and_b32 s22, s22, 0x3fffff
    ds_read_b128 a[232:235], v193 offset:43008
    ds_write_b128 v196, v[184:187] offset:49280
    v_lshlrev_b32 v216, 16, v156
    v_mfma_f32_32x32x16_bf16 v[16:31], a[208:211], a[228:231], v[16:31]
    buffer_load_dwordx4 v225, s[8:11], s22 offen offset:0 lds
    ds_read_b64_tr_b16 a[192:193], v221 offset:8192
    ds_read_b64_tr_b16 a[194:195], v221 offset:9216
    v_mfma_f32_32x32x16_bf16 v[32:47], a[212:215], a[224:227], v[32:47]
    ds_read_b128 a[236:239], v193 offset:44032
    ds_read_b64_tr_b16 a[196:197], v222 offset:8192
    ds_read_b64_tr_b16 a[198:199], v222 offset:9216
    v_and_b32 v217, 0xffff0000, v156
    v_lshlrev_b32 v218, 16, v157
    v_mfma_f32_32x32x16_bf16 v[48:63], a[212:215], a[228:231], v[48:63]
    buffer_load_dwordx4 v226, s[8:11], s22 offen offset:1024 lds
    ds_read_b64_tr_b16 a[200:201], v223 offset:8192
    v_and_b32 v219, 0xffff0000, v157
    v_mfma_f32_32x32x16_bf16 v[64:79], a[216:219], a[224:227], v[64:79]
    ds_read_b64_tr_b16 a[202:203], v223 offset:9216
    ds_read_b64_tr_b16 a[204:205], v224 offset:8192
    ds_read_b64_tr_b16 a[206:207], v224 offset:9216
    v_fma_f32 v216, v216, v198, v199
    v_fma_f32 v217, v217, v198, v199
    v_mfma_f32_32x32x16_bf16 v[80:95], a[216:219], a[228:231], v[80:95]
    buffer_load_dwordx4 v227, s[8:11], s22 offen offset:2048 lds
    v_fma_f32 v218, v218, v198, v199
    v_fma_f32 v219, v219, v198, v199
    v_mfma_f32_32x32x16_bf16 v[96:111], a[220:223], a[224:227], v[96:111]
    v_fma_f32 v216, v216, v212, v208
    v_fma_f32 v217, v217, v213, v209
    v_fma_f32 v218, v218, v214, v210
    v_fma_f32 v219, v219, v215, v211
    v_mfma_f32_32x32x16_bf16 v[112:127], a[220:223], a[228:231], v[112:127]
    s_waitcnt lgkmcnt(0)
    buffer_load_dwordx4 v228, s[8:11], s22 offen offset:3072 lds
    v_cvt_pk_bf16_f32 v156, v216, v217
    v_cvt_pk_bf16_f32 v157, v218, v219
    v_mfma_f32_32x32x16_bf16 v[0:15], a[192:195], a[232:235], v[0:15]
    s_waitcnt vmcnt(16)
    s_add_u32 m0, s23, 8192
    s_add_u32 s22, s21, 3670016
    s_and_b32 s22, s22, 0x3fffff
    ds_read_b128 a[224:227], v194 offset:45056
    v_lshlrev_b32 v216, 16, v188
    v_and_b32 v217, 0xffff0000, v188
    v_lshlrev_b32 v218, 16, v189
    v_mfma_f32_32x32x16_bf16 v[16:31], a[192:195], a[236:239], v[16:31]
    buffer_load_dwordx4 v225, s[8:11], s22 offen offset:0 lds
    ds_read_b64_tr_b16 a[208:209], v221 offset:12288
    ds_read_b64_tr_b16 a[210:211], v221 offset:13312
    v_and_b32 v219, 0xffff0000, v189
    v_mfma_f32_32x32x16_bf16 v[32:47], a[196:199], a[232:235], v[32:47]
    ds_read_b128 a[228:231], v194 offset:46080
    ds_read_b64_tr_b16 a[212:213], v222 offset:12288
    ds_read_b64_tr_b16 a[214:215], v222 offset:13312
    v_fma_f32 v216, v216, v200, v201
    v_mfma_f32_32x32x16_bf16 v[48:63], a[196:199], a[236:239], v[48:63]
    buffer_load_dwordx4 v226, s[8:11], s22 offen offset:1024 lds
    ds_read_b64_tr_b16 a[216:217], v223 offset:12288
    ds_read_b128 v[236:239], v197 offset:1808
    ds_read_b128 v[240:243], v197 offset:3856
    v_mfma_f32_32x32x16_bf16 v[64:79], a[200:203], a[232:235], v[64:79]
    ds_read_b64_tr_b16 a[218:219], v223 offset:13312
    ds_read_b64_tr_b16 a[220:221], v224 offset:12288
    ds_read_b64_tr_b16 a[222:223], v224 offset:13312
    v_fma_f32 v217, v217, v200, v201
    v_mfma_f32_32x32x16_bf16 v[80:95], a[200:203], a[236:239], v[80:95]
    buffer_load_dwordx4 v227, s[8:11], s22 offen offset:2048 lds
    v_fma_f32 v218, v218, v200, v201
    v_fma_f32 v219, v219, v200, v201
    v_mfma_f32_32x32x16_bf16 v[96:111], a[204:207], a[232:235], v[96:111]
    v_fma_f32 v216, v216, v212, v208
    v_fma_f32 v217, v217, v213, v209
    v_fma_f32 v218, v218, v214, v210
    v_fma_f32 v219, v219, v215, v211
    v_mfma_f32_32x32x16_bf16 v[112:127], a[204:207], a[236:239], v[112:127]
    s_waitcnt lgkmcnt(0)
    buffer_load_dwordx4 v228, s[8:11], s22 offen offset:3072 lds
    v_cvt_pk_bf16_f32 v188, v216, v217
    v_cvt_pk_bf16_f32 v189, v218, v219
    v_mfma_f32_32x32x16_bf16 v[0:15], a[208:211], a[224:227], v[0:15]
    s_waitcnt vmcnt(16)
    s_add_u32 m0, s23, 12288
    s_add_u32 s22, s21, 3801088
    s_and_b32 s22, s22, 0x3fffff
    ds_read_b128 a[232:235], v195 offset:47104
    v_lshlrev_b32 v216, 16, v158
    v_and_b32 v217, 0xffff0000, v158
    v_lshlrev_b32 v218, 16, v159
    v_mfma_f32_32x32x16_bf16 v[16:31], a[208:211], a[228:231], v[16:31]
    buffer_load_dwordx4 v225, s[8:11], s22 offen offset:0 lds
    ds_read_b64_tr_b16 a[192:193], v128 offset:0
    ds_read_b64_tr_b16 a[194:195], v128 offset:1024
    v_mfma_f32_32x32x16_bf16 v[32:47], a[212:215], a[224:227], v[32:47]
    ds_read_b128 a[236:239], v195 offset:48128
    ds_read_b64_tr_b16 a[196:197], v129 offset:0
    ds_read_b64_tr_b16 a[198:199], v129 offset:1024
    v_and_b32 v219, 0xffff0000, v159
    v_mfma_f32_32x32x16_bf16 v[48:63], a[212:215], a[228:231], v[48:63]
    buffer_load_dwordx4 v226, s[8:11], s22 offen offset:1024 lds
    ds_read_b64_tr_b16 a[200:201], v130 offset:0
    v_fma_f32 v216, v216, v198, v199
    v_fma_f32 v217, v217, v198, v199
    v_mfma_f32_32x32x16_bf16 v[64:79], a[216:219], a[224:227], v[64:79]
    ds_read_b64_tr_b16 a[202:203], v130 offset:1024
    ds_read_b64_tr_b16 a[204:205], v131 offset:0
    ds_read_b64_tr_b16 a[206:207], v131 offset:1024
    v_fma_f32 v218, v218, v198, v199
    v_mfma_f32_32x32x16_bf16 v[80:95], a[216:219], a[228:231], v[80:95]
    buffer_load_dwordx4 v227, s[8:11], s22 offen offset:2048 lds
    v_fma_f32 v219, v219, v198, v199
    v_fma_f32 v216, v216, v240, v236
    v_mfma_f32_32x32x16_bf16 v[96:111], a[220:223], a[224:227], v[96:111]
    v_fma_f32 v217, v217, v241, v237
    v_fma_f32 v218, v218, v242, v238
    v_fma_f32 v219, v219, v243, v239
    v_mfma_f32_32x32x16_bf16 v[112:127], a[220:223], a[228:231], v[112:127]
    s_waitcnt lgkmcnt(0)
    buffer_load_dwordx4 v228, s[8:11], s22 offen offset:3072 lds
    v_cvt_pk_bf16_f32 v158, v216, v217
    v_cvt_pk_bf16_f32 v159, v218, v219
    v_mfma_f32_32x32x16_bf16 v[0:15], a[192:195], a[232:235], v[0:15]
    s_barrier
    ds_read_b128 a[224:227], v192 offset:49152
    ds_read_b128 a[228:231], v192 offset:50176
    ds_write_b128 v196, v[156:159] offset:57344
    v_mfma_f32_32x32x16_bf16 v[16:31], a[192:195], a[236:239], v[16:31]
    v_lshlrev_b32 v216, 16, v190
    v_mfma_f32_32x32x16_bf16 v[32:47], a[196:199], a[232:235], v[32:47]
    v_and_b32 v217, 0xffff0000, v190
    v_lshlrev_b32 v218, 16, v191
    v_mfma_f32_32x32x16_bf16 v[48:63], a[196:199], a[236:239], v[48:63]
    v_and_b32 v219, 0xffff0000, v191
    v_fma_f32 v216, v216, v200, v201
    v_mfma_f32_32x32x16_bf16 v[64:79], a[200:203], a[232:235], v[64:79]
    v_fma_f32 v217, v217, v200, v201
    v_fma_f32 v218, v218, v200, v201
    v_mfma_f32_32x32x16_bf16 v[80:95], a[200:203], a[236:239], v[80:95]
    v_fma_f32 v219, v219, v200, v201
    v_fma_f32 v216, v216, v240, v236
    v_fma_f32 v217, v217, v241, v237
    v_mfma_f32_32x32x16_bf16 v[96:111], a[204:207], a[232:235], v[96:111]
    v_fma_f32 v218, v218, v242, v238
    v_fma_f32 v219, v219, v243, v239
    v_mfma_f32_32x32x16_bf16 v[112:127], a[204:207], a[236:239], v[112:127]
    s_waitcnt lgkmcnt(0)
    v_cvt_pk_bf16_f32 v190, v216, v217
    v_cvt_pk_bf16_f32 v191, v218, v219
    v_mfma_f32_32x32x16_bf16 v[0:15], a[80:83], a[224:227], v[0:15]
    s_waitcnt vmcnt(16)
    ds_read_b128 a[232:235], v193 offset:51200
    ds_write_b128 v196, v[188:191] offset:57472
    v_mfma_f32_32x32x16_bf16 v[16:31], a[80:83], a[228:231], v[16:31]
    ds_read_b64_tr_b16 a[208:209], v128 offset:4096
    ds_read_b64_tr_b16 a[210:211], v128 offset:5120
    v_mfma_f32_32x32x16_bf16 v[32:47], a[84:87], a[224:227], v[32:47]
    ds_read_b128 a[236:239], v193 offset:52224
    ds_read_b64_tr_b16 a[212:213], v129 offset:4096
    ds_read_b64_tr_b16 a[214:215], v129 offset:5120
    v_mfma_f32_32x32x16_bf16 v[48:63], a[84:87], a[228:231], v[48:63]
    ds_read_b64_tr_b16 a[216:217], v130 offset:4096
    v_mfma_f32_32x32x16_bf16 v[64:79], a[88:91], a[224:227], v[64:79]
    ds_read_b64_tr_b16 a[218:219], v130 offset:5120
    ds_read_b64_tr_b16 a[220:221], v131 offset:4096
    ds_read_b64_tr_b16 a[222:223], v131 offset:5120
    v_cmp_ne_u64 vcc, s[4:5], v[202:203]
    v_cmp_ne_u64 s[44:45], s[4:5], v[204:205]
    v_cmp_ne_u64 s[46:47], s[4:5], v[206:207]
    v_mfma_f32_32x32x16_bf16 v[80:95], a[88:91], a[228:231], v[80:95]
    s_or_b64 s[44:45], s[44:45], s[46:47]
    s_or_b64 s[44:45], s[44:45], vcc
    s_cbranch_scc1 KQ_SLOW
KQ_RET:
    v_mfma_f32_32x32x16_bf16 v[96:111], a[92:95], a[224:227], v[96:111]
    v_mfma_f32_32x32x16_bf16 v[112:127], a[92:95], a[228:231], v[112:127]
    s_waitcnt lgkmcnt(0)
    v_mfma_f32_32x32x16_bf16 v[0:15], a[208:211], a[232:235], v[0:15]
    s_waitcnt vmcnt(12)
    ds_read_b128 a[224:227], v194 offset:53248
    v_mfma_f32_32x32x16_bf16 v[16:31], a[208:211], a[236:239], v[16:31]
    ds_read_b64_tr_b16 a[192:193], v221 offset:0
    ds_read_b64_tr_b16 a[194:195], v221 offset:1024
    v_mfma_f32_32x32x16_bf16 v[32:47], a[212:215], a[232:235], v[32:47]
    ds_read_b128 a[228:231], v194 offset:54272
    ds_read_b64_tr_b16 a[196:197], v222 offset:0
    ds_read_b64_tr_b16 a[198:199], v222 offset:1024
    v_mfma_f32_32x32x16_bf16 v[48:63], a[212:215], a[236:239], v[48:63]
    ds_read_b64_tr_b16 a[200:201], v223 offset:0
    v_mfma_f32_32x32x16_bf16 v[64:79], a[216:219], a[232:235], v[64:79]
    ds_read_b64_tr_b16 a[202:203], v223 offset:1024
    ds_read_b64_tr_b16 a[204:205], v224 offset:0
    ds_read_b64_tr_b16 a[206:207], v224 offset:1024
    v_mfma_f32_32x32x16_bf16 v[80:95], a[216:219], a[236:239], v[80:95]
    v_mfma_f32_32x32x16_bf16 v[96:111], a[220:223], a[232:235], v[96:111]
    v_mfma_f32_32x32x16_bf16 v[112:127], a[220:223], a[236:239], v[112:127]
    s_waitcnt lgkmcnt(0)
    v_mfma_f32_32x32x16_bf16 v[0:15], a[192:195], a[224:227], v[0:15]
    s_waitcnt vmcnt(8)
    s_add_u32 m0, s23, 0
    s_add_u32 s22, s21, 3932160
    s_and_b32 s22, s22, 0x3fffff
    ds_read_b128 a[232:235], v195 offset:55296
    s_lshl_b32 s40, s38, 5
    s_add_u32 s40, s40, s39
    s_lshl_b32 s41, s40, 13
    s_lshl_b32 s46, s20, 11
    v_mfma_f32_32x32x16_bf16 v[16:31], a[192:195], a[228:231], v[16:31]
    buffer_load_dwordx4 v225, s[8:11], s22 offen offset:0 lds
    ds_read_b64_tr_b16 a[208:209], v221 offset:4096
    ds_read_b64_tr_b16 a[210:211], v221 offset:5120
    s_add_u32 s42, s41, s46
    v_mfma_f32_32x32x16_bf16 v[32:47], a[196:199], a[224:227], v[32:47]
    ds_read_b128 a[236:239], v195 offset:56320
    ds_read_b64_tr_b16 a[212:213], v222 offset:4096
    ds_read_b64_tr_b16 a[214:215], v222 offset:5120
    s_add_u32 s42, s42, 0x1000000
    v_bfe_u32 v216, v220, 4, 3
    v_mfma_f32_32x32x16_bf16 v[48:63], a[196:199], a[228:231], v[48:63]
    buffer_load_dwordx4 v226, s[8:11], s22 offen offset:1024 lds
    ds_read_b64_tr_b16 a[216:217], v223 offset:4096
    v_lshrrev_b32 v231, 9, v220
    v_lshlrev_b32 v231, 6, v231
    v_mfma_f32_32x32x16_bf16 v[64:79], a[200:203], a[224:227], v[64:79]
    ds_read_b64_tr_b16 a[218:219], v223 offset:5120
    ds_read_b64_tr_b16 a[220:221], v224 offset:4096
    ds_read_b64_tr_b16 a[222:223], v224 offset:5120
    v_bfe_u32 v229, v220, 7, 2
    v_lshl_add_u32 v231, v229, 3, v231
    v_mfma_f32_32x32x16_bf16 v[80:95], a[200:203], a[228:231], v[80:95]
    buffer_load_dwordx4 v227, s[8:11], s22 offen offset:2048 lds
    v_lshl_add_u32 v229, v216, 10, v231
    v_lshlrev_b32 v231, 1, v231
    s_lshl_b32 s46, s20, 8
    v_mfma_f32_32x32x16_bf16 v[96:111], a[204:207], a[224:227], v[96:111]
    s_add_u32 s43, s41, s46
    s_lshl_b32 s46, s20, 9
    s_add_u32 s32, s46, 4096
    s_add_u32 s33, s46, 8192
    s_mov_b32 s56, s64
    v_mfma_f32_32x32x16_bf16 v[112:127], a[204:207], a[228:231], v[112:127]
    s_waitcnt lgkmcnt(0)
    buffer_load_dwordx4 v228, s[8:11], s22 offen offset:3072 lds
    s_mov_b32 s57, s65
    s_mov_b32 s58, 0x200000
    s_mov_b32 s59, 0x20000
    v_mfma_f32_32x32x16_bf16 v[0:15], a[208:211], a[232:235], v[0:15]
    s_barrier
    s_waitcnt vmcnt(8)
    s_add_u32 m0, s23, 4096
    s_add_u32 s22, s21, 4063232
    s_and_b32 s22, s22, 0x3fffff
    ds_read_b128 a[224:227], v192 offset:57344
    v_mfma_f32_32x32x16_bf16 v[16:31], a[208:211], a[236:239], v[16:31]
    buffer_load_dwordx4 v225, s[8:11], s22 offen offset:0 lds
    ds_read_b64_tr_b16 a[192:193], v221 offset:8192
    ds_read_b64_tr_b16 a[194:195], v221 offset:9216
    v_mfma_f32_32x32x16_bf16 v[32:47], a[212:215], a[232:235], v[32:47]
    ds_read_b128 a[228:231], v192 offset:58368
    ds_read_b64_tr_b16 a[196:197], v222 offset:8192
    ds_read_b64_tr_b16 a[198:199], v222 offset:9216
    v_mfma_f32_32x32x16_bf16 v[48:63], a[212:215], a[236:239], v[48:63]
    buffer_load_dwordx4 v226, s[8:11], s22 offen offset:1024 lds
    ds_read_b64_tr_b16 a[200:201], v223 offset:8192
    v_mfma_f32_32x32x16_bf16 v[64:79], a[216:219], a[232:235], v[64:79]
    ds_read_b64_tr_b16 a[202:203], v223 offset:9216
    ds_read_b64_tr_b16 a[204:205], v224 offset:8192
    ds_read_b64_tr_b16 a[206:207], v224 offset:9216
    v_mfma_f32_32x32x16_bf16 v[80:95], a[216:219], a[236:239], v[80:95]
    buffer_load_dwordx4 v227, s[8:11], s22 offen offset:2048 lds
    v_mfma_f32_32x32x16_bf16 v[96:111], a[220:223], a[232:235], v[96:111]
    v_mfma_f32_32x32x16_bf16 v[112:127], a[220:223], a[236:239], v[112:127]
    s_waitcnt lgkmcnt(0)
    buffer_load_dwordx4 v228, s[8:11], s22 offen offset:3072 lds
    v_mfma_f32_32x32x16_bf16 v[0:15], a[192:195], a[224:227], v[0:15]
    s_waitcnt vmcnt(8)
    ds_read_b128 a[232:235], v193 offset:59392
    s_add_u32 m0, s26, 65536
    v_mfma_f32_32x32x16_bf16 v[16:31], a[192:195], a[228:231], v[16:31]
    buffer_load_dwordx4 v220, s[12:15], s27 offen offset:0 sc1 lds
    ds_read_b64_tr_b16 a[208:209], v221 offset:12288
    ds_read_b64_tr_b16 a[210:211], v221 offset:13312
    v_mfma_f32_32x32x16_bf16 v[32:47], a[196:199], a[224:227], v[32:47]
    ds_read_b128 a[236:239], v193 offset:60416
    ds_read_b64_tr_b16 a[212:213], v222 offset:12288
    ds_read_b64_tr_b16 a[214:215], v222 offset:13312
    v_mfma_f32_32x32x16_bf16 v[48:63], a[196:199], a[228:231], v[48:63]
    buffer_load_dwordx4 v220, s[12:15], s27 offen offset:1024 sc1 lds
    ds_read_b64_tr_b16 a[216:217], v223 offset:12288
    v_mfma_f32_32x32x16_bf16 v[64:79], a[200:203], a[224:227], v[64:79]
    ds_read_b64_tr_b16 a[218:219], v223 offset:13312
    ds_read_b64_tr_b16 a[220:221], v224 offset:12288
    ds_read_b64_tr_b16 a[222:223], v224 offset:13312
    v_mfma_f32_32x32x16_bf16 v[80:95], a[200:203], a[228:231], v[80:95]
    buffer_load_dwordx4 v220, s[12:15], s27 offen offset:2048 sc1 lds
    v_mfma_f32_32x32x16_bf16 v[96:111], a[204:207], a[224:227], v[96:111]
    v_mfma_f32_32x32x16_bf16 v[112:127], a[204:207], a[228:231], v[112:127]
    s_waitcnt lgkmcnt(0)
    buffer_load_dwordx4 v220, s[12:15], s27 offen offset:3072 sc1 lds
    s_add_u32 s27, s27, 16384
    v_mfma_f32_32x32x16_bf16 v[0:15], a[208:211], a[232:235], v[0:15]
    s_waitcnt vmcnt(8)
    ds_read_b128 a[224:227], v194 offset:61440
    s_add_u32 m0, s26, 81920
    v_mfma_f32_32x32x16_bf16 v[16:31], a[208:211], a[236:239], v[16:31]
    buffer_load_dwordx4 v220, s[12:15], s27 offen offset:0 sc1 lds
    ds_read_b64_tr_b16 a[192:193], v221 offset:0
    ds_read_b64_tr_b16 a[194:195], v221 offset:1024
    v_mfma_f32_32x32x16_bf16 v[32:47], a[212:215], a[232:235], v[32:47]
    ds_read_b128 a[228:231], v194 offset:62464
    ds_read_b64_tr_b16 a[196:197], v222 offset:0
    ds_read_b64_tr_b16 a[198:199], v222 offset:1024
    v_mfma_f32_32x32x16_bf16 v[48:63], a[212:215], a[236:239], v[48:63]
    buffer_load_dwordx4 v220, s[12:15], s27 offen offset:1024 sc1 lds
    ds_read_b64_tr_b16 a[200:201], v223 offset:0
    v_mfma_f32_32x32x16_bf16 v[64:79], a[216:219], a[232:235], v[64:79]
    ds_read_b64_tr_b16 a[202:203], v223 offset:1024
    ds_read_b64_tr_b16 a[204:205], v224 offset:0
    ds_read_b64_tr_b16 a[206:207], v224 offset:1024
    v_mfma_f32_32x32x16_bf16 v[80:95], a[216:219], a[236:239], v[80:95]
    buffer_load_dwordx4 v220, s[12:15], s27 offen offset:2048 sc1 lds
    v_mfma_f32_32x32x16_bf16 v[96:111], a[220:223], a[232:235], v[96:111]
    v_mfma_f32_32x32x16_bf16 v[112:127], a[220:223], a[236:239], v[112:127]
    s_waitcnt lgkmcnt(0)
    buffer_load_dwordx4 v220, s[12:15], s27 offen offset:3072 sc1 lds
    s_add_u32 s27, s27, 16384
    v_mfma_f32_32x32x16_bf16 v[0:15], a[192:195], a[224:227], v[0:15]
    s_waitcnt vmcnt(8)
    ds_read_b128 a[232:235], v195 offset:63488
    v_mfma_f32_32x32x16_bf16 v[16:31], a[192:195], a[228:231], v[16:31]
    ds_read_b64_tr_b16 a[208:209], v221 offset:4096
    ds_read_b64_tr_b16 a[210:211], v221 offset:5120
    v_mfma_f32_32x32x16_bf16 v[32:47], a[196:199], a[224:227], v[32:47]
    ds_read_b128 a[236:239], v195 offset:64512
    ds_read_b64_tr_b16 a[212:213], v222 offset:4096
    ds_read_b64_tr_b16 a[214:215], v222 offset:5120
    v_mfma_f32_32x32x16_bf16 v[48:63], a[196:199], a[228:231], v[48:63]
    ds_read_b64_tr_b16 a[216:217], v223 offset:4096
    v_mfma_f32_32x32x16_bf16 v[64:79], a[200:203], a[224:227], v[64:79]
    ds_read_b64_tr_b16 a[218:219], v223 offset:5120
    ds_read_b64_tr_b16 a[220:221], v224 offset:4096
    ds_read_b64_tr_b16 a[222:223], v224 offset:5120
    v_mfma_f32_32x32x16_bf16 v[80:95], a[200:203], a[228:231], v[80:95]
    v_mfma_f32_32x32x16_bf16 v[96:111], a[204:207], a[224:227], v[96:111]
    v_mfma_f32_32x32x16_bf16 v[112:127], a[204:207], a[228:231], v[112:127]
    s_waitcnt lgkmcnt(0)
    v_mfma_f32_32x32x16_bf16 v[0:15], a[208:211], a[232:235], v[0:15]
    v_mfma_f32_32x32x16_bf16 v[16:31], a[208:211], a[236:239], v[16:31]
    v_mfma_f32_32x32x16_bf16 v[32:47], a[212:215], a[232:235], v[32:47]
    v_mfma_f32_32x32x16_bf16 v[48:63], a[212:215], a[236:239], v[48:63]
    v_mfma_f32_32x32x16_bf16 v[64:79], a[216:219], a[232:235], v[64:79]
    v_mfma_f32_32x32x16_bf16 v[80:95], a[216:219], a[236:239], v[80:95]
    v_mfma_f32_32x32x16_bf16 v[96:111], a[220:223], a[232:235], v[96:111]
    v_mfma_f32_32x32x16_bf16 v[112:127], a[220:223], a[236:239], v[112:127]
    s_mov_b32 s8, s16
    s_mov_b32 s9, s17
    s_mov_b32 s10, s18
    s_lshl_b32 s21, s20, 8
    s_waitcnt vmcnt(4)
    s_barrier
    ds_read_b128 a[64:67], v230 offset:0
    ds_read_b128 a[68:71], v230 offset:1024
    ds_read_b128 a[72:75], v230 offset:2048
    ds_read_b128 a[76:79], v230 offset:3072
    ds_read_b128 a[80:83], v230 offset:4096
    ds_read_b128 a[84:87], v230 offset:5120
    ds_read_b128 a[88:91], v230 offset:6144
    ds_read_b128 a[92:95], v230 offset:7168
    s_add_u32 m0, s26, 0
    s_nop 0
    buffer_load_dwordx4 v220, s[12:15], s27 offen offset:0 sc1 lds
    buffer_load_dwordx4 v220, s[12:15], s27 offen offset:1024 sc1 lds
    buffer_load_dwordx4 v220, s[12:15], s27 offen offset:2048 sc1 lds
    buffer_load_dwordx4 v220, s[12:15], s27 offen offset:3072 sc1 lds
    s_add_u32 s27, s27, 16384
    v_cvt_pk_bf16_f32 v208, v0, v1
    v_cvt_pk_bf16_f32 v209, v2, v3
    v_cvt_pk_bf16_f32 v210, v4, v5
    v_cvt_pk_bf16_f32 v211, v6, v7
    v_accvgpr_write_b32 a0, v208
    v_accvgpr_write_b32 a1, v209
    v_accvgpr_write_b32 a2, v210
    v_accvgpr_write_b32 a3, v211
    v_cvt_pk_bf16_f32 v212, v8, v9
    v_cvt_pk_bf16_f32 v213, v10, v11
    v_cvt_pk_bf16_f32 v214, v12, v13
    v_cvt_pk_bf16_f32 v215, v14, v15
    v_accvgpr_write_b32 a8, v212
    v_accvgpr_write_b32 a9, v213
    v_accvgpr_write_b32 a10, v214
    v_accvgpr_write_b32 a11, v215
    v_cvt_pk_bf16_f32 v208, v32, v33
    v_cvt_pk_bf16_f32 v209, v34, v35
    v_cvt_pk_bf16_f32 v210, v36, v37
    v_cvt_pk_bf16_f32 v211, v38, v39
    v_accvgpr_write_b32 a16, v208
    v_accvgpr_write_b32 a17, v209
    v_accvgpr_write_b32 a18, v210
    v_accvgpr_write_b32 a19, v211
    v_cvt_pk_bf16_f32 v212, v40, v41
    v_cvt_pk_bf16_f32 v213, v42, v43
    v_cvt_pk_bf16_f32 v214, v44, v45
    v_cvt_pk_bf16_f32 v215, v46, v47
    v_accvgpr_write_b32 a24, v212
    v_accvgpr_write_b32 a25, v213
    v_accvgpr_write_b32 a26, v214
    v_accvgpr_write_b32 a27, v215
    v_cvt_pk_bf16_f32 v208, v64, v65
    v_cvt_pk_bf16_f32 v209, v66, v67
    v_cvt_pk_bf16_f32 v210, v68, v69
    v_cvt_pk_bf16_f32 v211, v70, v71
    v_accvgpr_write_b32 a32, v208
    v_accvgpr_write_b32 a33, v209
    v_accvgpr_write_b32 a34, v210
    v_accvgpr_write_b32 a35, v211
    v_cvt_pk_bf16_f32 v212, v72, v73
    v_cvt_pk_bf16_f32 v213, v74, v75
    v_cvt_pk_bf16_f32 v214, v76, v77
    v_cvt_pk_bf16_f32 v215, v78, v79
    v_accvgpr_write_b32 a40, v212
    v_accvgpr_write_b32 a41, v213
    v_accvgpr_write_b32 a42, v214
    v_accvgpr_write_b32 a43, v215
    v_cvt_pk_bf16_f32 v208, v96, v97
    v_cvt_pk_bf16_f32 v209, v98, v99
    v_cvt_pk_bf16_f32 v210, v100, v101
    v_cvt_pk_bf16_f32 v211, v102, v103
    v_accvgpr_write_b32 a48, v208
    v_accvgpr_write_b32 a49, v209
    v_accvgpr_write_b32 a50, v210
    v_accvgpr_write_b32 a51, v211
    v_cvt_pk_bf16_f32 v212, v104, v105
    v_cvt_pk_bf16_f32 v213, v106, v107
    v_cvt_pk_bf16_f32 v214, v108, v109
    v_cvt_pk_bf16_f32 v215, v110, v111
    v_accvgpr_write_b32 a56, v212
    v_accvgpr_write_b32 a57, v213
    v_accvgpr_write_b32 a58, v214
    v_accvgpr_write_b32 a59, v215
    s_waitcnt lgkmcnt(0)
    v_mfma_f32_32x32x16_bf16 v[128:143], a[64:67], a[0:3], 0
    s_add_u32 m0, s26, 16384
    ds_read_b128 a[128:131], v230 offset:8192
    v_cvt_pk_bf16_f32 v208, v16, v17
    v_cvt_pk_bf16_f32 v209, v18, v19
    v_cvt_pk_bf16_f32 v210, v20, v21
    v_cvt_pk_bf16_f32 v211, v22, v23
    v_accvgpr_write_b32 a4, v208
    v_accvgpr_write_b32 a5, v209
    v_accvgpr_write_b32 a6, v210
    v_accvgpr_write_b32 a7, v211
    v_cvt_pk_bf16_f32 v212, v24, v25
    v_mfma_f32_32x32x16_bf16 v[128:143], a[68:71], a[8:11], v[128:143]
    ds_read_b128 a[132:135], v230 offset:9216
    buffer_load_dwordx4 v220, s[12:15], s27 offen offset:0 sc1 lds
    v_cvt_pk_bf16_f32 v213, v26, v27
    v_cvt_pk_bf16_f32 v214, v28, v29
    v_cvt_pk_bf16_f32 v215, v30, v31
    v_accvgpr_write_b32 a12, v212
    v_accvgpr_write_b32 a13, v213
    v_accvgpr_write_b32 a14, v214
    v_accvgpr_write_b32 a15, v215
    v_mfma_f32_32x32x16_bf16 v[128:143], a[72:75], a[16:19], v[128:143]
    ds_read_b128 a[136:139], v230 offset:10240
    v_cvt_pk_bf16_f32 v208, v48, v49
    v_cvt_pk_bf16_f32 v209, v50, v51
    v_cvt_pk_bf16_f32 v210, v52, v53
    v_cvt_pk_bf16_f32 v211, v54, v55
    v_accvgpr_write_b32 a20, v208
    v_accvgpr_write_b32 a21, v209
    v_accvgpr_write_b32 a22, v210
    v_accvgpr_write_b32 a23, v211
    v_cvt_pk_bf16_f32 v212, v56, v57
    v_mfma_f32_32x32x16_bf16 v[128:143], a[76:79], a[24:27], v[128:143]
    ds_read_b128 a[140:143], v230 offset:11264
    buffer_load_dwordx4 v220, s[12:15], s27 offen offset:1024 sc1 lds
    v_cvt_pk_bf16_f32 v213, v58, v59
    v_cvt_pk_bf16_f32 v214, v60, v61
    v_cvt_pk_bf16_f32 v215, v62, v63
    v_accvgpr_write_b32 a28, v212
    v_accvgpr_write_b32 a29, v213
    v_accvgpr_write_b32 a30, v214
    v_accvgpr_write_b32 a31, v215
    v_mfma_f32_32x32x16_bf16 v[128:143], a[80:83], a[32:35], v[128:143]
    ds_read_b128 a[144:147], v230 offset:12288
    v_cvt_pk_bf16_f32 v208, v80, v81
    v_cvt_pk_bf16_f32 v209, v82, v83
    v_cvt_pk_bf16_f32 v210, v84, v85
    v_cvt_pk_bf16_f32 v211, v86, v87
    v_accvgpr_write_b32 a36, v208
    v_accvgpr_write_b32 a37, v209
    v_accvgpr_write_b32 a38, v210
    v_accvgpr_write_b32 a39, v211
    v_cvt_pk_bf16_f32 v212, v88, v89
    v_mfma_f32_32x32x16_bf16 v[128:143], a[84:87], a[40:43], v[128:143]
    ds_read_b128 a[148:151], v230 offset:13312
    buffer_load_dwordx4 v220, s[12:15], s27 offen offset:2048 sc1 lds
    v_cvt_pk_bf16_f32 v213, v90, v91
    v_cvt_pk_bf16_f32 v214, v92, v93
    v_cvt_pk_bf16_f32 v215, v94, v95
    v_accvgpr_write_b32 a44, v212
    v_accvgpr_write_b32 a45, v213
    v_accvgpr_write_b32 a46, v214
    v_accvgpr_write_b32 a47, v215
    v_mfma_f32_32x32x16_bf16 v[128:143], a[88:91], a[48:51], v[128:143]
    ds_read_b128 a[152:155], v230 offset:14336
    v_cvt_pk_bf16_f32 v208, v112, v113
    v_cvt_pk_bf16_f32 v209, v114, v115
    v_cvt_pk_bf16_f32 v210, v116, v117
    v_cvt_pk_bf16_f32 v211, v118, v119
    v_accvgpr_write_b32 a52, v208
    v_accvgpr_write_b32 a53, v209
    v_accvgpr_write_b32 a54, v210
    v_accvgpr_write_b32 a55, v211
    v_cvt_pk_bf16_f32 v212, v120, v121
    v_mfma_f32_32x32x16_bf16 v[128:143], a[92:95], a[56:59], v[128:143]
    ds_read_b128 a[156:159], v230 offset:15360
    buffer_load_dwordx4 v220, s[12:15], s27 offen offset:3072 sc1 lds
    s_add_u32 s27, s27, 16384
    v_cvt_pk_bf16_f32 v213, v122, v123
    v_cvt_pk_bf16_f32 v214, v124, v125
    v_cvt_pk_bf16_f32 v215, v126, v127
    v_accvgpr_write_b32 a60, v212
    v_accvgpr_write_b32 a61, v213
    v_accvgpr_write_b32 a62, v214
    v_accvgpr_write_b32 a63, v215
    s_waitcnt vmcnt(8) lgkmcnt(0)
    s_barrier
    v_mfma_f32_32x32x16_bf16 v[144:159], a[64:67], a[4:7], 0
    ds_read_b128 a[96:99], v230 offset:16384
    ds_read_b128 a[160:163], v230 offset:24576
    v_mfma_f32_32x32x16_bf16 v[144:159], a[68:71], a[12:15], v[144:159]
    ds_read_b128 a[100:103], v230 offset:17408
    ds_read_b128 a[164:167], v230 offset:25600
    v_max3_f32 v236, v128, v129, v130
    v_max3_f32 v236, v236, v131, v132
    v_max3_f32 v236, v236, v133, v134
    v_max3_f32 v236, v236, v135, v136
    v_mfma_f32_32x32x16_bf16 v[144:159], a[72:75], a[20:23], v[144:159]
    ds_read_b128 a[104:107], v230 offset:18432
    ds_read_b128 a[168:171], v230 offset:26624
    v_max3_f32 v236, v236, v137, v138
    v_max3_f32 v236, v236, v139, v140
    v_max3_f32 v236, v236, v141, v142
    v_max_f32 v236, v236, v143
    v_mov_b32 v237, v236
    v_mfma_f32_32x32x16_bf16 v[144:159], a[76:79], a[28:31], v[144:159]
    ds_read_b128 a[108:111], v230 offset:19456
    ds_read_b128 a[172:175], v230 offset:27648
    s_nop 1
    v_permlane32_swap_b32 v236, v237
    s_nop 0
    v_max_f32 v236, v236, v237
    v_mfma_f32_32x32x16_bf16 v[144:159], a[80:83], a[36:39], v[144:159]
    ds_read_b128 a[112:115], v230 offset:20480
    ds_read_b128 a[176:179], v230 offset:28672
    v_sub_f32 v236, 0xc2800000, v236
    v_add_f32 v128, v128, v236
    v_add_f32 v129, v129, v236
    v_add_f32 v130, v130, v236
    v_mfma_f32_32x32x16_bf16 v[144:159], a[84:87], a[44:47], v[144:159]
    ds_read_b128 a[116:119], v230 offset:21504
    ds_read_b128 a[180:183], v230 offset:29696
    v_add_f32 v131, v131, v236
    v_add_f32 v132, v132, v236
    v_add_f32 v133, v133, v236
    v_add_f32 v134, v134, v236
    v_mfma_f32_32x32x16_bf16 v[144:159], a[88:91], a[52:55], v[144:159]
    ds_read_b128 a[120:123], v230 offset:22528
    ds_read_b128 a[184:187], v230 offset:30720
    v_add_f32 v135, v135, v236
    v_add_f32 v136, v136, v236
    v_add_f32 v137, v137, v236
    v_add_f32 v138, v138, v236
    v_add_f32 v139, v139, v236
    v_mfma_f32_32x32x16_bf16 v[144:159], a[92:95], a[60:63], v[144:159]
    ds_read_b128 a[124:127], v230 offset:23552
    ds_read_b128 a[188:191], v230 offset:31744
    v_add_f32 v140, v140, v236
    v_add_f32 v141, v141, v236
    v_add_f32 v142, v142, v236
    v_add_f32 v143, v143, v236
    v_exp_f32 v208, v128
    v_exp_f32 v209, v129
    v_exp_f32 v210, v130
    v_add_f32 v218, v208, v209
    v_exp_f32 v211, v131
    v_cvt_pk_bf16_f32 v192, v208, v209
    v_exp_f32 v212, v132
    v_add_f32 v218, v218, v210
    v_add_f32 v218, v218, v211
    v_exp_f32 v213, v133
    v_cvt_pk_bf16_f32 v193, v210, v211
    v_exp_f32 v214, v134
    v_add_f32 v218, v218, v212
    v_add_f32 v218, v218, v213
    v_exp_f32 v215, v135
    v_cvt_pk_bf16_f32 v194, v212, v213
    v_exp_f32 v208, v136
    v_add_f32 v218, v218, v214
    v_add_f32 v218, v218, v215
    v_exp_f32 v209, v137
    v_cvt_pk_bf16_f32 v195, v214, v215
    v_exp_f32 v210, v138
    v_add_f32 v218, v218, v208
    v_add_f32 v218, v218, v209
    v_exp_f32 v211, v139
    v_cvt_pk_bf16_f32 v196, v208, v209
    v_exp_f32 v212, v140
    v_add_f32 v218, v218, v210
    v_add_f32 v218, v218, v211
    v_exp_f32 v213, v141
    v_cvt_pk_bf16_f32 v197, v210, v211
    v_exp_f32 v214, v142
    v_add_f32 v218, v218, v212
    v_add_f32 v218, v218, v213
    v_exp_f32 v215, v143
    v_cvt_pk_bf16_f32 v198, v212, v213
    v_add_f32 v218, v218, v214
    v_add_f32 v218, v218, v215
    v_cmp_lt_f32 vcc, s30, v218
    v_cvt_pk_bf16_f32 v199, v214, v215
    v_mov_b32 v216, v218
    v_mov_b32 v217, 0
    v_mfma_f32_32x32x16_bf16 v[0:15], a[128:131], v[192:195], 0
    s_add_u32 m0, s26, 32768
    v_max3_f32 v238, v144, v145, v146
    v_max3_f32 v238, v238, v147, v148
    v_max3_f32 v238, v238, v149, v150
    v_max3_f32 v238, v238, v151, v152
    v_max3_f32 v238, v238, v153, v154
    v_max3_f32 v238, v238, v155, v156
    v_max3_f32 v238, v238, v157, v158
    v_max_f32 v238, v238, v159
    v_mov_b32 v239, v238
    s_nop 1
    v_permlane32_swap_b32 v238, v239
    v_mfma_f32_32x32x16_bf16 v[32:47], a[132:135], v[192:195], 0
    buffer_load_dwordx4 v220, s[12:15], s27 offen offset:0 sc1 lds
    s_nop 0
    v_max_f32 v238, v238, v239
    v_sub_f32 v238, 0xc2800000, v238
    v_add_f32 v144, v144, v238
    v_add_f32 v145, v145, v238
    v_add_f32 v146, v146, v238
    v_add_f32 v147, v147, v238
    v_add_f32 v148, v148, v238
    v_add_f32 v149, v149, v238
    v_mfma_f32_32x32x16_bf16 v[64:79], a[136:139], v[192:195], 0
    v_add_f32 v150, v150, v238
    v_add_f32 v151, v151, v238
    v_add_f32 v152, v152, v238
    v_add_f32 v153, v153, v238
    v_add_f32 v154, v154, v238
    v_add_f32 v155, v155, v238
    v_add_f32 v156, v156, v238
    v_add_f32 v157, v157, v238
    v_add_f32 v158, v158, v238
    v_add_f32 v159, v159, v238
    v_mov_b32 v160, v236
    v_mfma_f32_32x32x16_bf16 v[96:111], a[140:143], v[192:195], 0
    buffer_load_dwordx4 v220, s[12:15], s27 offen offset:1024 sc1 lds
    v_mov_b32 v161, v236
    v_mov_b32 v162, v236
    v_mov_b32 v163, v236
    v_mov_b32 v164, v236
    v_mov_b32 v165, v236
    v_mov_b32 v166, v236
    v_mov_b32 v167, v236
    v_mov_b32 v168, v236
    v_mov_b32 v169, v236
    v_mfma_f32_32x32x16_bf16 v[0:15], a[144:147], v[196:199], v[0:15]
    v_mov_b32 v170, v236
    v_mov_b32 v171, v236
    v_mov_b32 v172, v236
    v_mov_b32 v173, v236
    v_mov_b32 v174, v236
    v_mov_b32 v175, v236
    v_exp_f32 v208, v144
    v_exp_f32 v209, v145
    v_exp_f32 v210, v146
    v_mfma_f32_32x32x16_bf16 v[32:47], a[148:151], v[196:199], v[32:47]
    buffer_load_dwordx4 v220, s[12:15], s27 offen offset:2048 sc1 lds
    v_add_f32 v219, v208, v209
    v_exp_f32 v211, v147
    v_cvt_pk_bf16_f32 v200, v208, v209
    v_exp_f32 v212, v148
    v_add_f32 v219, v219, v210
    v_add_f32 v219, v219, v211
    v_mfma_f32_32x32x16_bf16 v[64:79], a[152:155], v[196:199], v[64:79]
    v_exp_f32 v213, v149
    v_cvt_pk_bf16_f32 v201, v210, v211
    v_exp_f32 v214, v150
    v_add_f32 v219, v219, v212
    v_add_f32 v219, v219, v213
    v_exp_f32 v215, v151
    v_cvt_pk_bf16_f32 v202, v212, v213
    v_mfma_f32_32x32x16_bf16 v[96:111], a[156:159], v[196:199], v[96:111]
    buffer_load_dwordx4 v220, s[12:15], s27 offen offset:3072 sc1 lds
    s_add_u32 s27, s27, 16384
    s_waitcnt lgkmcnt(0)
    v_exp_f32 v208, v152
    v_add_f32 v219, v219, v214
    v_add_f32 v219, v219, v215
    v_lshlrev_b32 v243, 1, v220
    v_lshrrev_b32 v240, 9, v220
    v_mul_u32_u24 v240, 3584, v240
    v_and_b32 v241, 0x3ff, v243
    v_min_u32 v241, 864, v241
    v_add_u32 v244, v240, v241
    s_lshl_b32 s53, s2, 2
    s_add_u32 s53, s53, s20
    v_mfma_f32_32x32x16_bf16 v[128:143], a[96:99], a[0:3], v[160:175]
    s_waitcnt vmcnt(8)
    s_barrier
    v_mfma_f32_32x32x16_bf16 v[128:143], a[100:103], a[8:11], v[128:143]
    s_mov_b32 s48, s72
    v_exp_f32 v209, v153
    v_cvt_pk_bf16_f32 v203, v214, v215
    v_exp_f32 v210, v154
    v_mfma_f32_32x32x16_bf16 v[128:143], a[104:107], a[16:19], v[128:143]
    s_mov_b32 s49, s73
    v_add_f32 v219, v219, v208
    v_add_f32 v219, v219, v209
    v_exp_f32 v211, v155
    v_mfma_f32_32x32x16_bf16 v[128:143], a[108:111], a[24:27], v[128:143]
    s_mov_b32 s50, 4194304
    v_cvt_pk_bf16_f32 v204, v208, v209
    v_exp_f32 v212, v156
    v_add_f32 v219, v219, v210
    v_add_f32 v219, v219, v211
    v_mfma_f32_32x32x16_bf16 v[128:143], a[112:115], a[32:35], v[128:143]
    s_mov_b32 s51, 0x20000
    v_exp_f32 v213, v157
    v_cvt_pk_bf16_f32 v205, v210, v211
    v_exp_f32 v214, v158
    v_mfma_f32_32x32x16_bf16 v[128:143], a[116:119], a[40:43], v[128:143]
    s_lshl_b32 s52, s53, 12
    v_add_f32 v219, v219, v212
    v_add_f32 v219, v219, v213
    v_exp_f32 v215, v159
    v_mfma_f32_32x32x16_bf16 v[128:143], a[120:123], a[48:51], v[128:143]
    v_cvt_pk_bf16_f32 v206, v212, v213
    v_add_f32 v219, v219, v214
    v_add_f32 v219, v219, v215
    v_cmp_lt_f32 vcc, s30, v219
    v_cvt_pk_bf16_f32 v207, v214, v215
    v_mfma_f32_32x32x16_bf16 v[128:143], a[124:127], a[56:59], v[128:143]
    s_cbranch_vccnz KA_TR0
KA_RET0:
    v_add_f32 v217, v217, v219
    ds_read_b128 a[64:67], v220 offset:0
    v_mov_b32 v176, v238
    v_mov_b32 v177, v238
    v_mov_b32 v178, v238
    v_mov_b32 v179, v238
    v_mov_b32 v180, v238
    v_mov_b32 v181, v238
    v_mov_b32 v182, v238
    v_mov_b32 v183, v238
    v_mfma_f32_32x32x16_bf16 v[16:31], a[128:131], v[200:203], 0
    ds_read_b128 a[68:71], v220 offset:1024
    ds_read_b128 a[72:75], v220 offset:2048
    ds_read_b128 a[76:79], v220 offset:3072
    ds_read_b128 a[80:83], v220 offset:4096
    buffer_load_dword a252, v243, s[48:51], s52 offen
    v_mov_b32 v184, v238
    v_mov_b32 v185, v238
    v_mfma_f32_32x32x16_bf16 v[48:63], a[132:135], v[200:203], 0
    ds_read_b128 a[84:87], v220 offset:5120
    ds_read_b128 a[88:91], v220 offset:6144
    ds_read_b128 a[92:95], v220 offset:7168
    v_mov_b32 v186, v238
    v_mov_b32 v187, v238
    v_mov_b32 v188, v238
    v_mov_b32 v189, v238
    v_mov_b32 v190, v238
    v_mov_b32 v191, v238
    v_mfma_f32_32x32x16_bf16 v[80:95], a[136:139], v[200:203], 0
    s_add_u32 m0, s26, 49152
    v_exp_f32 v208, v128
    v_exp_f32 v209, v129
    v_exp_f32 v210, v130
    v_mfma_f32_32x32x16_bf16 v[112:127], a[140:143], v[200:203], 0
    v_add_f32 v218, v208, v209
    v_exp_f32 v211, v131
    v_cvt_pk_bf16_f32 v192, v208, v209
    v_mfma_f32_32x32x16_bf16 v[16:31], a[144:147], v[204:207], v[16:31]
    buffer_load_dwordx4 v220, s[12:15], s27 offen offset:0 sc1 lds
    v_exp_f32 v212, v132
    v_add_f32 v218, v218, v210
    v_mfma_f32_32x32x16_bf16 v[48:63], a[148:151], v[204:207], v[48:63]
    v_add_f32 v218, v218, v211
    v_exp_f32 v213, v133
    v_cvt_pk_bf16_f32 v193, v210, v211
    v_mfma_f32_32x32x16_bf16 v[80:95], a[152:155], v[204:207], v[80:95]
    buffer_load_dwordx4 v220, s[12:15], s27 offen offset:1024 sc1 lds
    v_exp_f32 v214, v134
    v_add_f32 v218, v218, v212
    v_add_f32 v218, v218, v213
    v_mfma_f32_32x32x16_bf16 v[112:127], a[156:159], v[204:207], v[112:127]
    v_exp_f32 v215, v135
    v_cvt_pk_bf16_f32 v194, v212, v213
    v_exp_f32 v208, v136
    v_mfma_f32_32x32x16_bf16 v[144:159], a[96:99], a[4:7], v[176:191]
    buffer_load_dwordx4 v220, s[12:15], s27 offen offset:2048 sc1 lds
    v_add_f32 v218, v218, v214
    v_add_f32 v218, v218, v215
    v_mfma_f32_32x32x16_bf16 v[144:159], a[100:103], a[12:15], v[144:159]
    v_exp_f32 v209, v137
    v_cvt_pk_bf16_f32 v195, v214, v215
    v_exp_f32 v210, v138
    v_add_f32 v218, v218, v208
    v_mfma_f32_32x32x16_bf16 v[144:159], a[104:107], a[20:23], v[144:159]
    buffer_load_dwordx4 v220, s[12:15], s27 offen offset:3072 sc1 lds
    v_add_f32 v218, v218, v209
    v_exp_f32 v211, v139
    v_mfma_f32_32x32x16_bf16 v[144:159], a[108:111], a[28:31], v[144:159]
    s_add_u32 s27, s27, 16384
    v_cvt_pk_bf16_f32 v196, v208, v209
    v_exp_f32 v212, v140
    v_add_f32 v218, v218, v210
    v_add_f32 v218, v218, v211
    v_mfma_f32_32x32x16_bf16 v[144:159], a[112:115], a[36:39], v[144:159]
    v_exp_f32 v213, v141
    v_cvt_pk_bf16_f32 v197, v210, v211
    v_exp_f32 v214, v142
    v_mfma_f32_32x32x16_bf16 v[144:159], a[116:119], a[44:47], v[144:159]
    v_add_f32 v218, v218, v212
    v_add_f32 v218, v218, v213
    v_exp_f32 v215, v143
    v_mfma_f32_32x32x16_bf16 v[144:159], a[120:123], a[52:55], v[144:159]
    v_cvt_pk_bf16_f32 v198, v212, v213
    v_add_f32 v218, v218, v214
    v_add_f32 v218, v218, v215
    v_cmp_lt_f32 vcc, s30, v218
    v_cvt_pk_bf16_f32 v199, v214, v215
    v_mfma_f32_32x32x16_bf16 v[144:159], a[124:127], a[60:63], v[144:159]
    s_cbranch_vccnz KA_TR1
KA_RET1:
    v_add_f32 v216, v216, v218
    ds_read_b128 a[128:131], v220 offset:8192
    v_mfma_f32_32x32x16_bf16 v[0:15], a[160:163], v[192:195], v[0:15]
    ds_read_b128 a[132:135], v220 offset:9216
    ds_read_b128 a[136:139], v220 offset:10240
    ds_read_b128 a[140:143], v220 offset:11264
    ds_read_b128 a[144:147], v220 offset:12288
    v_mfma_f32_32x32x16_bf16 v[32:47], a[164:167], v[192:195], v[32:47]
    ds_read_b128 a[148:151], v220 offset:13312
    ds_read_b128 a[152:155], v220 offset:14336
    ds_read_b128 a[156:159], v220 offset:15360
    v_exp_f32 v208, v144
    v_mfma_f32_32x32x16_bf16 v[64:79], a[168:171], v[192:195], v[64:79]
    v_exp_f32 v209, v145
    v_exp_f32 v210, v146
    v_mfma_f32_32x32x16_bf16 v[96:111], a[172:175], v[192:195], v[96:111]
    v_add_f32 v219, v208, v209
    v_exp_f32 v211, v147
    v_cvt_pk_bf16_f32 v200, v208, v209
    v_mfma_f32_32x32x16_bf16 v[0:15], a[176:179], v[196:199], v[0:15]
    v_exp_f32 v212, v148
    v_add_f32 v219, v219, v210
    v_add_f32 v219, v219, v211
    v_mfma_f32_32x32x16_bf16 v[32:47], a[180:183], v[196:199], v[32:47]
    v_exp_f32 v213, v149
    v_cvt_pk_bf16_f32 v201, v210, v211
    v_exp_f32 v214, v150
    v_mfma_f32_32x32x16_bf16 v[64:79], a[184:187], v[196:199], v[64:79]
    v_add_f32 v219, v219, v212
    v_add_f32 v219, v219, v213
    v_exp_f32 v215, v151
    v_cvt_pk_bf16_f32 v202, v212, v213
    v_mfma_f32_32x32x16_bf16 v[96:111], a[188:191], v[196:199], v[96:111]
    s_waitcnt lgkmcnt(0)
    v_exp_f32 v208, v152
    v_add_f32 v219, v219, v214
    v_add_f32 v219, v219, v215
    v_mfma_f32_32x32x16_bf16 v[128:143], a[64:67], a[0:3], v[160:175]
    s_waitcnt vmcnt(9)
    s_barrier
    v_mfma_f32_32x32x16_bf16 v[128:143], a[68:71], a[8:11], v[128:143]
    v_exp_f32 v209, v153
    v_cvt_pk_bf16_f32 v203, v214, v215
    v_exp_f32 v210, v154
    v_mfma_f32_32x32x16_bf16 v[128:143], a[72:75], a[16:19], v[128:143]
    v_add_f32 v219, v219, v208
    v_add_f32 v219, v219, v209
    v_exp_f32 v211, v155
    v_mfma_f32_32x32x16_bf16 v[128:143], a[76:79], a[24:27], v[128:143]
    v_cvt_pk_bf16_f32 v204, v208, v209
    v_exp_f32 v212, v156
    v_add_f32 v219, v219, v210
    v_add_f32 v219, v219, v211
    v_mfma_f32_32x32x16_bf16 v[128:143], a[80:83], a[32:35], v[128:143]
    v_exp_f32 v213, v157
    v_cvt_pk_bf16_f32 v205, v210, v211
    v_exp_f32 v214, v158
    v_mfma_f32_32x32x16_bf16 v[128:143], a[84:87], a[40:43], v[128:143]
    v_add_f32 v219, v219, v212
    v_add_f32 v219, v219, v213
    v_exp_f32 v215, v159
    v_mfma_f32_32x32x16_bf16 v[128:143], a[88:91], a[48:51], v[128:143]
    v_cvt_pk_bf16_f32 v206, v212, v213
    v_add_f32 v219, v219, v214
    v_add_f32 v219, v219, v215
    v_cmp_lt_f32 vcc, s30, v219
    v_cvt_pk_bf16_f32 v207, v214, v215
    v_mfma_f32_32x32x16_bf16 v[128:143], a[92:95], a[56:59], v[128:143]
    s_cbranch_vccnz KA_TR2
KA_RET2:
    v_add_f32 v217, v217, v219
    ds_read_b128 a[96:99], v220 offset:16384
    v_mfma_f32_32x32x16_bf16 v[16:31], a[160:163], v[200:203], v[16:31]
    ds_read_b128 a[100:103], v220 offset:17408
    ds_read_b128 a[104:107], v220 offset:18432
    ds_read_b128 a[108:111], v220 offset:19456
    ds_read_b128 a[112:115], v220 offset:20480
    v_mfma_f32_32x32x16_bf16 v[48:63], a[164:167], v[200:203], v[48:63]
    ds_read_b128 a[116:119], v220 offset:21504
    ds_read_b128 a[120:123], v220 offset:22528
    ds_read_b128 a[124:127], v220 offset:23552
    v_exp_f32 v208, v128
    v_mfma_f32_32x32x16_bf16 v[80:95], a[168:171], v[200:203], v[80:95]
    s_add_u32 m0, s26, 0
    v_exp_f32 v209, v129
    v_exp_f32 v210, v130
    v_add_f32 v218, v208, v209
    v_mfma_f32_32x32x16_bf16 v[112:127], a[172:175], v[200:203], v[112:127]
    v_exp_f32 v211, v131
    v_cvt_pk_bf16_f32 v192, v208, v209
    v_exp_f32 v212, v132
    v_mfma_f32_32x32x16_bf16 v[16:31], a[176:179], v[204:207], v[16:31]
    buffer_load_dwordx4 v220, s[12:15], s27 offen offset:0 sc1 lds
    v_add_f32 v218, v218, v210
    v_add_f32 v218, v218, v211
    v_mfma_f32_32x32x16_bf16 v[48:63], a[180:183], v[204:207], v[48:63]
    v_exp_f32 v213, v133
    v_cvt_pk_bf16_f32 v193, v210, v211
    v_exp_f32 v214, v134
    v_mfma_f32_32x32x16_bf16 v[80:95], a[184:187], v[204:207], v[80:95]
    buffer_load_dwordx4 v220, s[12:15], s27 offen offset:1024 sc1 lds
    v_add_f32 v218, v218, v212
    v_add_f32 v218, v218, v213
    v_exp_f32 v215, v135
    v_mfma_f32_32x32x16_bf16 v[112:127], a[188:191], v[204:207], v[112:127]
    v_cvt_pk_bf16_f32 v194, v212, v213
    v_exp_f32 v208, v136
    v_add_f32 v218, v218, v214
    v_mfma_f32_32x32x16_bf16 v[144:159], a[64:67], a[4:7], v[176:191]
    buffer_load_dwordx4 v220, s[12:15], s27 offen offset:2048 sc1 lds
    v_add_f32 v218, v218, v215
    v_exp_f32 v209, v137
    v_mfma_f32_32x32x16_bf16 v[144:159], a[68:71], a[12:15], v[144:159]
    v_cvt_pk_bf16_f32 v195, v214, v215
    v_exp_f32 v210, v138
    v_add_f32 v218, v218, v208
    v_mfma_f32_32x32x16_bf16 v[144:159], a[72:75], a[20:23], v[144:159]
    buffer_load_dwordx4 v220, s[12:15], s27 offen offset:3072 sc1 lds
    v_add_f32 v218, v218, v209
    v_exp_f32 v211, v139
    v_mfma_f32_32x32x16_bf16 v[144:159], a[76:79], a[28:31], v[144:159]
    s_add_u32 s27, s27, 16384
    v_cvt_pk_bf16_f32 v196, v208, v209
    v_exp_f32 v212, v140
    v_add_f32 v218, v218, v210
    v_add_f32 v218, v218, v211
    v_mfma_f32_32x32x16_bf16 v[144:159], a[80:83], a[36:39], v[144:159]
    v_exp_f32 v213, v141
    v_cvt_pk_bf16_f32 v197, v210, v211
    v_exp_f32 v214, v142
    v_mfma_f32_32x32x16_bf16 v[144:159], a[84:87], a[44:47], v[144:159]
    v_add_f32 v218, v218, v212
    v_add_f32 v218, v218, v213
    v_exp_f32 v215, v143
    v_mfma_f32_32x32x16_bf16 v[144:159], a[88:91], a[52:55], v[144:159]
    v_cvt_pk_bf16_f32 v198, v212, v213
    v_add_f32 v218, v218, v214
    v_add_f32 v218, v218, v215
    v_cmp_lt_f32 vcc, s30, v218
    v_cvt_pk_bf16_f32 v199, v214, v215
    v_mfma_f32_32x32x16_bf16 v[144:159], a[92:95], a[60:63], v[144:159]
    s_cbranch_vccnz KA_TR3
KA_RET3:
    v_add_f32 v216, v216, v218
    ds_read_b128 a[160:163], v220 offset:24576
    v_mfma_f32_32x32x16_bf16 v[0:15], a[128:131], v[192:195], v[0:15]
    ds_read_b128 a[164:167], v220 offset:25600
    ds_read_b128 a[168:171], v220 offset:26624
    ds_read_b128 a[172:175], v220 offset:27648
    ds_read_b128 a[176:179], v220 offset:28672
    v_mfma_f32_32x32x16_bf16 v[32:47], a[132:135], v[192:195], v[32:47]
    ds_read_b128 a[180:183], v220 offset:29696
    ds_read_b128 a[184:187], v220 offset:30720
    ds_read_b128 a[188:191], v220 offset:31744
    v_exp_f32 v208, v144
    v_mfma_f32_32x32x16_bf16 v[64:79], a[136:139], v[192:195], v[64:79]
    v_exp_f32 v209, v145
    v_exp_f32 v210, v146
    v_mfma_f32_32x32x16_bf16 v[96:111], a[140:143], v[192:195], v[96:111]
    v_add_f32 v219, v208, v209
    v_exp_f32 v211, v147
    v_cvt_pk_bf16_f32 v200, v208, v209
    v_mfma_f32_32x32x16_bf16 v[0:15], a[144:147], v[196:199], v[0:15]
    v_exp_f32 v212, v148
    v_add_f32 v219, v219, v210
    v_add_f32 v219, v219, v211
    v_mfma_f32_32x32x16_bf16 v[32:47], a[148:151], v[196:199], v[32:47]
    v_exp_f32 v213, v149
    v_cvt_pk_bf16_f32 v201, v210, v211
    v_exp_f32 v214, v150
    v_mfma_f32_32x32x16_bf16 v[64:79], a[152:155], v[196:199], v[64:79]
    v_add_f32 v219, v219, v212
    v_add_f32 v219, v219, v213
    v_exp_f32 v215, v151
    v_cvt_pk_bf16_f32 v202, v212, v213
    v_mfma_f32_32x32x16_bf16 v[96:111], a[156:159], v[196:199], v[96:111]
    s_waitcnt lgkmcnt(0)
    v_exp_f32 v208, v152
    v_add_f32 v219, v219, v214
    v_add_f32 v219, v219, v215
    v_mfma_f32_32x32x16_bf16 v[128:143], a[96:99], a[0:3], v[160:175]
    s_waitcnt vmcnt(9)
    s_barrier
    v_mfma_f32_32x32x16_bf16 v[128:143], a[100:103], a[8:11], v[128:143]
    s_add_u32 s52, s52, 2048
    v_exp_f32 v209, v153
    v_cvt_pk_bf16_f32 v203, v214, v215
    v_exp_f32 v210, v154
    v_mfma_f32_32x32x16_bf16 v[128:143], a[104:107], a[16:19], v[128:143]
    v_add_f32 v219, v219, v208
    v_add_f32 v219, v219, v209
    v_exp_f32 v211, v155
    v_mfma_f32_32x32x16_bf16 v[128:143], a[108:111], a[24:27], v[128:143]
    v_cvt_pk_bf16_f32 v204, v208, v209
    v_exp_f32 v212, v156
    v_add_f32 v219, v219, v210
    v_add_f32 v219, v219, v211
    v_mfma_f32_32x32x16_bf16 v[128:143], a[112:115], a[32:35], v[128:143]
    v_exp_f32 v213, v157
    v_cvt_pk_bf16_f32 v205, v210, v211
    v_exp_f32 v214, v158
    v_mfma_f32_32x32x16_bf16 v[128:143], a[116:119], a[40:43], v[128:143]
    v_add_f32 v219, v219, v212
    v_add_f32 v219, v219, v213
    v_exp_f32 v215, v159
    v_mfma_f32_32x32x16_bf16 v[128:143], a[120:123], a[48:51], v[128:143]
    v_cvt_pk_bf16_f32 v206, v212, v213
    v_add_f32 v219, v219, v214
    v_add_f32 v219, v219, v215
    v_cmp_lt_f32 vcc, s30, v219
    v_cvt_pk_bf16_f32 v207, v214, v215
    v_mfma_f32_32x32x16_bf16 v[128:143], a[124:127], a[56:59], v[128:143]
    s_cbranch_vccnz KA_TR4
KA_RET4:
    v_add_f32 v217, v217, v219
    ds_read_b128 a[64:67], v220 offset:32768
    v_mfma_f32_32x32x16_bf16 v[16:31], a[128:131], v[200:203], v[16:31]
    ds_read_b128 a[68:71], v220 offset:33792
    ds_read_b128 a[72:75], v220 offset:34816
    ds_read_b128 a[76:79], v220 offset:35840
    ds_read_b128 a[80:83], v220 offset:36864
    buffer_load_dword a252, v243, s[48:51], s52 offen
    v_mfma_f32_32x32x16_bf16 v[48:63], a[132:135], v[200:203], v[48:63]
    ds_read_b128 a[84:87], v220 offset:37888
    ds_read_b128 a[88:91], v220 offset:38912
    ds_read_b128 a[92:95], v220 offset:39936
    v_exp_f32 v208, v128
    v_mfma_f32_32x32x16_bf16 v[80:95], a[136:139], v[200:203], v[80:95]
    s_add_u32 m0, s26, 16384
    v_exp_f32 v209, v129
    v_exp_f32 v210, v130
    v_add_f32 v218, v208, v209
    v_mfma_f32_32x32x16_bf16 v[112:127], a[140:143], v[200:203], v[112:127]
    v_exp_f32 v211, v131
    v_cvt_pk_bf16_f32 v192, v208, v209
    v_exp_f32 v212, v132
    v_mfma_f32_32x32x16_bf16 v[16:31], a[144:147], v[204:207], v[16:31]
    buffer_load_dwordx4 v220, s[12:15], s27 offen offset:0 sc1 lds
    v_add_f32 v218, v218, v210
    v_add_f32 v218, v218, v211
    v_mfma_f32_32x32x16_bf16 v[48:63], a[148:151], v[204:207], v[48:63]
    v_exp_f32 v213, v133
    v_cvt_pk_bf16_f32 v193, v210, v211
    v_exp_f32 v214, v134
    v_mfma_f32_32x32x16_bf16 v[80:95], a[152:155], v[204:207], v[80:95]
    buffer_load_dwordx4 v220, s[12:15], s27 offen offset:1024 sc1 lds
    v_add_f32 v218, v218, v212
    v_add_f32 v218, v218, v213
    v_exp_f32 v215, v135
    v_mfma_f32_32x32x16_bf16 v[112:127], a[156:159], v[204:207], v[112:127]
    v_cvt_pk_bf16_f32 v194, v212, v213
    v_exp_f32 v208, v136
    v_add_f32 v218, v218, v214
    v_mfma_f32_32x32x16_bf16 v[144:159], a[96:99], a[4:7], v[176:191]
    buffer_load_dwordx4 v220, s[12:15], s27 offen offset:2048 sc1 lds
    v_add_f32 v218, v218, v215
    v_exp_f32 v209, v137
    v_mfma_f32_32x32x16_bf16 v[144:159], a[100:103], a[12:15], v[144:159]
    v_cvt_pk_bf16_f32 v195, v214, v215
    v_exp_f32 v210, v138
    v_add_f32 v218, v218, v208
    v_mfma_f32_32x32x16_bf16 v[144:159], a[104:107], a[20:23], v[144:159]
    buffer_load_dwordx4 v220, s[12:15], s27 offen offset:3072 sc1 lds
    v_add_f32 v218, v218, v209
    v_exp_f32 v211, v139
    v_mfma_f32_32x32x16_bf16 v[144:159], a[108:111], a[28:31], v[144:159]
    s_add_u32 s27, s27, 16384
    v_cvt_pk_bf16_f32 v196, v208, v209
    v_exp_f32 v212, v140
    v_add_f32 v218, v218, v210
    v_add_f32 v218, v218, v211
    v_mfma_f32_32x32x16_bf16 v[144:159], a[112:115], a[36:39], v[144:159]
    v_exp_f32 v213, v141
    v_cvt_pk_bf16_f32 v197, v210, v211
    v_exp_f32 v214, v142
    v_mfma_f32_32x32x16_bf16 v[144:159], a[116:119], a[44:47], v[144:159]
    v_add_f32 v218, v218, v212
    v_add_f32 v218, v218, v213
    v_exp_f32 v215, v143
    v_mfma_f32_32x32x16_bf16 v[144:159], a[120:123], a[52:55], v[144:159]
    v_cvt_pk_bf16_f32 v198, v212, v213
    v_add_f32 v218, v218, v214
    v_add_f32 v218, v218, v215
    v_cmp_lt_f32 vcc, s30, v218
    v_cvt_pk_bf16_f32 v199, v214, v215
    v_mfma_f32_32x32x16_bf16 v[144:159], a[124:127], a[60:63], v[144:159]
    s_cbranch_vccnz KA_TR5
KA_RET5:
    v_add_f32 v216, v216, v218
    ds_read_b128 a[128:131], v220 offset:40960
    v_mfma_f32_32x32x16_bf16 v[0:15], a[160:163], v[192:195], v[0:15]
    ds_read_b128 a[132:135], v220 offset:41984
    ds_read_b128 a[136:139], v220 offset:43008
    ds_read_b128 a[140:143], v220 offset:44032
    ds_read_b128 a[144:147], v220 offset:45056
    v_mfma_f32_32x32x16_bf16 v[32:47], a[164:167], v[192:195], v[32:47]
    ds_read_b128 a[148:151], v220 offset:46080
    ds_read_b128 a[152:155], v220 offset:47104
    ds_read_b128 a[156:159], v220 offset:48128
    v_exp_f32 v208, v144
    v_mfma_f32_32x32x16_bf16 v[64:79], a[168:171], v[192:195], v[64:79]
    v_exp_f32 v209, v145
    v_exp_f32 v210, v146
    v_mfma_f32_32x32x16_bf16 v[96:111], a[172:175], v[192:195], v[96:111]
    v_add_f32 v219, v208, v209
    v_exp_f32 v211, v147
    v_cvt_pk_bf16_f32 v200, v208, v209
    v_mfma_f32_32x32x16_bf16 v[0:15], a[176:179], v[196:199], v[0:15]
    v_exp_f32 v212, v148
    v_add_f32 v219, v219, v210
    v_add_f32 v219, v219, v211
    v_mfma_f32_32x32x16_bf16 v[32:47], a[180:183], v[196:199], v[32:47]
    v_exp_f32 v213, v149
    v_cvt_pk_bf16_f32 v201, v210, v211
    v_exp_f32 v214, v150
    v_mfma_f32_32x32x16_bf16 v[64:79], a[184:187], v[196:199], v[64:79]
    v_add_f32 v219, v219, v212
    v_add_f32 v219, v219, v213
    v_exp_f32 v215, v151
    v_cvt_pk_bf16_f32 v202, v212, v213
    v_mfma_f32_32x32x16_bf16 v[96:111], a[188:191], v[196:199], v[96:111]
    s_waitcnt lgkmcnt(0)
    v_exp_f32 v208, v152
    v_add_f32 v219, v219, v214
    v_add_f32 v219, v219, v215
    v_mfma_f32_32x32x16_bf16 v[128:143], a[64:67], a[0:3], v[160:175]
    s_waitcnt vmcnt(9)
    s_barrier
    v_mfma_f32_32x32x16_bf16 v[128:143], a[68:71], a[8:11], v[128:143]
    v_exp_f32 v209, v153
    v_cvt_pk_bf16_f32 v203, v214, v215
    v_exp_f32 v210, v154
    v_mfma_f32_32x32x16_bf16 v[128:143], a[72:75], a[16:19], v[128:143]
    v_add_f32 v219, v219, v208
    v_add_f32 v219, v219, v209
    v_exp_f32 v211, v155
    v_mfma_f32_32x32x16_bf16 v[128:143], a[76:79], a[24:27], v[128:143]
    v_cvt_pk_bf16_f32 v204, v208, v209
    v_exp_f32 v212, v156
    v_add_f32 v219, v219, v210
    v_add_f32 v219, v219, v211
    v_mfma_f32_32x32x16_bf16 v[128:143], a[80:83], a[32:35], v[128:143]
    v_exp_f32 v213, v157
    v_cvt_pk_bf16_f32 v205, v210, v211
    v_exp_f32 v214, v158
    v_mfma_f32_32x32x16_bf16 v[128:143], a[84:87], a[40:43], v[128:143]
    v_add_f32 v219, v219, v212
    v_add_f32 v219, v219, v213
    v_exp_f32 v215, v159
    v_mfma_f32_32x32x16_bf16 v[128:143], a[88:91], a[48:51], v[128:143]
    v_cvt_pk_bf16_f32 v206, v212, v213
    v_add_f32 v219, v219, v214
    v_add_f32 v219, v219, v215
    v_cmp_lt_f32 vcc, s30, v219
    v_cvt_pk_bf16_f32 v207, v214, v215
    v_mfma_f32_32x32x16_bf16 v[128:143], a[92:95], a[56:59], v[128:143]
    s_cbranch_vccnz KA_TR6
KA_RET6:
    v_add_f32 v217, v217, v219
    ds_read_b128 a[96:99], v220 offset:49152
    v_mfma_f32_32x32x16_bf16 v[16:31], a[160:163], v[200:203], v[16:31]
    ds_read_b128 a[100:103], v220 offset:50176
    ds_read_b128 a[104:107], v220 offset:51200
    ds_read_b128 a[108:111], v220 offset:52224
    ds_read_b128 a[112:115], v220 offset:53248
    v_mfma_f32_32x32x16_bf16 v[48:63], a[164:167], v[200:203], v[48:63]
    ds_read_b128 a[116:119], v220 offset:54272
    ds_read_b128 a[120:123], v220 offset:55296
    ds_read_b128 a[124:127], v220 offset:56320
    v_exp_f32 v208, v128
    v_mfma_f32_32x32x16_bf16 v[80:95], a[168:171], v[200:203], v[80:95]
    s_add_u32 m0, s26, 32768
    v_exp_f32 v209, v129
    v_exp_f32 v210, v130
    v_add_f32 v218, v208, v209
    v_mfma_f32_32x32x16_bf16 v[112:127], a[172:175], v[200:203], v[112:127]
    v_exp_f32 v211, v131
    v_cvt_pk_bf16_f32 v192, v208, v209
    v_exp_f32 v212, v132
    v_mfma_f32_32x32x16_bf16 v[16:31], a[176:179], v[204:207], v[16:31]
    buffer_load_dwordx4 v220, s[12:15], s27 offen offset:0 sc1 lds
    v_add_f32 v218, v218, v210
    v_add_f32 v218, v218, v211
    v_mfma_f32_32x32x16_bf16 v[48:63], a[180:183], v[204:207], v[48:63]
    v_exp_f32 v213, v133
    v_cvt_pk_bf16_f32 v193, v210, v211
    v_exp_f32 v214, v134
    v_mfma_f32_32x32x16_bf16 v[80:95], a[184:187], v[204:207], v[80:95]
    buffer_load_dwordx4 v220, s[12:15], s27 offen offset:1024 sc1 lds
    v_add_f32 v218, v218, v212
    v_add_f32 v218, v218, v213
    v_exp_f32 v215, v135
    v_mfma_f32_32x32x16_bf16 v[112:127], a[188:191], v[204:207], v[112:127]
    v_cvt_pk_bf16_f32 v194, v212, v213
    v_exp_f32 v208, v136
    v_add_f32 v218, v218, v214
    v_mfma_f32_32x32x16_bf16 v[144:159], a[64:67], a[4:7], v[176:191]
    buffer_load_dwordx4 v220, s[12:15], s27 offen offset:2048 sc1 lds
    v_add_f32 v218, v218, v215
    v_exp_f32 v209, v137
    v_mfma_f32_32x32x16_bf16 v[144:159], a[68:71], a[12:15], v[144:159]
    v_cvt_pk_bf16_f32 v195, v214, v215
    v_exp_f32 v210, v138
    v_add_f32 v218, v218, v208
    v_mfma_f32_32x32x16_bf16 v[144:159], a[72:75], a[20:23], v[144:159]
    buffer_load_dwordx4 v220, s[12:15], s27 offen offset:3072 sc1 lds
    v_add_f32 v218, v218, v209
    v_exp_f32 v211, v139
    v_mfma_f32_32x32x16_bf16 v[144:159], a[76:79], a[28:31], v[144:159]
    s_add_u32 s27, s27, 16384
    v_cvt_pk_bf16_f32 v196, v208, v209
    v_exp_f32 v212, v140
    v_add_f32 v218, v218, v210
    v_add_f32 v218, v218, v211
    v_mfma_f32_32x32x16_bf16 v[144:159], a[80:83], a[36:39], v[144:159]
    v_exp_f32 v213, v141
    v_cvt_pk_bf16_f32 v197, v210, v211
    v_exp_f32 v214, v142
    v_mfma_f32_32x32x16_bf16 v[144:159], a[84:87], a[44:47], v[144:159]
    v_add_f32 v218, v218, v212
    v_add_f32 v218, v218, v213
    v_exp_f32 v215, v143
    v_mfma_f32_32x32x16_bf16 v[144:159], a[88:91], a[52:55], v[144:159]
    v_cvt_pk_bf16_f32 v198, v212, v213
    v_add_f32 v218, v218, v214
    v_add_f32 v218, v218, v215
    v_cmp_lt_f32 vcc, s30, v218
    v_cvt_pk_bf16_f32 v199, v214, v215
    v_mfma_f32_32x32x16_bf16 v[144:159], a[92:95], a[60:63], v[144:159]
    s_cbranch_vccnz KA_TR7
KA_RET7:
    v_add_f32 v216, v216, v218
    ds_read_b128 a[160:163], v220 offset:57344
    v_mfma_f32_32x32x16_bf16 v[0:15], a[128:131], v[192:195], v[0:15]
    ds_read_b128 a[164:167], v220 offset:58368
    ds_read_b128 a[168:171], v220 offset:59392
    ds_read_b128 a[172:175], v220 offset:60416
    ds_read_b128 a[176:179], v220 offset:61440
    v_mfma_f32_32x32x16_bf16 v[32:47], a[132:135], v[192:195], v[32:47]
    ds_read_b128 a[180:183], v220 offset:62464
    ds_read_b128 a[184:187], v220 offset:63488
    ds_read_b128 a[188:191], v220 offset:64512
    v_exp_f32 v208, v144
    v_mfma_f32_32x32x16_bf16 v[64:79], a[136:139], v[192:195], v[64:79]
    v_exp_f32 v209, v145
    v_exp_f32 v210, v146
    v_mfma_f32_32x32x16_bf16 v[96:111], a[140:143], v[192:195], v[96:111]
    v_add_f32 v219, v208, v209
    v_exp_f32 v211, v147
    v_cvt_pk_bf16_f32 v200, v208, v209
    v_mfma_f32_32x32x16_bf16 v[0:15], a[144:147], v[196:199], v[0:15]
    v_exp_f32 v212, v148
    v_add_f32 v219, v219, v210
    v_add_f32 v219, v219, v211
    v_mfma_f32_32x32x16_bf16 v[32:47], a[148:151], v[196:199], v[32:47]
    v_exp_f32 v213, v149
    v_cvt_pk_bf16_f32 v201, v210, v211
    v_exp_f32 v214, v150
    v_mfma_f32_32x32x16_bf16 v[64:79], a[152:155], v[196:199], v[64:79]
    v_add_f32 v219, v219, v212
    v_add_f32 v219, v219, v213
    v_exp_f32 v215, v151
    v_cvt_pk_bf16_f32 v202, v212, v213
    v_mfma_f32_32x32x16_bf16 v[96:111], a[156:159], v[196:199], v[96:111]
    s_waitcnt lgkmcnt(0)
    v_exp_f32 v208, v152
    v_add_f32 v219, v219, v214
    v_add_f32 v219, v219, v215
    v_mfma_f32_32x32x16_bf16 v[128:143], a[96:99], a[0:3], v[160:175]
    s_waitcnt vmcnt(9)
    s_barrier
    v_mfma_f32_32x32x16_bf16 v[128:143], a[100:103], a[8:11], v[128:143]
    s_mov_b32 s48, s76
    v_exp_f32 v209, v153
    v_cvt_pk_bf16_f32 v203, v214, v215
    v_exp_f32 v210, v154
    v_mfma_f32_32x32x16_bf16 v[128:143], a[104:107], a[16:19], v[128:143]
    s_mov_b32 s49, s77
    v_add_f32 v219, v219, v208
    v_add_f32 v219, v219, v209
    v_exp_f32 v211, v155
    v_mfma_f32_32x32x16_bf16 v[128:143], a[108:111], a[24:27], v[128:143]
    s_mov_b32 s50, 1835008
    v_cvt_pk_bf16_f32 v204, v208, v209
    v_exp_f32 v212, v156
    v_add_f32 v219, v219, v210
    v_add_f32 v219, v219, v211
    v_mfma_f32_32x32x16_bf16 v[128:143], a[112:115], a[32:35], v[128:143]
    s_mov_b32 s51, 0x20000
    v_exp_f32 v213, v157
    v_cvt_pk_bf16_f32 v205, v210, v211
    v_exp_f32 v214, v158
    v_mfma_f32_32x32x16_bf16 v[128:143], a[116:119], a[40:43], v[128:143]
    s_mul_i32 s52, s53, 1792
    v_add_f32 v219, v219, v212
    v_add_f32 v219, v219, v213
    v_exp_f32 v215, v159
    v_mfma_f32_32x32x16_bf16 v[128:143], a[120:123], a[48:51], v[128:143]
    v_cvt_pk_bf16_f32 v206, v212, v213
    v_add_f32 v219, v219, v214
    v_add_f32 v219, v219, v215
    v_cmp_lt_f32 vcc, s30, v219
    v_cvt_pk_bf16_f32 v207, v214, v215
    v_mfma_f32_32x32x16_bf16 v[128:143], a[124:127], a[56:59], v[128:143]
    s_cbranch_vccnz KA_TR8
KA_RET8:
    v_add_f32 v217, v217, v219
    ds_read_b128 a[64:67], v220 offset:0
    v_mfma_f32_32x32x16_bf16 v[16:31], a[128:131], v[200:203], v[16:31]
    ds_read_b128 a[68:71], v220 offset:1024
    ds_read_b128 a[72:75], v220 offset:2048
    ds_read_b128 a[76:79], v220 offset:3072
    ds_read_b128 a[80:83], v220 offset:4096
    buffer_load_dword a252, v243, s[48:51], s52 offen
    v_mfma_f32_32x32x16_bf16 v[48:63], a[132:135], v[200:203], v[48:63]
    ds_read_b128 a[84:87], v220 offset:5120
    ds_read_b128 a[88:91], v220 offset:6144
    ds_read_b128 a[92:95], v220 offset:7168
    v_exp_f32 v208, v128
    v_mfma_f32_32x32x16_bf16 v[80:95], a[136:139], v[200:203], v[80:95]
    s_add_u32 m0, s26, 49152
    v_exp_f32 v209, v129
    v_exp_f32 v210, v130
    v_add_f32 v218, v208, v209
    v_mfma_f32_32x32x16_bf16 v[112:127], a[140:143], v[200:203], v[112:127]
    v_exp_f32 v211, v131
    v_cvt_pk_bf16_f32 v192, v208, v209
    v_exp_f32 v212, v132
    v_mfma_f32_32x32x16_bf16 v[16:31], a[144:147], v[204:207], v[16:31]
    buffer_load_dwordx4 v220, s[12:15], s27 offen offset:0 sc1 lds
    v_add_f32 v218, v218, v210
    v_add_f32 v218, v218, v211
    v_mfma_f32_32x32x16_bf16 v[48:63], a[148:151], v[204:207], v[48:63]
    v_exp_f32 v213, v133
    v_cvt_pk_bf16_f32 v193, v210, v211
    v_exp_f32 v214, v134
    v_mfma_f32_32x32x16_bf16 v[80:95], a[152:155], v[204:207], v[80:95]
    buffer_load_dwordx4 v220, s[12:15], s27 offen offset:1024 sc1 lds
    v_add_f32 v218, v218, v212
    v_add_f32 v218, v218, v213
    v_exp_f32 v215, v135
    v_mfma_f32_32x32x16_bf16 v[112:127], a[156:159], v[204:207], v[112:127]
    v_cvt_pk_bf16_f32 v194, v212, v213
    v_exp_f32 v208, v136
    v_add_f32 v218, v218, v214
    v_mfma_f32_32x32x16_bf16 v[144:159], a[96:99], a[4:7], v[176:191]
    buffer_load_dwordx4 v220, s[12:15], s27 offen offset:2048 sc1 lds
    v_add_f32 v218, v218, v215
    v_exp_f32 v209, v137
    v_mfma_f32_32x32x16_bf16 v[144:159], a[100:103], a[12:15], v[144:159]
    v_cvt_pk_bf16_f32 v195, v214, v215
    v_exp_f32 v210, v138
    v_add_f32 v218, v218, v208
    v_mfma_f32_32x32x16_bf16 v[144:159], a[104:107], a[20:23], v[144:159]
    buffer_load_dwordx4 v220, s[12:15], s27 offen offset:3072 sc1 lds
    v_add_f32 v218, v218, v209
    v_exp_f32 v211, v139
    v_mfma_f32_32x32x16_bf16 v[144:159], a[108:111], a[28:31], v[144:159]
    s_add_u32 s27, s27, 16384
    v_cvt_pk_bf16_f32 v196, v208, v209
    v_exp_f32 v212, v140
    v_add_f32 v218, v218, v210
    v_add_f32 v218, v218, v211
    v_mfma_f32_32x32x16_bf16 v[144:159], a[112:115], a[36:39], v[144:159]
    v_exp_f32 v213, v141
    v_cvt_pk_bf16_f32 v197, v210, v211
    v_exp_f32 v214, v142
    v_mfma_f32_32x32x16_bf16 v[144:159], a[116:119], a[44:47], v[144:159]
    v_add_f32 v218, v218, v212
    v_add_f32 v218, v218, v213
    v_exp_f32 v215, v143
    v_mfma_f32_32x32x16_bf16 v[144:159], a[120:123], a[52:55], v[144:159]
    v_cvt_pk_bf16_f32 v198, v212, v213
    v_add_f32 v218, v218, v214
    v_add_f32 v218, v218, v215
    v_cmp_lt_f32 vcc, s30, v218
    v_cvt_pk_bf16_f32 v199, v214, v215
    v_mfma_f32_32x32x16_bf16 v[144:159], a[124:127], a[60:63], v[144:159]
    s_cbranch_vccnz KA_TR9
KA_RET9:
    v_add_f32 v216, v216, v218
    ds_read_b128 a[128:131], v220 offset:8192
    v_mfma_f32_32x32x16_bf16 v[0:15], a[160:163], v[192:195], v[0:15]
    ds_read_b128 a[132:135], v220 offset:9216
    ds_read_b128 a[136:139], v220 offset:10240
    ds_read_b128 a[140:143], v220 offset:11264
    ds_read_b128 a[144:147], v220 offset:12288
    v_mfma_f32_32x32x16_bf16 v[32:47], a[164:167], v[192:195], v[32:47]
    ds_read_b128 a[148:151], v220 offset:13312
    ds_read_b128 a[152:155], v220 offset:14336
    ds_read_b128 a[156:159], v220 offset:15360
    v_exp_f32 v208, v144
    v_mfma_f32_32x32x16_bf16 v[64:79], a[168:171], v[192:195], v[64:79]
    v_exp_f32 v209, v145
    v_exp_f32 v210, v146
    v_mfma_f32_32x32x16_bf16 v[96:111], a[172:175], v[192:195], v[96:111]
    v_add_f32 v219, v208, v209
    v_exp_f32 v211, v147
    v_cvt_pk_bf16_f32 v200, v208, v209
    v_mfma_f32_32x32x16_bf16 v[0:15], a[176:179], v[196:199], v[0:15]
    v_exp_f32 v212, v148
    v_add_f32 v219, v219, v210
    v_add_f32 v219, v219, v211
    v_mfma_f32_32x32x16_bf16 v[32:47], a[180:183], v[196:199], v[32:47]
    v_exp_f32 v213, v149
    v_cvt_pk_bf16_f32 v201, v210, v211
    v_exp_f32 v214, v150
    v_mfma_f32_32x32x16_bf16 v[64:79], a[184:187], v[196:199], v[64:79]
    v_add_f32 v219, v219, v212
    v_add_f32 v219, v219, v213
    v_exp_f32 v215, v151
    v_cvt_pk_bf16_f32 v202, v212, v213
    v_mfma_f32_32x32x16_bf16 v[96:111], a[188:191], v[196:199], v[96:111]
    s_waitcnt lgkmcnt(0)
    v_exp_f32 v208, v152
    v_add_f32 v219, v219, v214
    v_add_f32 v219, v219, v215
    v_mfma_f32_32x32x16_bf16 v[128:143], a[64:67], a[0:3], v[160:175]
    s_waitcnt vmcnt(9)
    s_barrier
    v_mfma_f32_32x32x16_bf16 v[128:143], a[68:71], a[8:11], v[128:143]
    v_exp_f32 v209, v153
    v_cvt_pk_bf16_f32 v203, v214, v215
    v_exp_f32 v210, v154
    v_mfma_f32_32x32x16_bf16 v[128:143], a[72:75], a[16:19], v[128:143]
    v_add_f32 v219, v219, v208
    v_add_f32 v219, v219, v209
    v_exp_f32 v211, v155
    v_mfma_f32_32x32x16_bf16 v[128:143], a[76:79], a[24:27], v[128:143]
    v_cvt_pk_bf16_f32 v204, v208, v209
    v_exp_f32 v212, v156
    v_add_f32 v219, v219, v210
    v_add_f32 v219, v219, v211
    v_mfma_f32_32x32x16_bf16 v[128:143], a[80:83], a[32:35], v[128:143]
    v_exp_f32 v213, v157
    v_cvt_pk_bf16_f32 v205, v210, v211
    v_exp_f32 v214, v158
    v_mfma_f32_32x32x16_bf16 v[128:143], a[84:87], a[40:43], v[128:143]
    v_add_f32 v219, v219, v212
    v_add_f32 v219, v219, v213
    v_exp_f32 v215, v159
    v_mfma_f32_32x32x16_bf16 v[128:143], a[88:91], a[48:51], v[128:143]
    v_cvt_pk_bf16_f32 v206, v212, v213
    v_add_f32 v219, v219, v214
    v_add_f32 v219, v219, v215
    v_cmp_lt_f32 vcc, s30, v219
    v_cvt_pk_bf16_f32 v207, v214, v215
    v_mfma_f32_32x32x16_bf16 v[128:143], a[92:95], a[56:59], v[128:143]
    s_cbranch_vccnz KA_TR10
KA_RET10:
    v_add_f32 v217, v217, v219
    ds_read_b128 a[96:99], v220 offset:16384
    v_mfma_f32_32x32x16_bf16 v[16:31], a[160:163], v[200:203], v[16:31]
    ds_read_b128 a[100:103], v220 offset:17408
    ds_read_b128 a[104:107], v220 offset:18432
    ds_read_b128 a[108:111], v220 offset:19456
    ds_read_b128 a[112:115], v220 offset:20480
    v_mfma_f32_32x32x16_bf16 v[48:63], a[164:167], v[200:203], v[48:63]
    ds_read_b128 a[116:119], v220 offset:21504
    ds_read_b128 a[120:123], v220 offset:22528
    ds_read_b128 a[124:127], v220 offset:23552
    v_exp_f32 v208, v128
    v_mfma_f32_32x32x16_bf16 v[80:95], a[168:171], v[200:203], v[80:95]
    s_add_u32 m0, s26, 0
    v_exp_f32 v209, v129
    v_exp_f32 v210, v130
    v_add_f32 v218, v208, v209
    v_mfma_f32_32x32x16_bf16 v[112:127], a[172:175], v[200:203], v[112:127]
    v_exp_f32 v211, v131
    v_cvt_pk_bf16_f32 v192, v208, v209
    v_exp_f32 v212, v132
    v_mfma_f32_32x32x16_bf16 v[16:31], a[176:179], v[204:207], v[16:31]
    buffer_load_dwordx4 v220, s[12:15], s27 offen offset:0 sc1 lds
    v_add_f32 v218, v218, v210
    v_add_f32 v218, v218, v211
    v_exp_f32 v213, v133
    v_mfma_f32_32x32x16_bf16 v[48:63], a[180:183], v[204:207], v[48:63]
    v_cvt_pk_bf16_f32 v193, v210, v211
    v_exp_f32 v214, v134
    v_add_f32 v218, v218, v212
    v_add_f32 v218, v218, v213
    v_mfma_f32_32x32x16_bf16 v[80:95], a[184:187], v[204:207], v[80:95]
    buffer_load_dwordx4 v220, s[12:15], s27 offen offset:1024 sc1 lds
    v_exp_f32 v215, v135
    v_cvt_pk_bf16_f32 v194, v212, v213
    v_mfma_f32_32x32x16_bf16 v[112:127], a[188:191], v[204:207], v[112:127]
    v_exp_f32 v208, v136
    v_add_f32 v218, v218, v214
    v_add_f32 v218, v218, v215
    v_mfma_f32_32x32x16_bf16 v[144:159], a[64:67], a[4:7], v[176:191]
    buffer_load_dwordx4 v220, s[12:15], s27 offen offset:2048 sc1 lds
    v_exp_f32 v209, v137
    v_cvt_pk_bf16_f32 v195, v214, v215
    v_mfma_f32_32x32x16_bf16 v[144:159], a[68:71], a[12:15], v[144:159]
    v_exp_f32 v210, v138
    v_add_f32 v218, v218, v208
    v_add_f32 v218, v218, v209
    v_exp_f32 v211, v139
    v_mfma_f32_32x32x16_bf16 v[144:159], a[72:75], a[20:23], v[144:159]
    buffer_load_dwordx4 v220, s[12:15], s27 offen offset:3072 sc1 lds
    v_cvt_pk_bf16_f32 v196, v208, v209
    v_exp_f32 v212, v140
    v_mfma_f32_32x32x16_bf16 v[144:159], a[76:79], a[28:31], v[144:159]
    s_add_u32 s27, s27, 16384
    v_add_f32 v218, v218, v210
    v_add_f32 v218, v218, v211
    v_exp_f32 v213, v141
    v_cvt_pk_bf16_f32 v197, v210, v211
    v_mfma_f32_32x32x16_bf16 v[144:159], a[80:83], a[36:39], v[144:159]
    buffer_load_dwordx2 a[192:193], v229, s[56:59], s43 offen offset:0
    v_exp_f32 v214, v142
    v_add_f32 v218, v218, v212
    v_mfma_f32_32x32x16_bf16 v[144:159], a[84:87], a[44:47], v[144:159]
    v_add_f32 v218, v218, v213
    v_exp_f32 v215, v143
    v_cvt_pk_bf16_f32 v198, v212, v213
    v_add_f32 v218, v218, v214
    v_mfma_f32_32x32x16_bf16 v[144:159], a[88:91], a[52:55], v[144:159]
    buffer_load_dwordx2 a[194:195], v229, s[56:59], s43 offen offset:32
    v_add_f32 v218, v218, v215
    v_cmp_lt_f32 vcc, s30, v218
    v_cvt_pk_bf16_f32 v199, v214, v215
    v_mfma_f32_32x32x16_bf16 v[144:159], a[92:95], a[60:63], v[144:159]
    s_cbranch_vccnz KA_TR11
KA_RET11:
    v_add_f32 v216, v216, v218
    ds_read_b128 a[160:163], v220 offset:24576
    v_mfma_f32_32x32x16_bf16 v[0:15], a[128:131], v[192:195], v[0:15]
    ds_read_b128 a[164:167], v220 offset:25600
    ds_read_b128 a[168:171], v220 offset:26624
    ds_read_b128 a[172:175], v220 offset:27648
    ds_read_b128 a[176:179], v220 offset:28672
    v_mfma_f32_32x32x16_bf16 v[32:47], a[132:135], v[192:195], v[32:47]
    ds_read_b128 a[180:183], v220 offset:29696
    ds_read_b128 a[184:187], v220 offset:30720
    ds_read_b128 a[188:191], v220 offset:31744
    v_exp_f32 v208, v144
    v_mfma_f32_32x32x16_bf16 v[64:79], a[136:139], v[192:195], v[64:79]
    v_exp_f32 v209, v145
    v_exp_f32 v210, v146
    v_add_f32 v219, v208, v209
    v_mfma_f32_32x32x16_bf16 v[96:111], a[140:143], v[192:195], v[96:111]
    buffer_load_dwordx2 a[196:197], v229, s[56:59], s43 offen offset:128
    v_exp_f32 v211, v147
    v_cvt_pk_bf16_f32 v200, v208, v209
    v_mfma_f32_32x32x16_bf16 v[0:15], a[144:147], v[196:199], v[0:15]
    v_exp_f32 v212, v148
    v_add_f32 v219, v219, v210
    v_add_f32 v219, v219, v211
    v_exp_f32 v213, v149
    v_mfma_f32_32x32x16_bf16 v[32:47], a[148:151], v[196:199], v[32:47]
    buffer_load_dwordx2 a[198:199], v229, s[56:59], s43 offen offset:160
    v_cvt_pk_bf16_f32 v201, v210, v211
    v_exp_f32 v214, v150
    v_mfma_f32_32x32x16_bf16 v[64:79], a[152:155], v[196:199], v[64:79]
    v_add_f32 v219, v219, v212
    v_add_f32 v219, v219, v213
    v_exp_f32 v215, v151
    v_mfma_f32_32x32x16_bf16 v[96:111], a[156:159], v[196:199], v[96:111]
    s_waitcnt lgkmcnt(0)
    v_cvt_pk_bf16_f32 v202, v212, v213
    v_exp_f32 v208, v152
    v_add_f32 v219, v219, v214
    v_add_f32 v219, v219, v215
    v_mfma_f32_32x32x16_bf16 v[128:143], a[96:99], a[0:3], v[160:175]
    s_waitcnt vmcnt(13)
    s_barrier
    v_mfma_f32_32x32x16_bf16 v[128:143], a[100:103], a[8:11], v[128:143]
    s_mov_b32 s48, s78
    v_exp_f32 v209, v153
    v_cvt_pk_bf16_f32 v203, v214, v215
    v_exp_f32 v210, v154
    v_mfma_f32_32x32x16_bf16 v[128:143], a[104:107], a[16:19], v[128:143]
    s_mov_b32 s49, s79
    v_add_f32 v219, v219, v208
    v_add_f32 v219, v219, v209
    v_exp_f32 v211, v155
    v_mfma_f32_32x32x16_bf16 v[128:143], a[108:111], a[24:27], v[128:143]
    v_cvt_pk_bf16_f32 v204, v208, v209
    v_exp_f32 v212, v156
    v_add_f32 v219, v219, v210
    v_add_f32 v219, v219, v211
    v_mfma_f32_32x32x16_bf16 v[128:143], a[112:115], a[32:35], v[128:143]
    v_exp_f32 v213, v157
    v_cvt_pk_bf16_f32 v205, v210, v211
    v_exp_f32 v214, v158
    v_mfma_f32_32x32x16_bf16 v[128:143], a[116:119], a[40:43], v[128:143]
    v_add_f32 v219, v219, v212
    v_add_f32 v219, v219, v213
    v_exp_f32 v215, v159
    v_mfma_f32_32x32x16_bf16 v[128:143], a[120:123], a[48:51], v[128:143]
    v_cvt_pk_bf16_f32 v206, v212, v213
    v_add_f32 v219, v219, v214
    v_add_f32 v219, v219, v215
    v_cmp_lt_f32 vcc, s30, v219
    v_cvt_pk_bf16_f32 v207, v214, v215
    v_mfma_f32_32x32x16_bf16 v[128:143], a[124:127], a[56:59], v[128:143]
    s_cbranch_vccnz KA_TR12
KA_RET12:
    v_add_f32 v217, v217, v219
    ds_read_b128 a[64:67], v220 offset:32768
    v_mfma_f32_32x32x16_bf16 v[16:31], a[128:131], v[200:203], v[16:31]
    ds_read_b128 a[68:71], v220 offset:33792
    ds_read_b128 a[72:75], v220 offset:34816
    ds_read_b128 a[76:79], v220 offset:35840
    ds_read_b128 a[80:83], v220 offset:36864
    buffer_load_dword a252, v243, s[48:51], s52 offen
    v_mfma_f32_32x32x16_bf16 v[48:63], a[132:135], v[200:203], v[48:63]
    ds_read_b128 a[84:87], v220 offset:37888
    ds_read_b128 a[88:91], v220 offset:38912
    ds_read_b128 a[92:95], v220 offset:39936
    v_exp_f32 v208, v128
    v_mfma_f32_32x32x16_bf16 v[80:95], a[136:139], v[200:203], v[80:95]
    s_add_u32 m0, s26, 16384
    v_exp_f32 v209, v129
    v_exp_f32 v210, v130
    v_add_f32 v218, v208, v209
    v_mfma_f32_32x32x16_bf16 v[112:127], a[140:143], v[200:203], v[112:127]
    v_exp_f32 v211, v131
    v_cvt_pk_bf16_f32 v192, v208, v209
    v_exp_f32 v212, v132
    v_mfma_f32_32x32x16_bf16 v[16:31], a[144:147], v[204:207], v[16:31]
    buffer_load_dwordx4 v220, s[12:15], s27 offen offset:0 sc1 lds
    v_add_f32 v218, v218, v210
    v_add_f32 v218, v218, v211
    v_exp_f32 v213, v133
    v_mfma_f32_32x32x16_bf16 v[48:63], a[148:151], v[204:207], v[48:63]
    v_cvt_pk_bf16_f32 v193, v210, v211
    v_exp_f32 v214, v134
    v_add_f32 v218, v218, v212
    v_add_f32 v218, v218, v213
    v_mfma_f32_32x32x16_bf16 v[80:95], a[152:155], v[204:207], v[80:95]
    buffer_load_dwordx4 v220, s[12:15], s27 offen offset:1024 sc1 lds
    v_exp_f32 v215, v135
    v_cvt_pk_bf16_f32 v194, v212, v213
    v_mfma_f32_32x32x16_bf16 v[112:127], a[156:159], v[204:207], v[112:127]
    v_exp_f32 v208, v136
    v_add_f32 v218, v218, v214
    v_add_f32 v218, v218, v215
    v_mfma_f32_32x32x16_bf16 v[144:159], a[96:99], a[4:7], v[176:191]
    buffer_load_dwordx4 v220, s[12:15], s27 offen offset:2048 sc1 lds
    v_exp_f32 v209, v137
    v_cvt_pk_bf16_f32 v195, v214, v215
    v_mfma_f32_32x32x16_bf16 v[144:159], a[100:103], a[12:15], v[144:159]
    v_exp_f32 v210, v138
    v_add_f32 v218, v218, v208
    v_add_f32 v218, v218, v209
    v_exp_f32 v211, v139
    v_mfma_f32_32x32x16_bf16 v[144:159], a[104:107], a[20:23], v[144:159]
    buffer_load_dwordx4 v220, s[12:15], s27 offen offset:3072 sc1 lds
    v_cvt_pk_bf16_f32 v196, v208, v209
    v_exp_f32 v212, v140
    v_mfma_f32_32x32x16_bf16 v[144:159], a[108:111], a[28:31], v[144:159]
    s_add_u32 s27, s27, 16384
    v_add_f32 v218, v218, v210
    v_add_f32 v218, v218, v211
    v_exp_f32 v213, v141
    v_cvt_pk_bf16_f32 v197, v210, v211
    v_mfma_f32_32x32x16_bf16 v[144:159], a[112:115], a[36:39], v[144:159]
    buffer_load_dwordx4 a[200:203], v231, s[12:15], s32 offen offset:0 sc1
    v_exp_f32 v214, v142
    v_add_f32 v218, v218, v212
    v_mfma_f32_32x32x16_bf16 v[144:159], a[116:119], a[44:47], v[144:159]
    v_add_f32 v218, v218, v213
    v_exp_f32 v215, v143
    v_cvt_pk_bf16_f32 v198, v212, v213
    v_add_f32 v218, v218, v214
    v_mfma_f32_32x32x16_bf16 v[144:159], a[120:123], a[52:55], v[144:159]
    buffer_load_dwordx4 a[216:219], v231, s[12:15], s32 offen offset:2048 sc1
    v_add_f32 v218, v218, v215
    v_cmp_lt_f32 vcc, s30, v218
    v_cvt_pk_bf16_f32 v199, v214, v215
    v_mfma_f32_32x32x16_bf16 v[144:159], a[124:127], a[60:63], v[144:159]
    s_cbranch_vccnz KA_TR13
KA_RET13:
    v_add_f32 v216, v216, v218
    ds_read_b128 a[128:131], v220 offset:40960
    v_mfma_f32_32x32x16_bf16 v[0:15], a[160:163], v[192:195], v[0:15]
    ds_read_b128 a[132:135], v220 offset:41984
    ds_read_b128 a[136:139], v220 offset:43008
    ds_read_b128 a[140:143], v220 offset:44032
    ds_read_b128 a[144:147], v220 offset:45056
    v_mfma_f32_32x32x16_bf16 v[32:47], a[164:167], v[192:195], v[32:47]
    ds_read_b128 a[148:151], v220 offset:46080
    ds_read_b128 a[152:155], v220 offset:47104
    ds_read_b128 a[156:159], v220 offset:48128
    v_exp_f32 v208, v144
    v_mfma_f32_32x32x16_bf16 v[64:79], a[168:171], v[192:195], v[64:79]
    v_exp_f32 v209, v145
    v_exp_f32 v210, v146
    v_add_f32 v219, v208, v209
    v_mfma_f32_32x32x16_bf16 v[96:111], a[172:175], v[192:195], v[96:111]
    buffer_load_dwordx4 a[232:235], v231, s[12:15], s33 offen offset:0 sc1
    v_exp_f32 v211, v147
    v_cvt_pk_bf16_f32 v200, v208, v209
    v_mfma_f32_32x32x16_bf16 v[0:15], a[176:179], v[196:199], v[0:15]
    v_exp_f32 v212, v148
    v_add_f32 v219, v219, v210
    v_add_f32 v219, v219, v211
    v_exp_f32 v213, v149
    v_mfma_f32_32x32x16_bf16 v[32:47], a[180:183], v[196:199], v[32:47]
    buffer_load_dwordx4 a[204:207], v231, s[12:15], s32 offen offset:64 sc1
    v_cvt_pk_bf16_f32 v201, v210, v211
    v_exp_f32 v214, v150
    v_mfma_f32_32x32x16_bf16 v[64:79], a[184:187], v[196:199], v[64:79]
    v_add_f32 v219, v219, v212
    v_add_f32 v219, v219, v213
    v_exp_f32 v215, v151
    v_mfma_f32_32x32x16_bf16 v[96:111], a[188:191], v[196:199], v[96:111]
    s_waitcnt lgkmcnt(0)
    v_cvt_pk_bf16_f32 v202, v212, v213
    v_exp_f32 v208, v152
    v_add_f32 v219, v219, v214
    v_add_f32 v219, v219, v215
    v_mfma_f32_32x32x16_bf16 v[128:143], a[64:67], a[0:3], v[160:175]
    s_waitcnt vmcnt(17)
    s_barrier
    v_mfma_f32_32x32x16_bf16 v[128:143], a[68:71], a[8:11], v[128:143]
    v_exp_f32 v209, v153
    v_cvt_pk_bf16_f32 v203, v214, v215
    v_exp_f32 v210, v154
    v_mfma_f32_32x32x16_bf16 v[128:143], a[72:75], a[16:19], v[128:143]
    v_add_f32 v219, v219, v208
    v_add_f32 v219, v219, v209
    v_exp_f32 v211, v155
    v_mfma_f32_32x32x16_bf16 v[128:143], a[76:79], a[24:27], v[128:143]
    v_cvt_pk_bf16_f32 v204, v208, v209
    v_exp_f32 v212, v156
    v_add_f32 v219, v219, v210
    v_add_f32 v219, v219, v211
    v_mfma_f32_32x32x16_bf16 v[128:143], a[80:83], a[32:35], v[128:143]
    v_exp_f32 v213, v157
    v_cvt_pk_bf16_f32 v205, v210, v211
    v_exp_f32 v214, v158
    v_mfma_f32_32x32x16_bf16 v[128:143], a[84:87], a[40:43], v[128:143]
    v_add_f32 v219, v219, v212
    v_add_f32 v219, v219, v213
    v_exp_f32 v215, v159
    v_mfma_f32_32x32x16_bf16 v[128:143], a[88:91], a[48:51], v[128:143]
    v_cvt_pk_bf16_f32 v206, v212, v213
    v_add_f32 v219, v219, v214
    v_add_f32 v219, v219, v215
    v_cmp_lt_f32 vcc, s30, v219
    v_cvt_pk_bf16_f32 v207, v214, v215
    v_mfma_f32_32x32x16_bf16 v[128:143], a[92:95], a[56:59], v[128:143]
    s_cbranch_vccnz KA_TR14
KA_RET14:
    v_add_f32 v217, v217, v219
    ds_read_b128 a[96:99], v220 offset:49152
    v_mfma_f32_32x32x16_bf16 v[16:31], a[160:163], v[200:203], v[16:31]
    ds_read_b128 a[100:103], v220 offset:50176
    ds_read_b128 a[104:107], v220 offset:51200
    ds_read_b128 a[108:111], v220 offset:52224
    ds_read_b128 a[112:115], v220 offset:53248
    v_mfma_f32_32x32x16_bf16 v[48:63], a[164:167], v[200:203], v[48:63]
    ds_read_b128 a[116:119], v220 offset:54272
    ds_read_b128 a[120:123], v220 offset:55296
    ds_read_b128 a[124:127], v220 offset:56320
    v_exp_f32 v208, v128
    v_mfma_f32_32x32x16_bf16 v[80:95], a[168:171], v[200:203], v[80:95]
    s_add_u32 m0, s26, 32768
    v_exp_f32 v209, v129
    v_exp_f32 v210, v130
    v_add_f32 v218, v208, v209
    v_mfma_f32_32x32x16_bf16 v[112:127], a[172:175], v[200:203], v[112:127]
    v_exp_f32 v211, v131
    v_cvt_pk_bf16_f32 v192, v208, v209
    v_exp_f32 v212, v132
    v_mfma_f32_32x32x16_bf16 v[16:31], a[176:179], v[204:207], v[16:31]
    buffer_load_dwordx4 v220, s[12:15], s27 offen offset:0 sc1 lds
    v_add_f32 v218, v218, v210
    v_add_f32 v218, v218, v211
    v_exp_f32 v213, v133
    v_mfma_f32_32x32x16_bf16 v[48:63], a[180:183], v[204:207], v[48:63]
    v_cvt_pk_bf16_f32 v193, v210, v211
    v_exp_f32 v214, v134
    v_add_f32 v218, v218, v212
    v_add_f32 v218, v218, v213
    v_mfma_f32_32x32x16_bf16 v[80:95], a[184:187], v[204:207], v[80:95]
    buffer_load_dwordx4 v220, s[12:15], s27 offen offset:1024 sc1 lds
    v_exp_f32 v215, v135
    v_cvt_pk_bf16_f32 v194, v212, v213
    v_mfma_f32_32x32x16_bf16 v[112:127], a[188:191], v[204:207], v[112:127]
    v_exp_f32 v208, v136
    v_add_f32 v218, v218, v214
    v_add_f32 v218, v218, v215
    v_mfma_f32_32x32x16_bf16 v[144:159], a[64:67], a[4:7], v[176:191]
    buffer_load_dwordx4 v220, s[12:15], s27 offen offset:2048 sc1 lds
    v_exp_f32 v209, v137
    v_cvt_pk_bf16_f32 v195, v214, v215
    v_mfma_f32_32x32x16_bf16 v[144:159], a[68:71], a[12:15], v[144:159]
    v_exp_f32 v210, v138
    v_add_f32 v218, v218, v208
    v_add_f32 v218, v218, v209
    v_exp_f32 v211, v139
    v_mfma_f32_32x32x16_bf16 v[144:159], a[72:75], a[20:23], v[144:159]
    buffer_load_dwordx4 v220, s[12:15], s27 offen offset:3072 sc1 lds
    v_cvt_pk_bf16_f32 v196, v208, v209
    v_exp_f32 v212, v140
    v_mfma_f32_32x32x16_bf16 v[144:159], a[76:79], a[28:31], v[144:159]
    s_add_u32 s27, s27, 16384
    v_add_f32 v218, v218, v210
    v_add_f32 v218, v218, v211
    v_exp_f32 v213, v141
    v_cvt_pk_bf16_f32 v197, v210, v211
    v_mfma_f32_32x32x16_bf16 v[144:159], a[80:83], a[36:39], v[144:159]
    buffer_load_dwordx4 a[220:223], v231, s[12:15], s32 offen offset:2112 sc1
    v_exp_f32 v214, v142
    v_add_f32 v218, v218, v212
    v_mfma_f32_32x32x16_bf16 v[144:159], a[84:87], a[44:47], v[144:159]
    v_add_f32 v218, v218, v213
    v_exp_f32 v215, v143
    v_cvt_pk_bf16_f32 v198, v212, v213
    v_add_f32 v218, v218, v214
    v_mfma_f32_32x32x16_bf16 v[144:159], a[88:91], a[52:55], v[144:159]
    buffer_load_dwordx4 a[236:239], v231, s[12:15], s33 offen offset:64 sc1
    v_add_f32 v218, v218, v215
    v_cmp_lt_f32 vcc, s30, v218
    v_cvt_pk_bf16_f32 v199, v214, v215
    v_mfma_f32_32x32x16_bf16 v[144:159], a[92:95], a[60:63], v[144:159]
    s_cbranch_vccnz KA_TR15
KA_RET15:
    v_add_f32 v216, v216, v218
    ds_read_b128 a[160:163], v220 offset:57344
    v_mfma_f32_32x32x16_bf16 v[0:15], a[128:131], v[192:195], v[0:15]
    ds_read_b128 a[164:167], v220 offset:58368
    ds_read_b128 a[168:171], v220 offset:59392
    ds_read_b128 a[172:175], v220 offset:60416
    ds_read_b128 a[176:179], v220 offset:61440
    v_mfma_f32_32x32x16_bf16 v[32:47], a[132:135], v[192:195], v[32:47]
    ds_read_b128 a[180:183], v220 offset:62464
    ds_read_b128 a[184:187], v220 offset:63488
    ds_read_b128 a[188:191], v220 offset:64512
    v_exp_f32 v208, v144
    v_mfma_f32_32x32x16_bf16 v[64:79], a[136:139], v[192:195], v[64:79]
    v_exp_f32 v209, v145
    v_exp_f32 v210, v146
    v_add_f32 v219, v208, v209
    v_mfma_f32_32x32x16_bf16 v[96:111], a[140:143], v[192:195], v[96:111]
    buffer_load_dwordx4 a[208:211], v231, s[12:15], s32 offen offset:256 sc1
    v_exp_f32 v211, v147
    v_cvt_pk_bf16_f32 v200, v208, v209
    v_mfma_f32_32x32x16_bf16 v[0:15], a[144:147], v[196:199], v[0:15]
    v_exp_f32 v212, v148
    v_add_f32 v219, v219, v210
    v_add_f32 v219, v219, v211
    v_exp_f32 v213, v149
    v_mfma_f32_32x32x16_bf16 v[32:47], a[148:151], v[196:199], v[32:47]
    buffer_load_dwordx4 a[224:227], v231, s[12:15], s32 offen offset:2304 sc1
    v_cvt_pk_bf16_f32 v201, v210, v211
    v_exp_f32 v214, v150
    v_mfma_f32_32x32x16_bf16 v[64:79], a[152:155], v[196:199], v[64:79]
    v_add_f32 v219, v219, v212
    v_add_f32 v219, v219, v213
    v_exp_f32 v215, v151
    v_mfma_f32_32x32x16_bf16 v[96:111], a[156:159], v[196:199], v[96:111]
    s_waitcnt lgkmcnt(0)
    v_cvt_pk_bf16_f32 v202, v212, v213
    v_exp_f32 v208, v152
    v_add_f32 v219, v219, v214
    v_add_f32 v219, v219, v215
    v_mfma_f32_32x32x16_bf16 v[128:143], a[96:99], a[0:3], v[160:175]
    s_waitcnt vmcnt(21)
    s_barrier
    v_mfma_f32_32x32x16_bf16 v[128:143], a[100:103], a[8:11], v[128:143]
    s_mov_b32 s48, s80
    v_exp_f32 v209, v153
    v_cvt_pk_bf16_f32 v203, v214, v215
    v_exp_f32 v210, v154
    v_mfma_f32_32x32x16_bf16 v[128:143], a[104:107], a[16:19], v[128:143]
    s_mov_b32 s49, s81
    v_add_f32 v219, v219, v208
    v_add_f32 v219, v219, v209
    v_exp_f32 v211, v155
    v_mfma_f32_32x32x16_bf16 v[128:143], a[108:111], a[24:27], v[128:143]
    v_cvt_pk_bf16_f32 v204, v208, v209
    v_exp_f32 v212, v156
    v_add_f32 v219, v219, v210
    v_add_f32 v219, v219, v211
    v_mfma_f32_32x32x16_bf16 v[128:143], a[112:115], a[32:35], v[128:143]
    v_exp_f32 v213, v157
    v_cvt_pk_bf16_f32 v205, v210, v211
    v_exp_f32 v214, v158
    v_mfma_f32_32x32x16_bf16 v[128:143], a[116:119], a[40:43], v[128:143]
    v_add_f32 v219, v219, v212
    v_add_f32 v219, v219, v213
    v_exp_f32 v215, v159
    v_mfma_f32_32x32x16_bf16 v[128:143], a[120:123], a[48:51], v[128:143]
    v_cvt_pk_bf16_f32 v206, v212, v213
    v_add_f32 v219, v219, v214
    v_add_f32 v219, v219, v215
    v_cmp_lt_f32 vcc, s30, v219
    v_cvt_pk_bf16_f32 v207, v214, v215
    v_mfma_f32_32x32x16_bf16 v[128:143], a[124:127], a[56:59], v[128:143]
    s_cbranch_vccnz KA_TR16
KA_RET16:
    v_add_f32 v217, v217, v219
    ds_read_b128 a[64:67], v220 offset:0
    v_mfma_f32_32x32x16_bf16 v[16:31], a[128:131], v[200:203], v[16:31]
    ds_read_b128 a[68:71], v220 offset:1024
    ds_read_b128 a[72:75], v220 offset:2048
    ds_read_b128 a[76:79], v220 offset:3072
    ds_read_b128 a[80:83], v220 offset:4096
    buffer_load_dword a252, v243, s[48:51], s52 offen
    v_mfma_f32_32x32x16_bf16 v[48:63], a[132:135], v[200:203], v[48:63]
    ds_read_b128 a[84:87], v220 offset:5120
    ds_read_b128 a[88:91], v220 offset:6144
    ds_read_b128 a[92:95], v220 offset:7168
    v_exp_f32 v208, v128
    v_mfma_f32_32x32x16_bf16 v[80:95], a[136:139], v[200:203], v[80:95]
    s_add_u32 m0, s26, 49152
    v_exp_f32 v209, v129
    v_exp_f32 v210, v130
    v_add_f32 v218, v208, v209
    v_mfma_f32_32x32x16_bf16 v[112:127], a[140:143], v[200:203], v[112:127]
    v_exp_f32 v211, v131
    v_cvt_pk_bf16_f32 v192, v208, v209
    v_exp_f32 v212, v132
    v_mfma_f32_32x32x16_bf16 v[16:31], a[144:147], v[204:207], v[16:31]
    buffer_load_dwordx4 v220, s[12:15], s27 offen offset:0 sc1 lds
    v_add_f32 v218, v218, v210
    v_add_f32 v218, v218, v211
    v_exp_f32 v213, v133
    v_mfma_f32_32x32x16_bf16 v[48:63], a[148:151], v[204:207], v[48:63]
    v_cvt_pk_bf16_f32 v193, v210, v211
    v_exp_f32 v214, v134
    v_add_f32 v218, v218, v212
    v_add_f32 v218, v218, v213
    v_mfma_f32_32x32x16_bf16 v[80:95], a[152:155], v[204:207], v[80:95]
    buffer_load_dwordx4 v220, s[12:15], s27 offen offset:1024 sc1 lds
    v_exp_f32 v215, v135
    v_cvt_pk_bf16_f32 v194, v212, v213
    v_mfma_f32_32x32x16_bf16 v[112:127], a[156:159], v[204:207], v[112:127]
    v_exp_f32 v208, v136
    v_add_f32 v218, v218, v214
    v_add_f32 v218, v218, v215
    v_mfma_f32_32x32x16_bf16 v[144:159], a[96:99], a[4:7], v[176:191]
    buffer_load_dwordx4 v220, s[12:15], s27 offen offset:2048 sc1 lds
    v_exp_f32 v209, v137
    v_cvt_pk_bf16_f32 v195, v214, v215
    v_mfma_f32_32x32x16_bf16 v[144:159], a[100:103], a[12:15], v[144:159]
    v_exp_f32 v210, v138
    v_add_f32 v218, v218, v208
    v_add_f32 v218, v218, v209
    v_exp_f32 v211, v139
    v_mfma_f32_32x32x16_bf16 v[144:159], a[104:107], a[20:23], v[144:159]
    buffer_load_dwordx4 v220, s[12:15], s27 offen offset:3072 sc1 lds
    v_cvt_pk_bf16_f32 v196, v208, v209
    v_exp_f32 v212, v140
    v_mfma_f32_32x32x16_bf16 v[144:159], a[108:111], a[28:31], v[144:159]
    s_add_u32 s27, s27, 16384
    v_add_f32 v218, v218, v210
    v_add_f32 v218, v218, v211
    v_exp_f32 v213, v141
    v_cvt_pk_bf16_f32 v197, v210, v211
    v_mfma_f32_32x32x16_bf16 v[144:159], a[112:115], a[36:39], v[144:159]
    buffer_load_dwordx4 a[240:243], v231, s[12:15], s33 offen offset:256 sc1
    v_exp_f32 v214, v142
    v_add_f32 v218, v218, v212
    v_mfma_f32_32x32x16_bf16 v[144:159], a[116:119], a[44:47], v[144:159]
    v_add_f32 v218, v218, v213
    v_exp_f32 v215, v143
    v_cvt_pk_bf16_f32 v198, v212, v213
    v_add_f32 v218, v218, v214
    v_mfma_f32_32x32x16_bf16 v[144:159], a[120:123], a[52:55], v[144:159]
    buffer_load_dwordx4 a[212:215], v231, s[12:15], s32 offen offset:320 sc1
    v_add_f32 v218, v218, v215
    v_cmp_lt_f32 vcc, s30, v218
    v_cvt_pk_bf16_f32 v199, v214, v215
    v_mfma_f32_32x32x16_bf16 v[144:159], a[124:127], a[60:63], v[144:159]
    s_cbranch_vccnz KA_TR17
KA_RET17:
    v_add_f32 v216, v216, v218
    ds_read_b128 a[128:131], v220 offset:8192
    v_mfma_f32_32x32x16_bf16 v[0:15], a[160:163], v[192:195], v[0:15]
    ds_read_b128 a[132:135], v220 offset:9216
    ds_read_b128 a[136:139], v220 offset:10240
    ds_read_b128 a[140:143], v220 offset:11264
    ds_read_b128 a[144:147], v220 offset:12288
    v_mfma_f32_32x32x16_bf16 v[32:47], a[164:167], v[192:195], v[32:47]
    ds_read_b128 a[148:151], v220 offset:13312
    ds_read_b128 a[152:155], v220 offset:14336
    ds_read_b128 a[156:159], v220 offset:15360
    v_exp_f32 v208, v144
    v_mfma_f32_32x32x16_bf16 v[64:79], a[168:171], v[192:195], v[64:79]
    v_exp_f32 v209, v145
    v_exp_f32 v210, v146
    v_add_f32 v219, v208, v209
    v_mfma_f32_32x32x16_bf16 v[96:111], a[172:175], v[192:195], v[96:111]
    buffer_load_dwordx4 a[228:231], v231, s[12:15], s32 offen offset:2368 sc1
    v_exp_f32 v211, v147
    v_cvt_pk_bf16_f32 v200, v208, v209
    v_mfma_f32_32x32x16_bf16 v[0:15], a[176:179], v[196:199], v[0:15]
    v_exp_f32 v212, v148
    v_add_f32 v219, v219, v210
    v_add_f32 v219, v219, v211
    v_exp_f32 v213, v149
    v_mfma_f32_32x32x16_bf16 v[32:47], a[180:183], v[196:199], v[32:47]
    buffer_load_dwordx4 a[244:247], v231, s[12:15], s33 offen offset:320 sc1
    v_cvt_pk_bf16_f32 v201, v210, v211
    v_exp_f32 v214, v150
    v_mfma_f32_32x32x16_bf16 v[64:79], a[184:187], v[196:199], v[64:79]
    v_add_f32 v219, v219, v212
    v_add_f32 v219, v219, v213
    v_exp_f32 v215, v151
    v_mfma_f32_32x32x16_bf16 v[96:111], a[188:191], v[196:199], v[96:111]
    s_waitcnt lgkmcnt(0)
    v_cvt_pk_bf16_f32 v202, v212, v213
    v_exp_f32 v208, v152
    v_add_f32 v219, v219, v214
    v_add_f32 v219, v219, v215
    v_mfma_f32_32x32x16_bf16 v[128:143], a[64:67], a[0:3], v[160:175]
    s_waitcnt vmcnt(21)
    s_barrier
    v_mfma_f32_32x32x16_bf16 v[128:143], a[68:71], a[8:11], v[128:143]
    v_exp_f32 v209, v153
    v_cvt_pk_bf16_f32 v203, v214, v215
    v_exp_f32 v210, v154
    v_mfma_f32_32x32x16_bf16 v[128:143], a[72:75], a[16:19], v[128:143]
    v_add_f32 v219, v219, v208
    v_add_f32 v219, v219, v209
    v_exp_f32 v211, v155
    v_mfma_f32_32x32x16_bf16 v[128:143], a[76:79], a[24:27], v[128:143]
    v_cvt_pk_bf16_f32 v204, v208, v209
    v_exp_f32 v212, v156
    v_add_f32 v219, v219, v210
    v_add_f32 v219, v219, v211
    v_mfma_f32_32x32x16_bf16 v[128:143], a[80:83], a[32:35], v[128:143]
    v_exp_f32 v213, v157
    v_cvt_pk_bf16_f32 v205, v210, v211
    v_exp_f32 v214, v158
    v_mfma_f32_32x32x16_bf16 v[128:143], a[84:87], a[40:43], v[128:143]
    v_add_f32 v219, v219, v212
    v_add_f32 v219, v219, v213
    v_exp_f32 v215, v159
    v_mfma_f32_32x32x16_bf16 v[128:143], a[88:91], a[48:51], v[128:143]
    v_cvt_pk_bf16_f32 v206, v212, v213
    v_add_f32 v219, v219, v214
    v_add_f32 v219, v219, v215
    v_cmp_lt_f32 vcc, s30, v219
    v_cvt_pk_bf16_f32 v207, v214, v215
    v_mfma_f32_32x32x16_bf16 v[128:143], a[92:95], a[56:59], v[128:143]
    s_cbranch_vccnz KA_TR18
KA_RET18:
    v_add_f32 v217, v217, v219
    ds_read_b128 a[96:99], v220 offset:16384
    v_mfma_f32_32x32x16_bf16 v[16:31], a[160:163], v[200:203], v[16:31]
    ds_read_b128 a[100:103], v220 offset:17408
    ds_read_b128 a[104:107], v220 offset:18432
    ds_read_b128 a[108:111], v220 offset:19456
    ds_read_b128 a[112:115], v220 offset:20480
    v_mfma_f32_32x32x16_bf16 v[48:63], a[164:167], v[200:203], v[48:63]
    ds_read_b128 a[116:119], v220 offset:21504
    ds_read_b128 a[120:123], v220 offset:22528
    ds_read_b128 a[124:127], v220 offset:23552
    v_exp_f32 v208, v128
    v_mfma_f32_32x32x16_bf16 v[80:95], a[168:171], v[200:203], v[80:95]
    s_add_u32 m0, s26, 0
    v_exp_f32 v209, v129
    v_exp_f32 v210, v130
    v_add_f32 v218, v208, v209
    v_mfma_f32_32x32x16_bf16 v[112:127], a[172:175], v[200:203], v[112:127]
    v_exp_f32 v211, v131
    v_cvt_pk_bf16_f32 v192, v208, v209
    v_exp_f32 v212, v132
    v_mfma_f32_32x32x16_bf16 v[16:31], a[176:179], v[204:207], v[16:31]
    buffer_load_dwordx4 v220, s[12:15], s27 offen offset:0 sc1 lds
    v_add_f32 v218, v218, v210
    v_add_f32 v218, v218, v211
    v_exp_f32 v213, v133
    v_mfma_f32_32x32x16_bf16 v[48:63], a[180:183], v[204:207], v[48:63]
    v_cvt_pk_bf16_f32 v193, v210, v211
    v_exp_f32 v214, v134
    v_add_f32 v218, v218, v212
    v_add_f32 v218, v218, v213
    v_mfma_f32_32x32x16_bf16 v[80:95], a[184:187], v[204:207], v[80:95]
    buffer_load_dwordx4 v220, s[12:15], s27 offen offset:1024 sc1 lds
    v_exp_f32 v215, v135
    v_cvt_pk_bf16_f32 v194, v212, v213
    v_mfma_f32_32x32x16_bf16 v[112:127], a[188:191], v[204:207], v[112:127]
    v_exp_f32 v208, v136
    v_add_f32 v218, v218, v214
    v_add_f32 v218, v218, v215
    v_mfma_f32_32x32x16_bf16 v[144:159], a[64:67], a[4:7], v[176:191]
    buffer_load_dwordx4 v220, s[12:15], s27 offen offset:2048 sc1 lds
    v_exp_f32 v209, v137
    v_cvt_pk_bf16_f32 v195, v214, v215
    v_mfma_f32_32x32x16_bf16 v[144:159], a[68:71], a[12:15], v[144:159]
    v_exp_f32 v210, v138
    v_add_f32 v218, v218, v208
    v_add_f32 v218, v218, v209
    v_exp_f32 v211, v139
    v_mfma_f32_32x32x16_bf16 v[144:159], a[72:75], a[20:23], v[144:159]
    buffer_load_dwordx4 v220, s[12:15], s27 offen offset:3072 sc1 lds
    v_cvt_pk_bf16_f32 v196, v208, v209
    v_exp_f32 v212, v140
    v_mfma_f32_32x32x16_bf16 v[144:159], a[76:79], a[28:31], v[144:159]
    s_add_u32 m0, s23, 0
    s_add_u32 s27, s27, 16384
    v_add_f32 v218, v218, v210
    v_add_f32 v218, v218, v211
    v_exp_f32 v213, v141
    v_cvt_pk_bf16_f32 v197, v210, v211
    v_mfma_f32_32x32x16_bf16 v[144:159], a[80:83], a[36:39], v[144:159]
    s_add_u32 s22, s21, 0
    buffer_load_dwordx4 v248, s[8:11], s22 offen offset:0 lds
    v_exp_f32 v214, v142
    v_add_f32 v218, v218, v212
    v_mfma_f32_32x32x16_bf16 v[144:159], a[84:87], a[44:47], v[144:159]
    v_add_f32 v218, v218, v213
    v_exp_f32 v215, v143
    v_cvt_pk_bf16_f32 v198, v212, v213
    v_add_f32 v218, v218, v214
    v_mfma_f32_32x32x16_bf16 v[144:159], a[88:91], a[52:55], v[144:159]
    buffer_load_dwordx4 v249, s[8:11], s22 offen offset:1024 lds
    v_add_f32 v218, v218, v215
    v_cmp_lt_f32 vcc, s30, v218
    v_cvt_pk_bf16_f32 v199, v214, v215
    v_mfma_f32_32x32x16_bf16 v[144:159], a[92:95], a[60:63], v[144:159]
    s_cbranch_vccnz KA_TR19
KA_RET19:
    v_add_f32 v216, v216, v218
    ds_read_b128 a[160:163], v220 offset:24576
    v_mfma_f32_32x32x16_bf16 v[0:15], a[128:131], v[192:195], v[0:15]
    ds_read_b128 a[164:167], v220 offset:25600
    ds_read_b128 a[168:171], v220 offset:26624
    ds_read_b128 a[172:175], v220 offset:27648
    ds_read_b128 a[176:179], v220 offset:28672
    v_mfma_f32_32x32x16_bf16 v[32:47], a[132:135], v[192:195], v[32:47]
    ds_read_b128 a[180:183], v220 offset:29696
    ds_read_b128 a[184:187], v220 offset:30720
    ds_read_b128 a[188:191], v220 offset:31744
    v_exp_f32 v208, v144
    v_mfma_f32_32x32x16_bf16 v[64:79], a[136:139], v[192:195], v[64:79]
    v_exp_f32 v209, v145
    v_exp_f32 v210, v146
    v_add_f32 v219, v208, v209
    v_mfma_f32_32x32x16_bf16 v[96:111], a[140:143], v[192:195], v[96:111]
    buffer_load_dwordx4 v250, s[8:11], s22 offen offset:2048 lds
    v_exp_f32 v211, v147
    v_cvt_pk_bf16_f32 v200, v208, v209
    v_mfma_f32_32x32x16_bf16 v[0:15], a[144:147], v[196:199], v[0:15]
    v_exp_f32 v212, v148
    v_add_f32 v219, v219, v210
    v_add_f32 v219, v219, v211
    v_exp_f32 v213, v149
    v_mfma_f32_32x32x16_bf16 v[32:47], a[148:151], v[196:199], v[32:47]
    buffer_load_dwordx4 v251, s[8:11], s22 offen offset:3072 lds
    v_cvt_pk_bf16_f32 v201, v210, v211
    v_exp_f32 v214, v150
    v_mfma_f32_32x32x16_bf16 v[64:79], a[152:155], v[196:199], v[64:79]
    v_add_f32 v219, v219, v212
    v_add_f32 v219, v219, v213
    v_exp_f32 v215, v151
    v_mfma_f32_32x32x16_bf16 v[96:111], a[156:159], v[196:199], v[96:111]
    s_waitcnt lgkmcnt(0)
    v_cvt_pk_bf16_f32 v202, v212, v213
    v_exp_f32 v208, v152
    v_add_f32 v219, v219, v214
    v_add_f32 v219, v219, v215
    v_mfma_f32_32x32x16_bf16 v[128:143], a[96:99], a[0:3], v[160:175]
    s_waitcnt vmcnt(21)
    s_barrier
    v_mfma_f32_32x32x16_bf16 v[128:143], a[100:103], a[8:11], v[128:143]
    v_exp_f32 v209, v153
    v_cvt_pk_bf16_f32 v203, v214, v215
    v_exp_f32 v210, v154
    v_mfma_f32_32x32x16_bf16 v[128:143], a[104:107], a[16:19], v[128:143]
    v_add_f32 v219, v219, v208
    v_add_f32 v219, v219, v209
    v_exp_f32 v211, v155
    v_mfma_f32_32x32x16_bf16 v[128:143], a[108:111], a[24:27], v[128:143]
    v_cvt_pk_bf16_f32 v204, v208, v209
    v_exp_f32 v212, v156
    v_add_f32 v219, v219, v210
    v_add_f32 v219, v219, v211
    v_mfma_f32_32x32x16_bf16 v[128:143], a[112:115], a[32:35], v[128:143]
    v_exp_f32 v213, v157
    v_cvt_pk_bf16_f32 v205, v210, v211
    v_exp_f32 v214, v158
    v_mfma_f32_32x32x16_bf16 v[128:143], a[116:119], a[40:43], v[128:143]
    v_add_f32 v219, v219, v212
    v_add_f32 v219, v219, v213
    v_exp_f32 v215, v159
    v_mfma_f32_32x32x16_bf16 v[128:143], a[120:123], a[48:51], v[128:143]
    v_cvt_pk_bf16_f32 v206, v212, v213
    v_add_f32 v219, v219, v214
    v_add_f32 v219, v219, v215
    v_cmp_lt_f32 vcc, s30, v219
    v_cvt_pk_bf16_f32 v207, v214, v215
    v_mfma_f32_32x32x16_bf16 v[128:143], a[124:127], a[56:59], v[128:143]
    s_cbranch_vccnz KA_TR20
KA_RET20:
    v_add_f32 v217, v217, v219
    ds_read_b128 a[64:67], v220 offset:32768
    v_mfma_f32_32x32x16_bf16 v[16:31], a[128:131], v[200:203], v[16:31]
    ds_read_b128 a[68:71], v220 offset:33792
    ds_read_b128 a[72:75], v220 offset:34816
    ds_read_b128 a[76:79], v220 offset:35840
    ds_read_b128 a[80:83], v220 offset:36864
    v_mfma_f32_32x32x16_bf16 v[48:63], a[132:135], v[200:203], v[48:63]
    ds_read_b128 a[84:87], v220 offset:37888
    ds_read_b128 a[88:91], v220 offset:38912
    ds_read_b128 a[92:95], v220 offset:39936
    v_exp_f32 v208, v128
    v_mfma_f32_32x32x16_bf16 v[80:95], a[136:139], v[200:203], v[80:95]
    s_add_u32 m0, s26, 16384
    v_exp_f32 v209, v129
    v_exp_f32 v210, v130
    v_add_f32 v218, v208, v209
    v_mfma_f32_32x32x16_bf16 v[112:127], a[140:143], v[200:203], v[112:127]
    v_exp_f32 v211, v131
    v_cvt_pk_bf16_f32 v192, v208, v209
    v_exp_f32 v212, v132
    v_mfma_f32_32x32x16_bf16 v[16:31], a[144:147], v[204:207], v[16:31]
    buffer_load_dwordx4 v220, s[12:15], s27 offen offset:0 sc1 lds
    v_add_f32 v218, v218, v210
    v_add_f32 v218, v218, v211
    v_exp_f32 v213, v133
    v_mfma_f32_32x32x16_bf16 v[48:63], a[148:151], v[204:207], v[48:63]
    v_cvt_pk_bf16_f32 v193, v210, v211
    v_exp_f32 v214, v134
    v_add_f32 v218, v218, v212
    v_add_f32 v218, v218, v213
    v_mfma_f32_32x32x16_bf16 v[80:95], a[152:155], v[204:207], v[80:95]
    buffer_load_dwordx4 v220, s[12:15], s27 offen offset:1024 sc1 lds
    v_exp_f32 v215, v135
    v_cvt_pk_bf16_f32 v194, v212, v213
    v_mfma_f32_32x32x16_bf16 v[112:127], a[156:159], v[204:207], v[112:127]
    v_exp_f32 v208, v136
    v_add_f32 v218, v218, v214
    v_add_f32 v218, v218, v215
    v_mfma_f32_32x32x16_bf16 v[144:159], a[96:99], a[4:7], v[176:191]
    buffer_load_dwordx4 v220, s[12:15], s27 offen offset:2048 sc1 lds
    v_exp_f32 v209, v137
    v_cvt_pk_bf16_f32 v195, v214, v215
    v_mfma_f32_32x32x16_bf16 v[144:159], a[100:103], a[12:15], v[144:159]
    v_exp_f32 v210, v138
    v_add_f32 v218, v218, v208
    v_add_f32 v218, v218, v209
    v_exp_f32 v211, v139
    v_mfma_f32_32x32x16_bf16 v[144:159], a[104:107], a[20:23], v[144:159]
    buffer_load_dwordx4 v220, s[12:15], s27 offen offset:3072 sc1 lds
    v_cvt_pk_bf16_f32 v196, v208, v209
    v_exp_f32 v212, v140
    v_mfma_f32_32x32x16_bf16 v[144:159], a[108:111], a[28:31], v[144:159]
    s_add_u32 m0, s23, 4096
    s_add_u32 s27, s27, 16384
    v_add_f32 v218, v218, v210
    v_add_f32 v218, v218, v211
    v_exp_f32 v213, v141
    v_cvt_pk_bf16_f32 v197, v210, v211
    v_mfma_f32_32x32x16_bf16 v[144:159], a[112:115], a[36:39], v[144:159]
    s_add_u32 s22, s21, 32768
    buffer_load_dwordx4 v248, s[8:11], s22 offen offset:0 lds
    v_exp_f32 v214, v142
    v_add_f32 v218, v218, v212
    v_mfma_f32_32x32x16_bf16 v[144:159], a[116:119], a[44:47], v[144:159]
    v_add_f32 v218, v218, v213
    v_exp_f32 v215, v143
    v_cvt_pk_bf16_f32 v198, v212, v213
    v_add_f32 v218, v218, v214
    v_mfma_f32_32x32x16_bf16 v[144:159], a[120:123], a[52:55], v[144:159]
    buffer_load_dwordx4 v249, s[8:11], s22 offen offset:1024 lds
    v_add_f32 v218, v218, v215
    v_cmp_lt_f32 vcc, s30, v218
    v_cvt_pk_bf16_f32 v199, v214, v215
    v_mfma_f32_32x32x16_bf16 v[144:159], a[124:127], a[60:63], v[144:159]
    s_cbranch_vccnz KA_TR21
KA_RET21:
    v_add_f32 v216, v216, v218
    ds_read_b128 a[128:131], v220 offset:40960
    v_mfma_f32_32x32x16_bf16 v[0:15], a[160:163], v[192:195], v[0:15]
    ds_read_b128 a[132:135], v220 offset:41984
    ds_read_b128 a[136:139], v220 offset:43008
    ds_read_b128 a[140:143], v220 offset:44032
    ds_read_b128 a[144:147], v220 offset:45056
    v_mfma_f32_32x32x16_bf16 v[32:47], a[164:167], v[192:195], v[32:47]
    ds_read_b128 a[148:151], v220 offset:46080
    ds_read_b128 a[152:155], v220 offset:47104
    ds_read_b128 a[156:159], v220 offset:48128
    v_exp_f32 v208, v144
    v_mfma_f32_32x32x16_bf16 v[64:79], a[168:171], v[192:195], v[64:79]
    v_exp_f32 v209, v145
    v_exp_f32 v210, v146
    v_add_f32 v219, v208, v209
    v_mfma_f32_32x32x16_bf16 v[96:111], a[172:175], v[192:195], v[96:111]
    buffer_load_dwordx4 v250, s[8:11], s22 offen offset:2048 lds
    v_exp_f32 v211, v147
    v_cvt_pk_bf16_f32 v200, v208, v209
    v_mfma_f32_32x32x16_bf16 v[0:15], a[176:179], v[196:199], v[0:15]
    v_exp_f32 v212, v148
    v_add_f32 v219, v219, v210
    v_add_f32 v219, v219, v211
    v_exp_f32 v213, v149
    v_mfma_f32_32x32x16_bf16 v[32:47], a[180:183], v[196:199], v[32:47]
    buffer_load_dwordx4 v251, s[8:11], s22 offen offset:3072 lds
    v_cvt_pk_bf16_f32 v201, v210, v211
    v_exp_f32 v214, v150
    v_mfma_f32_32x32x16_bf16 v[64:79], a[184:187], v[196:199], v[64:79]
    v_add_f32 v219, v219, v212
    v_add_f32 v219, v219, v213
    v_exp_f32 v215, v151
    v_mfma_f32_32x32x16_bf16 v[96:111], a[188:191], v[196:199], v[96:111]
    s_waitcnt lgkmcnt(0)
    v_cvt_pk_bf16_f32 v202, v212, v213
    v_exp_f32 v208, v152
    v_add_f32 v219, v219, v214
    v_add_f32 v219, v219, v215
    v_mfma_f32_32x32x16_bf16 v[128:143], a[64:67], a[0:3], v[160:175]
    s_waitcnt vmcnt(20)
    s_barrier
    v_mfma_f32_32x32x16_bf16 v[128:143], a[68:71], a[8:11], v[128:143]
    v_exp_f32 v209, v153
    v_cvt_pk_bf16_f32 v203, v214, v215
    v_exp_f32 v210, v154
    v_mfma_f32_32x32x16_bf16 v[128:143], a[72:75], a[16:19], v[128:143]
    v_add_f32 v219, v219, v208
    v_add_f32 v219, v219, v209
    v_exp_f32 v211, v155
    v_mfma_f32_32x32x16_bf16 v[128:143], a[76:79], a[24:27], v[128:143]
    v_cvt_pk_bf16_f32 v204, v208, v209
    v_exp_f32 v212, v156
    v_add_f32 v219, v219, v210
    v_add_f32 v219, v219, v211
    v_mfma_f32_32x32x16_bf16 v[128:143], a[80:83], a[32:35], v[128:143]
    v_exp_f32 v213, v157
    v_cvt_pk_bf16_f32 v205, v210, v211
    v_exp_f32 v214, v158
    v_mfma_f32_32x32x16_bf16 v[128:143], a[84:87], a[40:43], v[128:143]
    v_add_f32 v219, v219, v212
    v_add_f32 v219, v219, v213
    v_exp_f32 v215, v159
    v_mfma_f32_32x32x16_bf16 v[128:143], a[88:91], a[48:51], v[128:143]
    v_cvt_pk_bf16_f32 v206, v212, v213
    v_add_f32 v219, v219, v214
    v_add_f32 v219, v219, v215
    v_cmp_lt_f32 vcc, s30, v219
    v_cvt_pk_bf16_f32 v207, v214, v215
    v_mfma_f32_32x32x16_bf16 v[128:143], a[92:95], a[56:59], v[128:143]
    s_cbranch_vccnz KA_TR22
KA_RET22:
    v_add_f32 v217, v217, v219
    ds_read_b128 a[96:99], v220 offset:49152
    v_mfma_f32_32x32x16_bf16 v[16:31], a[160:163], v[200:203], v[16:31]
    ds_read_b128 a[100:103], v220 offset:50176
    ds_read_b128 a[104:107], v220 offset:51200
    ds_read_b128 a[108:111], v220 offset:52224
    ds_read_b128 a[112:115], v220 offset:53248
    v_mfma_f32_32x32x16_bf16 v[48:63], a[164:167], v[200:203], v[48:63]
    ds_read_b128 a[116:119], v220 offset:54272
    ds_read_b128 a[120:123], v220 offset:55296
    ds_read_b128 a[124:127], v220 offset:56320
    v_exp_f32 v208, v128
    v_mfma_f32_32x32x16_bf16 v[80:95], a[168:171], v[200:203], v[80:95]
    s_add_u32 m0, s23, 8192
    v_exp_f32 v209, v129
    v_exp_f32 v210, v130
    v_add_f32 v218, v208, v209
    v_mfma_f32_32x32x16_bf16 v[112:127], a[172:175], v[200:203], v[112:127]
    s_add_u32 s22, s21, 65536
    v_exp_f32 v211, v131
    v_cvt_pk_bf16_f32 v192, v208, v209
    v_exp_f32 v212, v132
    v_mfma_f32_32x32x16_bf16 v[16:31], a[176:179], v[204:207], v[16:31]
    buffer_load_dwordx4 v248, s[8:11], s22 offen offset:0 lds
    v_add_f32 v218, v218, v210
    v_add_f32 v218, v218, v211
    v_mfma_f32_32x32x16_bf16 v[48:63], a[180:183], v[204:207], v[48:63]
    v_exp_f32 v213, v133
    v_cvt_pk_bf16_f32 v193, v210, v211
    v_exp_f32 v214, v134
    v_mfma_f32_32x32x16_bf16 v[80:95], a[184:187], v[204:207], v[80:95]
    buffer_load_dwordx4 v249, s[8:11], s22 offen offset:1024 lds
    v_add_f32 v218, v218, v212
    v_add_f32 v218, v218, v213
    v_exp_f32 v215, v135
    v_mfma_f32_32x32x16_bf16 v[112:127], a[188:191], v[204:207], v[112:127]
    v_cvt_pk_bf16_f32 v194, v212, v213
    v_exp_f32 v208, v136
    v_add_f32 v218, v218, v214
    v_mfma_f32_32x32x16_bf16 v[144:159], a[64:67], a[4:7], v[176:191]
    buffer_load_dwordx4 v250, s[8:11], s22 offen offset:2048 lds
    v_add_f32 v218, v218, v215
    v_exp_f32 v209, v137
    v_mfma_f32_32x32x16_bf16 v[144:159], a[68:71], a[12:15], v[144:159]
    v_cvt_pk_bf16_f32 v195, v214, v215
    v_exp_f32 v210, v138
    v_add_f32 v218, v218, v208
    v_mfma_f32_32x32x16_bf16 v[144:159], a[72:75], a[20:23], v[144:159]
    buffer_load_dwordx4 v251, s[8:11], s22 offen offset:3072 lds
    v_add_f32 v218, v218, v209
    v_exp_f32 v211, v139
    v_mfma_f32_32x32x16_bf16 v[144:159], a[76:79], a[28:31], v[144:159]
    v_cvt_pk_bf16_f32 v196, v208, v209
    v_exp_f32 v212, v140
    v_add_f32 v218, v218, v210
    v_add_f32 v218, v218, v211
    v_mfma_f32_32x32x16_bf16 v[144:159], a[80:83], a[36:39], v[144:159]
    v_exp_f32 v213, v141
    v_cvt_pk_bf16_f32 v197, v210, v211
    v_exp_f32 v214, v142
    v_mfma_f32_32x32x16_bf16 v[144:159], a[84:87], a[44:47], v[144:159]
    v_add_f32 v218, v218, v212
    v_add_f32 v218, v218, v213
    v_exp_f32 v215, v143
    v_mfma_f32_32x32x16_bf16 v[144:159], a[88:91], a[52:55], v[144:159]
    v_cvt_pk_bf16_f32 v198, v212, v213
    v_add_f32 v218, v218, v214
    v_add_f32 v218, v218, v215
    v_cmp_lt_f32 vcc, s30, v218
    v_cvt_pk_bf16_f32 v199, v214, v215
    v_mfma_f32_32x32x16_bf16 v[144:159], a[92:95], a[60:63], v[144:159]
    s_cbranch_vccnz KA_TR23
KA_RET23:
    v_add_f32 v216, v216, v218
    ds_read_b128 a[160:163], v220 offset:57344
    v_mfma_f32_32x32x16_bf16 v[0:15], a[128:131], v[192:195], v[0:15]
    ds_read_b128 a[164:167], v220 offset:58368
    ds_read_b128 a[168:171], v220 offset:59392
    ds_read_b128 a[172:175], v220 offset:60416
    ds_read_b128 a[176:179], v220 offset:61440
    v_mfma_f32_32x32x16_bf16 v[32:47], a[132:135], v[192:195], v[32:47]
    ds_read_b128 a[180:183], v220 offset:62464
    ds_read_b128 a[184:187], v220 offset:63488
    ds_read_b128 a[188:191], v220 offset:64512
    v_exp_f32 v208, v144
    v_mfma_f32_32x32x16_bf16 v[64:79], a[136:139], v[192:195], v[64:79]
    v_exp_f32 v209, v145
    v_exp_f32 v210, v146
    v_mfma_f32_32x32x16_bf16 v[96:111], a[140:143], v[192:195], v[96:111]
    v_add_f32 v219, v208, v209
    v_exp_f32 v211, v147
    v_cvt_pk_bf16_f32 v200, v208, v209
    v_mfma_f32_32x32x16_bf16 v[0:15], a[144:147], v[196:199], v[0:15]
    v_exp_f32 v212, v148
    v_add_f32 v219, v219, v210
    v_add_f32 v219, v219, v211
    v_mfma_f32_32x32x16_bf16 v[32:47], a[148:151], v[196:199], v[32:47]
    v_exp_f32 v213, v149
    v_cvt_pk_bf16_f32 v201, v210, v211
    v_exp_f32 v214, v150
    v_mfma_f32_32x32x16_bf16 v[64:79], a[152:155], v[196:199], v[64:79]
    v_add_f32 v219, v219, v212
    v_add_f32 v219, v219, v213
    v_exp_f32 v215, v151
    v_cvt_pk_bf16_f32 v202, v212, v213
    v_mfma_f32_32x32x16_bf16 v[96:111], a[156:159], v[196:199], v[96:111]
    s_waitcnt lgkmcnt(0)
    v_exp_f32 v208, v152
    v_add_f32 v219, v219, v214
    v_add_f32 v219, v219, v215
    v_mfma_f32_32x32x16_bf16 v[128:143], a[96:99], a[0:3], v[160:175]
    s_waitcnt vmcnt(16)
    s_barrier
    v_mfma_f32_32x32x16_bf16 v[128:143], a[100:103], a[8:11], v[128:143]
    v_exp_f32 v209, v153
    v_cvt_pk_bf16_f32 v203, v214, v215
    v_exp_f32 v210, v154
    v_mfma_f32_32x32x16_bf16 v[128:143], a[104:107], a[16:19], v[128:143]
    v_add_f32 v219, v219, v208
    v_add_f32 v219, v219, v209
    v_exp_f32 v211, v155
    v_mfma_f32_32x32x16_bf16 v[128:143], a[108:111], a[24:27], v[128:143]
    v_cvt_pk_bf16_f32 v204, v208, v209
    v_exp_f32 v212, v156
    v_add_f32 v219, v219, v210
    v_add_f32 v219, v219, v211
    v_mfma_f32_32x32x16_bf16 v[128:143], a[112:115], a[32:35], v[128:143]
    v_exp_f32 v213, v157
    v_cvt_pk_bf16_f32 v205, v210, v211
    v_exp_f32 v214, v158
    v_mfma_f32_32x32x16_bf16 v[128:143], a[116:119], a[40:43], v[128:143]
    v_add_f32 v219, v219, v212
    v_add_f32 v219, v219, v213
    v_exp_f32 v215, v159
    v_mfma_f32_32x32x16_bf16 v[128:143], a[120:123], a[48:51], v[128:143]
    v_cvt_pk_bf16_f32 v206, v212, v213
    v_add_f32 v219, v219, v214
    v_add_f32 v219, v219, v215
    v_cmp_lt_f32 vcc, s30, v219
    v_cvt_pk_bf16_f32 v207, v214, v215
    v_mfma_f32_32x32x16_bf16 v[128:143], a[124:127], a[56:59], v[128:143]
    s_cbranch_vccnz KA_TR24
KA_RET24:
    v_add_f32 v217, v217, v219
    ds_read_b128 a[64:67], v220 offset:0
    v_mfma_f32_32x32x16_bf16 v[16:31], a[128:131], v[200:203], v[16:31]
    ds_read_b128 a[68:71], v220 offset:1024
    ds_read_b128 a[72:75], v220 offset:2048
    ds_read_b128 a[76:79], v220 offset:3072
    ds_read_b128 a[80:83], v220 offset:4096
    v_mfma_f32_32x32x16_bf16 v[48:63], a[132:135], v[200:203], v[48:63]
    ds_read_b128 a[84:87], v220 offset:5120
    ds_read_b128 a[88:91], v220 offset:6144
    ds_read_b128 a[92:95], v220 offset:7168
    v_exp_f32 v208, v128
    v_mfma_f32_32x32x16_bf16 v[80:95], a[136:139], v[200:203], v[80:95]
    s_add_u32 m0, s23, 12288
    v_exp_f32 v209, v129
    v_exp_f32 v210, v130
    v_add_f32 v218, v208, v209
    v_mfma_f32_32x32x16_bf16 v[112:127], a[140:143], v[200:203], v[112:127]
    s_add_u32 s22, s21, 98304
    v_exp_f32 v211, v131
    v_cvt_pk_bf16_f32 v192, v208, v209
    v_exp_f32 v212, v132
    v_mfma_f32_32x32x16_bf16 v[16:31], a[144:147], v[204:207], v[16:31]
    buffer_load_dwordx4 v248, s[8:11], s22 offen offset:0 lds
    v_add_f32 v218, v218, v210
    v_add_f32 v218, v218, v211
    v_mfma_f32_32x32x16_bf16 v[48:63], a[148:151], v[204:207], v[48:63]
    v_exp_f32 v213, v133
    v_cvt_pk_bf16_f32 v193, v210, v211
    v_exp_f32 v214, v134
    v_mfma_f32_32x32x16_bf16 v[80:95], a[152:155], v[204:207], v[80:95]
    buffer_load_dwordx4 v249, s[8:11], s22 offen offset:1024 lds
    v_add_f32 v218, v218, v212
    v_add_f32 v218, v218, v213
    v_exp_f32 v215, v135
    v_mfma_f32_32x32x16_bf16 v[112:127], a[156:159], v[204:207], v[112:127]
    v_cvt_pk_bf16_f32 v194, v212, v213
    v_exp_f32 v208, v136
    v_add_f32 v218, v218, v214
    v_mfma_f32_32x32x16_bf16 v[144:159], a[96:99], a[4:7], v[176:191]
    buffer_load_dwordx4 v250, s[8:11], s22 offen offset:2048 lds
    v_add_f32 v218, v218, v215
    v_exp_f32 v209, v137
    v_mfma_f32_32x32x16_bf16 v[144:159], a[100:103], a[12:15], v[144:159]
    v_cvt_pk_bf16_f32 v195, v214, v215
    v_exp_f32 v210, v138
    v_add_f32 v218, v218, v208
    v_mfma_f32_32x32x16_bf16 v[144:159], a[104:107], a[20:23], v[144:159]
    buffer_load_dwordx4 v251, s[8:11], s22 offen offset:3072 lds
    v_add_f32 v218, v218, v209
    v_exp_f32 v211, v139
    v_mfma_f32_32x32x16_bf16 v[144:159], a[108:111], a[28:31], v[144:159]
    v_cvt_pk_bf16_f32 v196, v208, v209
    v_exp_f32 v212, v140
    v_add_f32 v218, v218, v210
    v_add_f32 v218, v218, v211
    v_mfma_f32_32x32x16_bf16 v[144:159], a[112:115], a[36:39], v[144:159]
    v_exp_f32 v213, v141
    v_cvt_pk_bf16_f32 v197, v210, v211
    v_exp_f32 v214, v142
    v_mfma_f32_32x32x16_bf16 v[144:159], a[116:119], a[44:47], v[144:159]
    v_add_f32 v218, v218, v212
    v_add_f32 v218, v218, v213
    v_exp_f32 v215, v143
    v_mfma_f32_32x32x16_bf16 v[144:159], a[120:123], a[52:55], v[144:159]
    v_cvt_pk_bf16_f32 v198, v212, v213
    v_add_f32 v218, v218, v214
    v_add_f32 v218, v218, v215
    v_cmp_lt_f32 vcc, s30, v218
    v_cvt_pk_bf16_f32 v199, v214, v215
    v_mfma_f32_32x32x16_bf16 v[144:159], a[124:127], a[60:63], v[144:159]
    s_cbranch_vccnz KA_TR25
KA_RET25:
    v_add_f32 v216, v216, v218
    ds_read_b128 a[128:131], v220 offset:8192
    v_mfma_f32_32x32x16_bf16 v[0:15], a[160:163], v[192:195], v[0:15]
    ds_read_b128 a[132:135], v220 offset:9216
    ds_read_b128 a[136:139], v220 offset:10240
    ds_read_b128 a[140:143], v220 offset:11264
    ds_read_b128 a[144:147], v220 offset:12288
    v_mfma_f32_32x32x16_bf16 v[32:47], a[164:167], v[192:195], v[32:47]
    ds_read_b128 a[148:151], v220 offset:13312
    ds_read_b128 a[152:155], v220 offset:14336
    ds_read_b128 a[156:159], v220 offset:15360
    v_exp_f32 v208, v144
    v_mfma_f32_32x32x16_bf16 v[64:79], a[168:171], v[192:195], v[64:79]
    v_exp_f32 v209, v145
    v_exp_f32 v210, v146
    v_mfma_f32_32x32x16_bf16 v[96:111], a[172:175], v[192:195], v[96:111]
    v_add_f32 v219, v208, v209
    v_exp_f32 v211, v147
    v_cvt_pk_bf16_f32 v200, v208, v209
    v_mfma_f32_32x32x16_bf16 v[0:15], a[176:179], v[196:199], v[0:15]
    v_exp_f32 v212, v148
    v_add_f32 v219, v219, v210
    v_add_f32 v219, v219, v211
    v_mfma_f32_32x32x16_bf16 v[32:47], a[180:183], v[196:199], v[32:47]
    v_exp_f32 v213, v149
    v_cvt_pk_bf16_f32 v201, v210, v211
    v_exp_f32 v214, v150
    v_mfma_f32_32x32x16_bf16 v[64:79], a[184:187], v[196:199], v[64:79]
    v_add_f32 v219, v219, v212
    v_add_f32 v219, v219, v213
    v_exp_f32 v215, v151
    v_cvt_pk_bf16_f32 v202, v212, v213
    v_mfma_f32_32x32x16_bf16 v[96:111], a[188:191], v[196:199], v[96:111]
    s_waitcnt lgkmcnt(0)
    v_exp_f32 v208, v152
    v_add_f32 v219, v219, v214
    v_add_f32 v219, v219, v215
    v_mfma_f32_32x32x16_bf16 v[128:143], a[64:67], a[0:3], v[160:175]
    s_waitcnt vmcnt(12)
    s_barrier
    v_mfma_f32_32x32x16_bf16 v[128:143], a[68:71], a[8:11], v[128:143]
    v_exp_f32 v209, v153
    v_cvt_pk_bf16_f32 v203, v214, v215
    v_exp_f32 v210, v154
    v_mfma_f32_32x32x16_bf16 v[128:143], a[72:75], a[16:19], v[128:143]
    v_add_f32 v219, v219, v208
    v_add_f32 v219, v219, v209
    v_exp_f32 v211, v155
    v_mfma_f32_32x32x16_bf16 v[128:143], a[76:79], a[24:27], v[128:143]
    v_cvt_pk_bf16_f32 v204, v208, v209
    v_exp_f32 v212, v156
    v_add_f32 v219, v219, v210
    v_add_f32 v219, v219, v211
    v_mfma_f32_32x32x16_bf16 v[128:143], a[80:83], a[32:35], v[128:143]
    v_exp_f32 v213, v157
    v_cvt_pk_bf16_f32 v205, v210, v211
    v_exp_f32 v214, v158
    v_mfma_f32_32x32x16_bf16 v[128:143], a[84:87], a[40:43], v[128:143]
    v_add_f32 v219, v219, v212
    v_add_f32 v219, v219, v213
    v_exp_f32 v215, v159
    v_mfma_f32_32x32x16_bf16 v[128:143], a[88:91], a[48:51], v[128:143]
    v_cvt_pk_bf16_f32 v206, v212, v213
    v_add_f32 v219, v219, v214
    v_add_f32 v219, v219, v215
    v_cmp_lt_f32 vcc, s30, v219
    v_cvt_pk_bf16_f32 v207, v214, v215
    v_mfma_f32_32x32x16_bf16 v[128:143], a[92:95], a[56:59], v[128:143]
    s_cbranch_vccnz KA_TR26
KA_RET26:
    v_add_f32 v217, v217, v219
    ds_read_b128 a[96:99], v220 offset:16384
    v_mfma_f32_32x32x16_bf16 v[16:31], a[160:163], v[200:203], v[16:31]
    ds_read_b128 a[100:103], v220 offset:17408
    ds_read_b128 a[104:107], v220 offset:18432
    ds_read_b128 a[108:111], v220 offset:19456
    ds_read_b128 a[112:115], v220 offset:20480
    v_mfma_f32_32x32x16_bf16 v[48:63], a[164:167], v[200:203], v[48:63]
    ds_read_b128 a[116:119], v220 offset:21504
    ds_read_b128 a[120:123], v220 offset:22528
    ds_read_b128 a[124:127], v220 offset:23552
    v_exp_f32 v208, v128
    v_mfma_f32_32x32x16_bf16 v[80:95], a[168:171], v[200:203], v[80:95]
    s_add_u32 m0, s29, 65536
    v_exp_f32 v209, v129
    v_exp_f32 v210, v130
    v_add_f32 v218, v208, v209
    v_mfma_f32_32x32x16_bf16 v[112:127], a[172:175], v[200:203], v[112:127]
    s_add_u32 s22, s21, 131072
    v_exp_f32 v211, v131
    v_cvt_pk_bf16_f32 v192, v208, v209
    v_exp_f32 v212, v132
    v_mfma_f32_32x32x16_bf16 v[16:31], a[176:179], v[204:207], v[16:31]
    buffer_load_dwordx4 v248, s[8:11], s22 offen offset:0 lds
    v_add_f32 v218, v218, v210
    v_add_f32 v218, v218, v211
    v_mfma_f32_32x32x16_bf16 v[48:63], a[180:183], v[204:207], v[48:63]
    v_exp_f32 v213, v133
    v_cvt_pk_bf16_f32 v193, v210, v211
    v_exp_f32 v214, v134
    v_mfma_f32_32x32x16_bf16 v[80:95], a[184:187], v[204:207], v[80:95]
    buffer_load_dwordx4 v249, s[8:11], s22 offen offset:1024 lds
    v_add_f32 v218, v218, v212
    v_add_f32 v218, v218, v213
    v_exp_f32 v215, v135
    v_mfma_f32_32x32x16_bf16 v[112:127], a[188:191], v[204:207], v[112:127]
    v_cvt_pk_bf16_f32 v194, v212, v213
    v_exp_f32 v208, v136
    v_add_f32 v218, v218, v214
    v_mfma_f32_32x32x16_bf16 v[144:159], a[64:67], a[4:7], v[176:191]
    buffer_load_dwordx4 v250, s[8:11], s22 offen offset:2048 lds
    v_add_f32 v218, v218, v215
    v_exp_f32 v209, v137
    v_mfma_f32_32x32x16_bf16 v[144:159], a[68:71], a[12:15], v[144:159]
    v_cvt_pk_bf16_f32 v195, v214, v215
    v_exp_f32 v210, v138
    v_add_f32 v218, v218, v208
    v_mfma_f32_32x32x16_bf16 v[144:159], a[72:75], a[20:23], v[144:159]
    buffer_load_dwordx4 v251, s[8:11], s22 offen offset:3072 lds
    v_add_f32 v218, v218, v209
    v_exp_f32 v211, v139
    v_mfma_f32_32x32x16_bf16 v[144:159], a[76:79], a[28:31], v[144:159]
    v_cvt_pk_bf16_f32 v196, v208, v209
    v_exp_f32 v212, v140
    v_add_f32 v218, v218, v210
    v_add_f32 v218, v218, v211
    v_mfma_f32_32x32x16_bf16 v[144:159], a[80:83], a[36:39], v[144:159]
    v_exp_f32 v213, v141
    v_cvt_pk_bf16_f32 v197, v210, v211
    v_exp_f32 v214, v142
    v_mfma_f32_32x32x16_bf16 v[144:159], a[84:87], a[44:47], v[144:159]
    v_add_f32 v218, v218, v212
    v_add_f32 v218, v218, v213
    v_exp_f32 v215, v143
    v_mfma_f32_32x32x16_bf16 v[144:159], a[88:91], a[52:55], v[144:159]
    v_cvt_pk_bf16_f32 v198, v212, v213
    v_add_f32 v218, v218, v214
    v_add_f32 v218, v218, v215
    v_cmp_lt_f32 vcc, s30, v218
    v_cvt_pk_bf16_f32 v199, v214, v215
    v_mfma_f32_32x32x16_bf16 v[144:159], a[92:95], a[60:63], v[144:159]
    s_cbranch_vccnz KA_TR27
KA_RET27:
    v_add_f32 v216, v216, v218
    ds_read_b128 a[160:163], v220 offset:24576
    v_mfma_f32_32x32x16_bf16 v[0:15], a[128:131], v[192:195], v[0:15]
    ds_read_b128 a[164:167], v220 offset:25600
    ds_read_b128 a[168:171], v220 offset:26624
    ds_read_b128 a[172:175], v220 offset:27648
    ds_read_b128 a[176:179], v220 offset:28672
    v_mfma_f32_32x32x16_bf16 v[32:47], a[132:135], v[192:195], v[32:47]
    ds_read_b128 a[180:183], v220 offset:29696
    ds_read_b128 a[184:187], v220 offset:30720
    ds_read_b128 a[188:191], v220 offset:31744
    v_exp_f32 v208, v144
    v_mfma_f32_32x32x16_bf16 v[64:79], a[136:139], v[192:195], v[64:79]
    v_exp_f32 v209, v145
    v_exp_f32 v210, v146
    v_mfma_f32_32x32x16_bf16 v[96:111], a[140:143], v[192:195], v[96:111]
    v_add_f32 v219, v208, v209
    v_exp_f32 v211, v147
    v_cvt_pk_bf16_f32 v200, v208, v209
    v_mfma_f32_32x32x16_bf16 v[0:15], a[144:147], v[196:199], v[0:15]
    v_exp_f32 v212, v148
    v_add_f32 v219, v219, v210
    v_add_f32 v219, v219, v211
    v_mfma_f32_32x32x16_bf16 v[32:47], a[148:151], v[196:199], v[32:47]
    v_exp_f32 v213, v149
    v_cvt_pk_bf16_f32 v201, v210, v211
    v_exp_f32 v214, v150
    v_mfma_f32_32x32x16_bf16 v[64:79], a[152:155], v[196:199], v[64:79]
    v_add_f32 v219, v219, v212
    v_add_f32 v219, v219, v213
    v_exp_f32 v215, v151
    v_cvt_pk_bf16_f32 v202, v212, v213
    v_mfma_f32_32x32x16_bf16 v[96:111], a[156:159], v[196:199], v[96:111]
    s_waitcnt lgkmcnt(0)
    v_exp_f32 v208, v152
    v_add_f32 v219, v219, v214
    v_add_f32 v219, v219, v215
    v_mfma_f32_32x32x16_bf16 v[128:143], a[96:99], a[0:3], v[160:175]
    s_barrier
    v_mfma_f32_32x32x16_bf16 v[128:143], a[100:103], a[8:11], v[128:143]
    v_exp_f32 v209, v153
    v_cvt_pk_bf16_f32 v203, v214, v215
    v_exp_f32 v210, v154
    v_mfma_f32_32x32x16_bf16 v[128:143], a[104:107], a[16:19], v[128:143]
    v_add_f32 v219, v219, v208
    v_add_f32 v219, v219, v209
    v_exp_f32 v211, v155
    v_mfma_f32_32x32x16_bf16 v[128:143], a[108:111], a[24:27], v[128:143]
    v_cvt_pk_bf16_f32 v204, v208, v209
    v_exp_f32 v212, v156
    v_add_f32 v219, v219, v210
    v_add_f32 v219, v219, v211
    v_mfma_f32_32x32x16_bf16 v[128:143], a[112:115], a[32:35], v[128:143]
    v_exp_f32 v213, v157
    v_cvt_pk_bf16_f32 v205, v210, v211
    v_exp_f32 v214, v158
    v_mfma_f32_32x32x16_bf16 v[128:143], a[116:119], a[40:43], v[128:143]
    v_add_f32 v219, v219, v212
    v_add_f32 v219, v219, v213
    v_exp_f32 v215, v159
    v_mfma_f32_32x32x16_bf16 v[128:143], a[120:123], a[48:51], v[128:143]
    v_cvt_pk_bf16_f32 v206, v212, v213
    v_add_f32 v219, v219, v214
    v_add_f32 v219, v219, v215
    v_cmp_lt_f32 vcc, s30, v219
    v_cvt_pk_bf16_f32 v207, v214, v215
    v_mfma_f32_32x32x16_bf16 v[128:143], a[124:127], a[56:59], v[128:143]
    s_cbranch_vccnz KA_TR28
KA_RET28:
    v_add_f32 v217, v217, v219
    v_mfma_f32_32x32x16_bf16 v[16:31], a[128:131], v[200:203], v[16:31]
    s_nop 5
    v_mfma_f32_32x32x16_bf16 v[48:63], a[132:135], v[200:203], v[48:63]
    s_nop 1
    v_exp_f32 v208, v128
    v_mfma_f32_32x32x16_bf16 v[80:95], a[136:139], v[200:203], v[80:95]
    s_add_u32 m0, s29, 69632
    v_exp_f32 v209, v129
    v_exp_f32 v210, v130
    v_add_f32 v218, v208, v209
    v_mfma_f32_32x32x16_bf16 v[112:127], a[140:143], v[200:203], v[112:127]
    s_add_u32 s22, s21, 163840
    v_exp_f32 v211, v131
    v_cvt_pk_bf16_f32 v192, v208, v209
    v_exp_f32 v212, v132
    v_mfma_f32_32x32x16_bf16 v[16:31], a[144:147], v[204:207], v[16:31]
    buffer_load_dwordx4 v248, s[8:11], s22 offen offset:0 lds
    v_add_f32 v218, v218, v210
    v_add_f32 v218, v218, v211
    v_exp_f32 v213, v133
    v_mfma_f32_32x32x16_bf16 v[48:63], a[148:151], v[204:207], v[48:63]
    v_cvt_pk_bf16_f32 v193, v210, v211
    v_exp_f32 v214, v134
    v_add_f32 v218, v218, v212
    v_mfma_f32_32x32x16_bf16 v[80:95], a[152:155], v[204:207], v[80:95]
    buffer_load_dwordx4 v249, s[8:11], s22 offen offset:1024 lds
    v_add_f32 v218, v218, v213
    v_exp_f32 v215, v135
    v_mfma_f32_32x32x16_bf16 v[112:127], a[156:159], v[204:207], v[112:127]
    v_cvt_pk_bf16_f32 v194, v212, v213
    v_exp_f32 v208, v136
    v_add_f32 v218, v218, v214
    v_mfma_f32_32x32x16_bf16 v[144:159], a[96:99], a[4:7], v[176:191]
    buffer_load_dwordx4 v250, s[8:11], s22 offen offset:2048 lds
    v_add_f32 v218, v218, v215
    v_exp_f32 v209, v137
    v_mfma_f32_32x32x16_bf16 v[144:159], a[100:103], a[12:15], v[144:159]
    v_cvt_pk_bf16_f32 v195, v214, v215
    v_exp_f32 v210, v138
    v_add_f32 v218, v218, v208
    v_add_f32 v218, v218, v209
    v_mfma_f32_32x32x16_bf16 v[144:159], a[104:107], a[20:23], v[144:159]
    buffer_load_dwordx4 v251, s[8:11], s22 offen offset:3072 lds
    v_exp_f32 v211, v139
    v_mfma_f32_32x32x16_bf16 v[144:159], a[108:111], a[28:31], v[144:159]
    v_cvt_pk_bf16_f32 v196, v208, v209
    v_exp_f32 v212, v140
    v_add_f32 v218, v218, v210
    v_add_f32 v218, v218, v211
    v_mfma_f32_32x32x16_bf16 v[144:159], a[112:115], a[36:39], v[144:159]
    v_exp_f32 v213, v141
    v_cvt_pk_bf16_f32 v197, v210, v211
    v_exp_f32 v214, v142
    v_mfma_f32_32x32x16_bf16 v[144:159], a[116:119], a[44:47], v[144:159]
    v_add_f32 v218, v218, v212
    v_add_f32 v218, v218, v213
    v_exp_f32 v215, v143
    v_cvt_pk_bf16_f32 v198, v212, v213
    v_mfma_f32_32x32x16_bf16 v[144:159], a[120:123], a[52:55], v[144:159]
    v_add_f32 v218, v218, v214
    v_add_f32 v218, v218, v215
    v_cmp_lt_f32 vcc, s30, v218
    v_cvt_pk_bf16_f32 v199, v214, v215
    v_mfma_f32_32x32x16_bf16 v[144:159], a[124:127], a[60:63], v[144:159]
    s_cbranch_vccnz KA_TR29
KA_RET29:
    v_add_f32 v216, v216, v218
    v_mfma_f32_32x32x16_bf16 v[0:15], a[160:163], v[192:195], v[0:15]
    s_nop 5
    v_mfma_f32_32x32x16_bf16 v[32:47], a[164:167], v[192:195], v[32:47]
    s_nop 1
    v_exp_f32 v208, v144
    v_mfma_f32_32x32x16_bf16 v[64:79], a[168:171], v[192:195], v[64:79]
    v_exp_f32 v209, v145
    v_exp_f32 v210, v146
    v_add_f32 v219, v208, v209
    v_mfma_f32_32x32x16_bf16 v[96:111], a[172:175], v[192:195], v[96:111]
    v_exp_f32 v211, v147
    v_cvt_pk_bf16_f32 v200, v208, v209
    v_mfma_f32_32x32x16_bf16 v[0:15], a[176:179], v[196:199], v[0:15]
    v_exp_f32 v212, v148
    v_add_f32 v219, v219, v210
    v_add_f32 v219, v219, v211
    v_exp_f32 v213, v149
    v_mfma_f32_32x32x16_bf16 v[32:47], a[180:183], v[196:199], v[32:47]
    v_cvt_pk_bf16_f32 v201, v210, v211
    v_exp_f32 v214, v150
    v_mfma_f32_32x32x16_bf16 v[64:79], a[184:187], v[196:199], v[64:79]
    v_add_f32 v219, v219, v212
    v_add_f32 v219, v219, v213
    v_exp_f32 v215, v151
    v_cvt_pk_bf16_f32 v202, v212, v213
    v_mfma_f32_32x32x16_bf16 v[96:111], a[188:191], v[196:199], v[96:111]
    v_exp_f32 v208, v152
    v_add_f32 v219, v219, v214
    v_add_f32 v219, v219, v215
    v_exp_f32 v209, v153
    v_cvt_pk_bf16_f32 v203, v214, v215
    v_exp_f32 v210, v154
    v_add_f32 v219, v219, v208
    v_add_f32 v219, v219, v209
    v_exp_f32 v211, v155
    v_cvt_pk_bf16_f32 v204, v208, v209
    v_exp_f32 v212, v156
    v_add_f32 v219, v219, v210
    v_add_f32 v219, v219, v211
    v_exp_f32 v213, v157
    v_cvt_pk_bf16_f32 v205, v210, v211
    v_exp_f32 v214, v158
    v_add_f32 v219, v219, v212
    v_add_f32 v219, v219, v213
    v_exp_f32 v215, v159
    v_cvt_pk_bf16_f32 v206, v212, v213
    v_add_f32 v219, v219, v214
    v_add_f32 v219, v219, v215
    v_cmp_lt_f32 vcc, s30, v219
    v_cvt_pk_bf16_f32 v207, v214, v215
    s_lshl_b32 s44, s20, 14
    v_and_b32 v240, 0xf0, v220
    v_bfe_u32 v241, v220, 8, 1
    v_lshl_add_u32 v240, v241, 10, v240
    v_lshrrev_b32 v241, 9, v220
    v_lshl_add_u32 v240, v241, 8, v240
    v_add_u32 v240, s44, v240
    s_add_u32 s44, s29, 65536
    v_add_u32 v221, s23, v252
    v_xor_b32 v222, 32, v221
    v_xor_b32 v223, 64, v221
    v_xor_b32 v224, 96, v221
    v_add_u32 v225, s44, v252
    v_xor_b32 v226, 32, v225
    v_xor_b32 v227, 64, v225
    v_xor_b32 v228, 96, v225
    s_cbranch_vccnz KA_TR30
KA_RET30:
    v_add_f32 v217, v217, v219
    v_mov_b32 v241, v216
    s_nop 1
    v_permlane32_swap_b32 v216, v241
    s_nop 0
    v_add_f32 v216, v216, v241
    v_rcp_f32 v218, v216
    s_nop 0
    v_mfma_f32_32x32x16_bf16 v[16:31], a[160:163], v[200:203], v[16:31]
    v_mul_f32 v0, v0, v218
    v_mul_f32 v1, v1, v218
    v_mul_f32 v2, v2, v218
    v_mul_f32 v3, v3, v218
    v_mul_f32 v4, v4, v218
    v_mul_f32 v5, v5, v218
    v_mul_f32 v6, v6, v218
    v_mfma_f32_32x32x16_bf16 v[48:63], a[164:167], v[200:203], v[48:63]
    v_mul_f32 v7, v7, v218
    v_cvt_pk_bf16_f32 v232, v0, v1
    v_cvt_pk_bf16_f32 v233, v2, v3
    v_cvt_pk_bf16_f32 v234, v4, v5
    v_cvt_pk_bf16_f32 v235, v6, v7
    v_mfma_f32_32x32x16_bf16 v[80:95], a[168:171], v[200:203], v[80:95]
    ds_write_b128 v240, v[232:235] offset:0
    v_mul_f32 v8, v8, v218
    v_mul_f32 v9, v9, v218
    v_mfma_f32_32x32x16_bf16 v[112:127], a[172:175], v[200:203], v[112:127]
    v_mul_f32 v10, v10, v218
    v_mul_f32 v11, v11, v218
    v_mul_f32 v12, v12, v218
    v_mul_f32 v13, v13, v218
    v_mul_f32 v14, v14, v218
    v_mul_f32 v15, v15, v218
    v_cvt_pk_bf16_f32 v236, v8, v9
    v_mfma_f32_32x32x16_bf16 v[16:31], a[176:179], v[204:207], v[16:31]
    v_cvt_pk_bf16_f32 v237, v10, v11
    v_cvt_pk_bf16_f32 v238, v12, v13
    v_cvt_pk_bf16_f32 v239, v14, v15
    ds_write_b128 v240, v[236:239] offset:512
    v_mfma_f32_32x32x16_bf16 v[48:63], a[180:183], v[204:207], v[48:63]
    v_mul_f32 v32, v32, v218
    v_mul_f32 v33, v33, v218
    v_mul_f32 v34, v34, v218
    v_mul_f32 v35, v35, v218
    v_mul_f32 v36, v36, v218
    v_mfma_f32_32x32x16_bf16 v[80:95], a[184:187], v[204:207], v[80:95]
    v_mul_f32 v37, v37, v218
    v_mul_f32 v38, v38, v218
    v_mul_f32 v39, v39, v218
    v_cvt_pk_bf16_f32 v232, v32, v33
    v_cvt_pk_bf16_f32 v233, v34, v35
    v_cvt_pk_bf16_f32 v234, v36, v37
    v_mfma_f32_32x32x16_bf16 v[112:127], a[188:191], v[204:207], v[112:127]
    v_cvt_pk_bf16_f32 v235, v38, v39
    ds_write_b128 v240, v[232:235] offset:4096
    v_mul_f32 v40, v40, v218
    v_mul_f32 v41, v41, v218
    v_mul_f32 v42, v42, v218
    v_mul_f32 v43, v43, v218
    v_mul_f32 v44, v44, v218
    v_mul_f32 v45, v45, v218
    v_mul_f32 v46, v46, v218
    v_mul_f32 v47, v47, v218
    v_cvt_pk_bf16_f32 v236, v40, v41
    v_cvt_pk_bf16_f32 v237, v42, v43
    v_cvt_pk_bf16_f32 v238, v44, v45
    v_cvt_pk_bf16_f32 v239, v46, v47
    ds_write_b128 v240, v[236:239] offset:4608
    v_mul_f32 v64, v64, v218
    v_mul_f32 v65, v65, v218
    v_mul_f32 v66, v66, v218
    v_mul_f32 v67, v67, v218
    v_mul_f32 v68, v68, v218
    v_mul_f32 v69, v69, v218
    v_mul_f32 v70, v70, v218
    v_mul_f32 v71, v71, v218
    v_cvt_pk_bf16_f32 v232, v64, v65
    v_cvt_pk_bf16_f32 v233, v66, v67
    v_cvt_pk_bf16_f32 v234, v68, v69
    v_cvt_pk_bf16_f32 v235, v70, v71
    ds_write_b128 v240, v[232:235] offset:8192
    v_mul_f32 v72, v72, v218
    v_mul_f32 v73, v73, v218
    v_mul_f32 v74, v74, v218
    v_mul_f32 v75, v75, v218
    v_mul_f32 v76, v76, v218
    v_mul_f32 v77, v77, v218
    v_mul_f32 v78, v78, v218
    v_mul_f32 v79, v79, v218
    v_cvt_pk_bf16_f32 v236, v72, v73
    v_cvt_pk_bf16_f32 v237, v74, v75
    v_cvt_pk_bf16_f32 v238, v76, v77
    v_cvt_pk_bf16_f32 v239, v78, v79
    ds_write_b128 v240, v[236:239] offset:8704
    v_mul_f32 v96, v96, v218
    v_mul_f32 v97, v97, v218
    v_mul_f32 v98, v98, v218
    v_mul_f32 v99, v99, v218
    v_mul_f32 v100, v100, v218
    v_mul_f32 v101, v101, v218
    v_mul_f32 v102, v102, v218
    v_mul_f32 v103, v103, v218
    v_cvt_pk_bf16_f32 v232, v96, v97
    v_cvt_pk_bf16_f32 v233, v98, v99
    v_cvt_pk_bf16_f32 v234, v100, v101
    v_cvt_pk_bf16_f32 v235, v102, v103
    ds_write_b128 v240, v[232:235] offset:12288
    v_mul_f32 v104, v104, v218
    v_mul_f32 v105, v105, v218
    v_mul_f32 v106, v106, v218
    v_mul_f32 v107, v107, v218
    v_mul_f32 v108, v108, v218
    v_mul_f32 v109, v109, v218
    v_mul_f32 v110, v110, v218
    v_mul_f32 v111, v111, v218
    v_cvt_pk_bf16_f32 v236, v104, v105
    v_cvt_pk_bf16_f32 v237, v106, v107
    v_cvt_pk_bf16_f32 v238, v108, v109
    v_cvt_pk_bf16_f32 v239, v110, v111
    ds_write_b128 v240, v[236:239] offset:12800
    v_mov_b32 v241, v217
    s_nop 1
    v_permlane32_swap_b32 v217, v241
    s_nop 0
    v_add_f32 v217, v217, v241
    v_rcp_f32 v219, v217
    s_nop 0
    v_pk_mul_f32 v[16:17], v[16:17], v[218:219] op_sel:[0,1] op_sel_hi:[1,1]
    v_pk_mul_f32 v[18:19], v[18:19], v[218:219] op_sel:[0,1] op_sel_hi:[1,1]
    v_pk_mul_f32 v[20:21], v[20:21], v[218:219] op_sel:[0,1] op_sel_hi:[1,1]
    v_pk_mul_f32 v[22:23], v[22:23], v[218:219] op_sel:[0,1] op_sel_hi:[1,1]
    v_cvt_pk_bf16_f32 v232, v16, v17
    v_cvt_pk_bf16_f32 v233, v18, v19
    v_cvt_pk_bf16_f32 v234, v20, v21
    v_cvt_pk_bf16_f32 v235, v22, v23
    ds_write_b128 v240, v[232:235] offset:2048
    v_pk_mul_f32 v[24:25], v[24:25], v[218:219] op_sel:[0,1] op_sel_hi:[1,1]
    v_pk_mul_f32 v[26:27], v[26:27], v[218:219] op_sel:[0,1] op_sel_hi:[1,1]
    v_pk_mul_f32 v[28:29], v[28:29], v[218:219] op_sel:[0,1] op_sel_hi:[1,1]
    v_pk_mul_f32 v[30:31], v[30:31], v[218:219] op_sel:[0,1] op_sel_hi:[1,1]
    v_cvt_pk_bf16_f32 v236, v24, v25
    v_cvt_pk_bf16_f32 v237, v26, v27
    v_cvt_pk_bf16_f32 v238, v28, v29
    v_cvt_pk_bf16_f32 v239, v30, v31
    ds_write_b128 v240, v[236:239] offset:2560
    v_pk_mul_f32 v[48:49], v[48:49], v[218:219] op_sel:[0,1] op_sel_hi:[1,1]
    v_pk_mul_f32 v[50:51], v[50:51], v[218:219] op_sel:[0,1] op_sel_hi:[1,1]
    v_pk_mul_f32 v[52:53], v[52:53], v[218:219] op_sel:[0,1] op_sel_hi:[1,1]
    v_pk_mul_f32 v[54:55], v[54:55], v[218:219] op_sel:[0,1] op_sel_hi:[1,1]
    v_cvt_pk_bf16_f32 v232, v48, v49
    v_cvt_pk_bf16_f32 v233, v50, v51
    v_cvt_pk_bf16_f32 v234, v52, v53
    v_cvt_pk_bf16_f32 v235, v54, v55
    ds_write_b128 v240, v[232:235] offset:6144
    v_pk_mul_f32 v[56:57], v[56:57], v[218:219] op_sel:[0,1] op_sel_hi:[1,1]
    v_pk_mul_f32 v[58:59], v[58:59], v[218:219] op_sel:[0,1] op_sel_hi:[1,1]
    v_pk_mul_f32 v[60:61], v[60:61], v[218:219] op_sel:[0,1] op_sel_hi:[1,1]
    v_pk_mul_f32 v[62:63], v[62:63], v[218:219] op_sel:[0,1] op_sel_hi:[1,1]
    v_cvt_pk_bf16_f32 v236, v56, v57
    v_cvt_pk_bf16_f32 v237, v58, v59
    v_cvt_pk_bf16_f32 v238, v60, v61
    v_cvt_pk_bf16_f32 v239, v62, v63
    ds_write_b128 v240, v[236:239] offset:6656
    v_pk_mul_f32 v[80:81], v[80:81], v[218:219] op_sel:[0,1] op_sel_hi:[1,1]
    v_pk_mul_f32 v[82:83], v[82:83], v[218:219] op_sel:[0,1] op_sel_hi:[1,1]
    v_pk_mul_f32 v[84:85], v[84:85], v[218:219] op_sel:[0,1] op_sel_hi:[1,1]
    v_pk_mul_f32 v[86:87], v[86:87], v[218:219] op_sel:[0,1] op_sel_hi:[1,1]
    v_cvt_pk_bf16_f32 v232, v80, v81
    v_cvt_pk_bf16_f32 v233, v82, v83
    v_cvt_pk_bf16_f32 v234, v84, v85
    v_cvt_pk_bf16_f32 v235, v86, v87
    ds_write_b128 v240, v[232:235] offset:10240
    v_pk_mul_f32 v[88:89], v[88:89], v[218:219] op_sel:[0,1] op_sel_hi:[1,1]
    v_pk_mul_f32 v[90:91], v[90:91], v[218:219] op_sel:[0,1] op_sel_hi:[1,1]
    v_pk_mul_f32 v[92:93], v[92:93], v[218:219] op_sel:[0,1] op_sel_hi:[1,1]
    v_pk_mul_f32 v[94:95], v[94:95], v[218:219] op_sel:[0,1] op_sel_hi:[1,1]
    v_cvt_pk_bf16_f32 v236, v88, v89
    v_cvt_pk_bf16_f32 v237, v90, v91
    v_cvt_pk_bf16_f32 v238, v92, v93
    v_cvt_pk_bf16_f32 v239, v94, v95
    ds_write_b128 v240, v[236:239] offset:10752
    v_pk_mul_f32 v[112:113], v[112:113], v[218:219] op_sel:[0,1] op_sel_hi:[1,1]
    v_pk_mul_f32 v[114:115], v[114:115], v[218:219] op_sel:[0,1] op_sel_hi:[1,1]
    v_pk_mul_f32 v[116:117], v[116:117], v[218:219] op_sel:[0,1] op_sel_hi:[1,1]
    v_pk_mul_f32 v[118:119], v[118:119], v[218:219] op_sel:[0,1] op_sel_hi:[1,1]
    v_cvt_pk_bf16_f32 v232, v112, v113
    v_cvt_pk_bf16_f32 v233, v114, v115
    v_cvt_pk_bf16_f32 v234, v116, v117
    v_cvt_pk_bf16_f32 v235, v118, v119
    ds_write_b128 v240, v[232:235] offset:14336
    v_pk_mul_f32 v[120:121], v[120:121], v[218:219] op_sel:[0,1] op_sel_hi:[1,1]
    v_pk_mul_f32 v[122:123], v[122:123], v[218:219] op_sel:[0,1] op_sel_hi:[1,1]
    v_pk_mul_f32 v[124:125], v[124:125], v[218:219] op_sel:[0,1] op_sel_hi:[1,1]
    v_pk_mul_f32 v[126:127], v[126:127], v[218:219] op_sel:[0,1] op_sel_hi:[1,1]
    v_cvt_pk_bf16_f32 v236, v120, v121
    v_cvt_pk_bf16_f32 v237, v122, v123
    v_cvt_pk_bf16_f32 v238, v124, v125
    v_cvt_pk_bf16_f32 v239, v126, v127
    ds_write_b128 v240, v[236:239] offset:14848
    v_bfe_u32 v241, v220, 7, 1
    v_lshlrev_b32 v241, 13, v241
    v_lshrrev_b32 v242, 8, v220
    v_lshl_add_u32 v241, v242, 7, v241
    v_and_b32 v242, 0x70, v220
    v_add_u32 v253, v241, v242
    s_lshl_b32 s44, s3, 21
    s_lshl_b32 s45, s37, 16
    s_add_u32 s44, s44, s45
    s_lshl_b32 s45, s20, 11
    s_add_u32 s44, s44, s45
    s_add_u32 s44, s44, 0x1000000
    s_add_u32 s45, s44, 16384
    s_add_u32 s24, s44, 32768
    s_add_u32 s25, s44, 49152
    s_waitcnt vmcnt(24) lgkmcnt(0)
    s_barrier
    ds_read_b64_tr_b16 v[128:129], v221 offset:0
    ds_read_b64_tr_b16 v[130:131], v221 offset:2048
    ds_read_b128 a[0:3], v220 offset:0
    ds_read_b128 a[4:7], v220 offset:1024
    ds_read_b128 a[8:11], v220 offset:2048
    ds_read_b128 a[12:15], v220 offset:3072
    ds_read_b64_tr_b16 v[132:133], v222 offset:0
    ds_read_b64_tr_b16 v[134:135], v222 offset:2048
    ds_read_b64_tr_b16 v[136:137], v223 offset:0
    ds_read_b64_tr_b16 v[138:139], v223 offset:2048
    ds_read_b64_tr_b16 v[140:141], v224 offset:0
    ds_read_b64_tr_b16 v[142:143], v224 offset:2048
    s_waitcnt lgkmcnt(0)
    v_mfma_f32_16x16x32_bf16 v[0:3], v[128:131], a[0:3], 0
    s_waitcnt vmcnt(16)
    s_add_u32 m0, s23, 0
    v_accvgpr_read_b32 v160, a192
    v_mfma_f32_16x16x32_bf16 v[8:11], v[128:131], a[4:7], 0
    s_add_u32 s22, s21, 196608
    ds_read_b64_tr_b16 v[144:145], v221 offset:4096
    ds_read_b64_tr_b16 v[146:147], v221 offset:6144
    v_mfma_f32_16x16x32_bf16 v[16:19], v[128:131], a[8:11], 0
    ds_read_b128 a[16:19], v220 offset:4096
    ds_read_b128 a[20:23], v220 offset:5120
    v_mfma_f32_16x16x32_bf16 v[24:27], v[128:131], a[12:15], 0
    buffer_load_dwordx4 v248, s[8:11], s22 offen offset:0 lds
    v_mfma_f32_16x16x32_bf16 v[4:7], v[132:135], a[0:3], 0
    ds_read_b128 a[24:27], v220 offset:6144
    ds_read_b128 a[28:31], v220 offset:7168
    v_mfma_f32_16x16x32_bf16 v[12:15], v[132:135], a[4:7], 0
    ds_read_b64_tr_b16 v[148:149], v222 offset:4096
    ds_read_b64_tr_b16 v[150:151], v222 offset:6144
    v_mfma_f32_16x16x32_bf16 v[20:23], v[132:135], a[8:11], 0
    ds_read_b64_tr_b16 v[152:153], v223 offset:4096
    ds_read_b64_tr_b16 v[154:155], v223 offset:6144
    v_mfma_f32_16x16x32_bf16 v[28:31], v[132:135], a[12:15], 0
    buffer_load_dwordx4 v249, s[8:11], s22 offen offset:1024 lds
    v_mfma_f32_16x16x32_bf16 v[32:35], v[136:139], a[0:3], 0
    ds_read_b64_tr_b16 v[156:157], v224 offset:4096
    ds_read_b64_tr_b16 v[158:159], v224 offset:6144
    v_mfma_f32_16x16x32_bf16 v[40:43], v[136:139], a[4:7], 0
    v_mfma_f32_16x16x32_bf16 v[48:51], v[136:139], a[8:11], 0
    v_accvgpr_read_b32 v161, a193
    v_accvgpr_read_b32 v162, a194
    v_mfma_f32_16x16x32_bf16 v[56:59], v[136:139], a[12:15], 0
    buffer_load_dwordx4 v250, s[8:11], s22 offen offset:2048 lds
    v_mfma_f32_16x16x32_bf16 v[36:39], v[140:143], a[0:3], 0
    v_accvgpr_read_b32 v163, a195
    v_mfma_f32_16x16x32_bf16 v[44:47], v[140:143], a[4:7], 0
    v_accvgpr_read_b32 v164, a196
    v_accvgpr_read_b32 v165, a197
    v_mfma_f32_16x16x32_bf16 v[52:55], v[140:143], a[8:11], 0
    v_accvgpr_read_b32 v166, a198
    v_accvgpr_read_b32 v167, a199
    v_mfma_f32_16x16x32_bf16 v[60:63], v[140:143], a[12:15], 0
    s_waitcnt lgkmcnt(0)
    buffer_load_dwordx4 v251, s[8:11], s22 offen offset:3072 lds
    v_mfma_f32_16x16x32_bf16 v[0:3], v[144:147], a[16:19], v[0:3]
    s_waitcnt vmcnt(16)
    s_add_u32 m0, s23, 4096
    v_accvgpr_read_b32 v168, a200
    v_mfma_f32_16x16x32_bf16 v[8:11], v[144:147], a[20:23], v[8:11]
    s_add_u32 s22, s21, 229376
    ds_read_b64_tr_b16 v[128:129], v221 offset:8192
    ds_read_b64_tr_b16 v[130:131], v221 offset:10240
    v_mfma_f32_16x16x32_bf16 v[16:19], v[144:147], a[24:27], v[16:19]
    ds_read_b128 a[32:35], v220 offset:8192
    ds_read_b128 a[36:39], v220 offset:9216
    v_mfma_f32_16x16x32_bf16 v[24:27], v[144:147], a[28:31], v[24:27]
    buffer_load_dwordx4 v248, s[8:11], s22 offen offset:0 lds
    v_mfma_f32_16x16x32_bf16 v[4:7], v[148:151], a[16:19], v[4:7]
    ds_read_b128 a[40:43], v220 offset:10240
    ds_read_b128 a[44:47], v220 offset:11264
    v_mfma_f32_16x16x32_bf16 v[12:15], v[148:151], a[20:23], v[12:15]
    ds_read_b64_tr_b16 v[132:133], v222 offset:8192
    ds_read_b64_tr_b16 v[134:135], v222 offset:10240
    v_mfma_f32_16x16x32_bf16 v[20:23], v[148:151], a[24:27], v[20:23]
    ds_read_b64_tr_b16 v[136:137], v223 offset:8192
    ds_read_b64_tr_b16 v[138:139], v223 offset:10240
    v_mfma_f32_16x16x32_bf16 v[28:31], v[148:151], a[28:31], v[28:31]
    buffer_load_dwordx4 v249, s[8:11], s22 offen offset:1024 lds
    v_mfma_f32_16x16x32_bf16 v[32:35], v[152:155], a[16:19], v[32:35]
    ds_read_b64_tr_b16 v[140:141], v224 offset:8192
    ds_read_b64_tr_b16 v[142:143], v224 offset:10240
    v_mfma_f32_16x16x32_bf16 v[40:43], v[152:155], a[20:23], v[40:43]
    v_mfma_f32_16x16x32_bf16 v[48:51], v[152:155], a[24:27], v[48:51]
    v_accvgpr_read_b32 v169, a201
    v_accvgpr_read_b32 v170, a202
    v_mfma_f32_16x16x32_bf16 v[56:59], v[152:155], a[28:31], v[56:59]
    buffer_load_dwordx4 v250, s[8:11], s22 offen offset:2048 lds
    v_mfma_f32_16x16x32_bf16 v[36:39], v[156:159], a[16:19], v[36:39]
    v_accvgpr_read_b32 v171, a203
    v_mfma_f32_16x16x32_bf16 v[44:47], v[156:159], a[20:23], v[44:47]
    v_accvgpr_read_b32 v172, a204
    v_accvgpr_read_b32 v173, a205
    v_mfma_f32_16x16x32_bf16 v[52:55], v[156:159], a[24:27], v[52:55]
    v_accvgpr_read_b32 v174, a206
    v_accvgpr_read_b32 v175, a207
    v_mfma_f32_16x16x32_bf16 v[60:63], v[156:159], a[28:31], v[60:63]
    s_waitcnt lgkmcnt(0)
    buffer_load_dwordx4 v251, s[8:11], s22 offen offset:3072 lds
    v_mfma_f32_16x16x32_bf16 v[0:3], v[128:131], a[32:35], v[0:3]
    s_waitcnt vmcnt(16)
    s_add_u32 m0, s23, 8192
    v_accvgpr_read_b32 v176, a208
    v_mfma_f32_16x16x32_bf16 v[8:11], v[128:131], a[36:39], v[8:11]
    s_add_u32 s22, s21, 262144
    ds_read_b64_tr_b16 v[144:145], v221 offset:12288
    ds_read_b64_tr_b16 v[146:147], v221 offset:14336
    v_mfma_f32_16x16x32_bf16 v[16:19], v[128:131], a[40:43], v[16:19]
    ds_read_b128 a[48:51], v220 offset:12288
    ds_read_b128 a[52:55], v220 offset:13312
    v_mfma_f32_16x16x32_bf16 v[24:27], v[128:131], a[44:47], v[24:27]
    buffer_load_dwordx4 v248, s[8:11], s22 offen offset:0 lds
    v_mfma_f32_16x16x32_bf16 v[4:7], v[132:135], a[32:35], v[4:7]
    ds_read_b128 a[56:59], v220 offset:14336
    ds_read_b128 a[60:63], v220 offset:15360
    v_mfma_f32_16x16x32_bf16 v[12:15], v[132:135], a[36:39], v[12:15]
    ds_read_b64_tr_b16 v[148:149], v222 offset:12288
    ds_read_b64_tr_b16 v[150:151], v222 offset:14336
    v_mfma_f32_16x16x32_bf16 v[20:23], v[132:135], a[40:43], v[20:23]
    ds_read_b64_tr_b16 v[152:153], v223 offset:12288
    ds_read_b64_tr_b16 v[154:155], v223 offset:14336
    v_mfma_f32_16x16x32_bf16 v[28:31], v[132:135], a[44:47], v[28:31]
    buffer_load_dwordx4 v249, s[8:11], s22 offen offset:1024 lds
    v_mfma_f32_16x16x32_bf16 v[32:35], v[136:139], a[32:35], v[32:35]
    ds_read_b64_tr_b16 v[156:157], v224 offset:12288
    ds_read_b64_tr_b16 v[158:159], v224 offset:14336
    v_mfma_f32_16x16x32_bf16 v[40:43], v[136:139], a[36:39], v[40:43]
    v_mfma_f32_16x16x32_bf16 v[48:51], v[136:139], a[40:43], v[48:51]
    v_accvgpr_read_b32 v177, a209
    v_accvgpr_read_b32 v178, a210
    v_mfma_f32_16x16x32_bf16 v[56:59], v[136:139], a[44:47], v[56:59]
    buffer_load_dwordx4 v250, s[8:11], s22 offen offset:2048 lds
    v_mfma_f32_16x16x32_bf16 v[36:39], v[140:143], a[32:35], v[36:39]
    v_accvgpr_read_b32 v179, a211
    v_mfma_f32_16x16x32_bf16 v[44:47], v[140:143], a[36:39], v[44:47]
    v_accvgpr_read_b32 v180, a212
    v_accvgpr_read_b32 v181, a213
    v_mfma_f32_16x16x32_bf16 v[52:55], v[140:143], a[40:43], v[52:55]
    v_accvgpr_read_b32 v182, a214
    v_accvgpr_read_b32 v183, a215
    v_mfma_f32_16x16x32_bf16 v[60:63], v[140:143], a[44:47], v[60:63]
    s_waitcnt lgkmcnt(0)
    buffer_load_dwordx4 v251, s[8:11], s22 offen offset:3072 lds
    v_mfma_f32_16x16x32_bf16 v[0:3], v[144:147], a[48:51], v[0:3]
    s_waitcnt vmcnt(16)
    s_add_u32 m0, s23, 12288
    v_accvgpr_read_b32 v184, a216
    v_mfma_f32_16x16x32_bf16 v[8:11], v[144:147], a[52:55], v[8:11]
    s_add_u32 s22, s21, 294912
    ds_read_b64_tr_b16 v[128:129], v225 offset:0
    ds_read_b64_tr_b16 v[130:131], v225 offset:2048
    v_mfma_f32_16x16x32_bf16 v[16:19], v[144:147], a[56:59], v[16:19]
    ds_read_b128 a[64:67], v220 offset:16384
    ds_read_b128 a[68:71], v220 offset:17408
    v_mfma_f32_16x16x32_bf16 v[24:27], v[144:147], a[60:63], v[24:27]
    buffer_load_dwordx4 v248, s[8:11], s22 offen offset:0 lds
    v_mfma_f32_16x16x32_bf16 v[4:7], v[148:151], a[48:51], v[4:7]
    ds_read_b128 a[72:75], v220 offset:18432
    ds_read_b128 a[76:79], v220 offset:19456
    v_mfma_f32_16x16x32_bf16 v[12:15], v[148:151], a[52:55], v[12:15]
    ds_read_b64_tr_b16 v[132:133], v226 offset:0
    ds_read_b64_tr_b16 v[134:135], v226 offset:2048
    v_mfma_f32_16x16x32_bf16 v[20:23], v[148:151], a[56:59], v[20:23]
    ds_read_b64_tr_b16 v[136:137], v227 offset:0
    ds_read_b64_tr_b16 v[138:139], v227 offset:2048
    v_mfma_f32_16x16x32_bf16 v[28:31], v[148:151], a[60:63], v[28:31]
    buffer_load_dwordx4 v249, s[8:11], s22 offen offset:1024 lds
    v_mfma_f32_16x16x32_bf16 v[32:35], v[152:155], a[48:51], v[32:35]
    ds_read_b64_tr_b16 v[140:141], v228 offset:0
    ds_read_b64_tr_b16 v[142:143], v228 offset:2048
    v_mfma_f32_16x16x32_bf16 v[40:43], v[152:155], a[52:55], v[40:43]
    v_mfma_f32_16x16x32_bf16 v[48:51], v[152:155], a[56:59], v[48:51]
    v_accvgpr_read_b32 v185, a217
    v_accvgpr_read_b32 v186, a218
    v_mfma_f32_16x16x32_bf16 v[56:59], v[152:155], a[60:63], v[56:59]
    buffer_load_dwordx4 v250, s[8:11], s22 offen offset:2048 lds
    v_mfma_f32_16x16x32_bf16 v[36:39], v[156:159], a[48:51], v[36:39]
    v_accvgpr_read_b32 v187, a219
    v_mfma_f32_16x16x32_bf16 v[44:47], v[156:159], a[52:55], v[44:47]
    v_accvgpr_read_b32 v188, a220
    v_accvgpr_read_b32 v189, a221
    v_mfma_f32_16x16x32_bf16 v[52:55], v[156:159], a[56:59], v[52:55]
    v_accvgpr_read_b32 v190, a222
    v_accvgpr_read_b32 v191, a223
    v_mfma_f32_16x16x32_bf16 v[60:63], v[156:159], a[60:63], v[60:63]
    s_waitcnt lgkmcnt(0)
    buffer_load_dwordx4 v251, s[8:11], s22 offen offset:3072 lds
    v_mfma_f32_16x16x32_bf16 v[0:3], v[128:131], a[64:67], v[0:3]
    s_waitcnt vmcnt(16)
    s_add_u32 m0, s29, 65536
    v_accvgpr_read_b32 v192, a224
    v_mfma_f32_16x16x32_bf16 v[8:11], v[128:131], a[68:71], v[8:11]
    s_add_u32 s22, s21, 327680
    ds_read_b64_tr_b16 v[144:145], v225 offset:4096
    ds_read_b64_tr_b16 v[146:147], v225 offset:6144
    v_mfma_f32_16x16x32_bf16 v[16:19], v[128:131], a[72:75], v[16:19]
    ds_read_b128 a[80:83], v220 offset:20480
    ds_read_b128 a[84:87], v220 offset:21504
    v_mfma_f32_16x16x32_bf16 v[24:27], v[128:131], a[76:79], v[24:27]
    buffer_load_dwordx4 v248, s[8:11], s22 offen offset:0 lds
    v_accvgpr_read_b32 v193, a225
    v_mfma_f32_16x16x32_bf16 v[4:7], v[132:135], a[64:67], v[4:7]
    ds_read_b128 a[88:91], v220 offset:22528
    ds_read_b128 a[92:95], v220 offset:23552
    v_mfma_f32_16x16x32_bf16 v[12:15], v[132:135], a[68:71], v[12:15]
    ds_read_b64_tr_b16 v[148:149], v226 offset:4096
    ds_read_b64_tr_b16 v[150:151], v226 offset:6144
    v_mfma_f32_16x16x32_bf16 v[20:23], v[132:135], a[72:75], v[20:23]
    ds_read_b64_tr_b16 v[152:153], v227 offset:4096
    ds_read_b64_tr_b16 v[154:155], v227 offset:6144
    v_mfma_f32_16x16x32_bf16 v[28:31], v[132:135], a[76:79], v[28:31]
    buffer_load_dwordx4 v249, s[8:11], s22 offen offset:1024 lds
    v_accvgpr_read_b32 v194, a226
    v_mfma_f32_16x16x32_bf16 v[32:35], v[136:139], a[64:67], v[32:35]
    v_bfe_u32 v232, v220, 4, 3
    v_lshrrev_b32 v233, 7, v220
    s_and_b32 s46, s38, 1
    v_mfma_f32_16x16x32_bf16 v[40:43], v[136:139], a[68:71], v[40:43]
    s_lshl_b32 s46, s46, 2
    s_and_b32 s47, s39, 3
    s_add_u32 s54, s46, s47
    v_mfma_f32_16x16x32_bf16 v[48:51], v[136:139], a[72:75], v[48:51]
    ds_read_b64_tr_b16 v[156:157], v228 offset:4096
    ds_read_b64_tr_b16 v[158:159], v228 offset:6144
    v_mfma_f32_16x16x32_bf16 v[56:59], v[136:139], a[76:79], v[56:59]
    buffer_load_dwordx4 v250, s[8:11], s22 offen offset:2048 lds
    v_mfma_f32_16x16x32_bf16 v[36:39], v[140:143], a[64:67], v[36:39]
    v_mfma_f32_16x16x32_bf16 v[44:47], v[140:143], a[68:71], v[44:47]
    v_accvgpr_read_b32 v195, a227
    v_accvgpr_read_b32 v196, a228
    v_mfma_f32_16x16x32_bf16 v[52:55], v[140:143], a[72:75], v[52:55]
    v_accvgpr_read_b32 v197, a229
    v_accvgpr_read_b32 v198, a230
    v_mfma_f32_16x16x32_bf16 v[60:63], v[140:143], a[76:79], v[60:63]
    s_waitcnt lgkmcnt(0)
    buffer_load_dwordx4 v251, s[8:11], s22 offen offset:3072 lds
    v_accvgpr_read_b32 v199, a231
    v_mfma_f32_16x16x32_bf16 v[0:3], v[144:147], a[80:83], v[0:3]
    s_waitcnt vmcnt(16)
    s_add_u32 m0, s29, 69632
    v_accvgpr_read_b32 v200, a232
    v_mfma_f32_16x16x32_bf16 v[8:11], v[144:147], a[84:87], v[8:11]
    s_add_u32 s22, s21, 360448
    ds_read_b64_tr_b16 v[128:129], v221 offset:0
    ds_read_b64_tr_b16 v[130:131], v221 offset:2048
    v_mfma_f32_16x16x32_bf16 v[16:19], v[144:147], a[88:91], v[16:19]
    ds_read_b128 a[96:99], v220 offset:24576
    ds_read_b128 a[100:103], v220 offset:25600
    v_mfma_f32_16x16x32_bf16 v[24:27], v[144:147], a[92:95], v[24:27]
    buffer_load_dwordx4 v248, s[8:11], s22 offen offset:0 lds
    v_accvgpr_read_b32 v201, a233
    v_mfma_f32_16x16x32_bf16 v[4:7], v[148:151], a[80:83], v[4:7]
    ds_read_b128 a[104:107], v220 offset:26624
    ds_read_b128 a[108:111], v220 offset:27648
    v_mfma_f32_16x16x32_bf16 v[12:15], v[148:151], a[84:87], v[12:15]
    ds_read_b64_tr_b16 v[132:133], v222 offset:0
    ds_read_b64_tr_b16 v[134:135], v222 offset:2048
    v_mfma_f32_16x16x32_bf16 v[20:23], v[148:151], a[88:91], v[20:23]
    ds_read_b64_tr_b16 v[136:137], v223 offset:0
    ds_read_b64_tr_b16 v[138:139], v223 offset:2048
    v_mfma_f32_16x16x32_bf16 v[28:31], v[148:151], a[92:95], v[28:31]
    buffer_load_dwordx4 v249, s[8:11], s22 offen offset:1024 lds
    v_accvgpr_read_b32 v202, a234
    v_mfma_f32_16x16x32_bf16 v[32:35], v[152:155], a[80:83], v[32:35]
    ds_read_b64_tr_b16 v[140:141], v224 offset:0
    ds_read_b64_tr_b16 v[142:143], v224 offset:2048
    v_mfma_f32_16x16x32_bf16 v[40:43], v[152:155], a[84:87], v[40:43]
    s_lshr_b32 s46, s38, 1
    s_mul_i32 s46, s46, 7
    s_lshr_b32 s47, s39, 2
    s_add_u32 s55, s46, s47
    s_cmp_lt_u32 s20, 2
    s_cselect_b32 s48, s76, s78
    s_cselect_b32 s49, s77, s79
    v_mfma_f32_16x16x32_bf16 v[48:51], v[152:155], a[88:91], v[48:51]
    v_mfma_f32_16x16x32_bf16 v[56:59], v[152:155], a[92:95], v[56:59]
    buffer_load_dwordx4 v250, s[8:11], s22 offen offset:2048 lds
    v_mfma_f32_16x16x32_bf16 v[36:39], v[156:159], a[80:83], v[36:39]
    v_mfma_f32_16x16x32_bf16 v[44:47], v[156:159], a[84:87], v[44:47]
    v_accvgpr_read_b32 v203, a235
    v_accvgpr_read_b32 v204, a236
    v_mfma_f32_16x16x32_bf16 v[52:55], v[156:159], a[88:91], v[52:55]
    v_accvgpr_read_b32 v205, a237
    v_accvgpr_read_b32 v206, a238
    v_mfma_f32_16x16x32_bf16 v[60:63], v[156:159], a[92:95], v[60:63]
    s_waitcnt lgkmcnt(0)
    buffer_load_dwordx4 v251, s[8:11], s22 offen offset:3072 lds
    v_accvgpr_read_b32 v207, a239
    v_mfma_f32_16x16x32_bf16 v[0:3], v[128:131], a[96:99], v[0:3]
    s_waitcnt vmcnt(16)
    s_add_u32 m0, s23, 0
    v_accvgpr_read_b32 v208, a240
    v_mfma_f32_16x16x32_bf16 v[8:11], v[128:131], a[100:103], v[8:11]
    s_add_u32 s22, s21, 393216
    ds_read_b64_tr_b16 v[144:145], v221 offset:4096
    ds_read_b64_tr_b16 v[146:147], v221 offset:6144
    v_mfma_f32_16x16x32_bf16 v[16:19], v[128:131], a[104:107], v[16:19]
    ds_read_b128 a[112:115], v220 offset:28672
    ds_read_b128 a[116:119], v220 offset:29696
    v_mfma_f32_16x16x32_bf16 v[24:27], v[128:131], a[108:111], v[24:27]
    buffer_load_dwordx4 v248, s[8:11], s22 offen offset:0 lds
    v_accvgpr_read_b32 v209, a241
    v_mfma_f32_16x16x32_bf16 v[4:7], v[132:135], a[96:99], v[4:7]
    ds_read_b128 a[120:123], v220 offset:30720
    ds_read_b128 a[124:127], v220 offset:31744
    v_mfma_f32_16x16x32_bf16 v[12:15], v[132:135], a[100:103], v[12:15]
    ds_read_b64_tr_b16 v[148:149], v222 offset:4096
    ds_read_b64_tr_b16 v[150:151], v222 offset:6144
    v_mfma_f32_16x16x32_bf16 v[20:23], v[132:135], a[104:107], v[20:23]
    ds_read_b64_tr_b16 v[152:153], v223 offset:4096
    ds_read_b64_tr_b16 v[154:155], v223 offset:6144
    v_mfma_f32_16x16x32_bf16 v[28:31], v[132:135], a[108:111], v[28:31]
    buffer_load_dwordx4 v249, s[8:11], s22 offen offset:1024 lds
    v_accvgpr_read_b32 v210, a242
    v_mfma_f32_16x16x32_bf16 v[32:35], v[136:139], a[96:99], v[32:35]
    s_mov_b32 s50, 1835008
    s_mov_b32 s51, 0x20000
    s_and_b32 s46, s20, 1
    v_mfma_f32_16x16x32_bf16 v[40:43], v[136:139], a[100:103], v[40:43]
    s_mul_i32 s46, s46, 28672
    s_lshl_b32 s47, s55, 7
    s_add_u32 s53, s46, s47
    v_mfma_f32_16x16x32_bf16 v[48:51], v[136:139], a[104:107], v[48:51]
    ds_read_b64_tr_b16 v[156:157], v224 offset:4096
    ds_read_b64_tr_b16 v[158:159], v224 offset:6144
    v_mfma_f32_16x16x32_bf16 v[56:59], v[136:139], a[108:111], v[56:59]
    buffer_load_dwordx4 v250, s[8:11], s22 offen offset:2048 lds
    v_mfma_f32_16x16x32_bf16 v[36:39], v[140:143], a[96:99], v[36:39]
    v_mfma_f32_16x16x32_bf16 v[44:47], v[140:143], a[100:103], v[44:47]
    v_accvgpr_read_b32 v211, a243
    v_accvgpr_read_b32 v212, a244
    v_mfma_f32_16x16x32_bf16 v[52:55], v[140:143], a[104:107], v[52:55]
    v_accvgpr_read_b32 v213, a245
    v_accvgpr_read_b32 v214, a246
    v_mfma_f32_16x16x32_bf16 v[60:63], v[140:143], a[108:111], v[60:63]
    s_waitcnt lgkmcnt(0)
    buffer_load_dwordx4 v251, s[8:11], s22 offen offset:3072 lds
    v_accvgpr_read_b32 v215, a247
    v_mfma_f32_16x16x32_bf16 v[0:3], v[144:147], a[112:115], v[0:3]
    s_waitcnt vmcnt(16)
    s_add_u32 m0, s23, 4096
    v_mfma_f32_16x16x32_bf16 v[8:11], v[144:147], a[116:119], v[8:11]
    s_add_u32 s22, s21, 425984
    ds_read_b64_tr_b16 v[128:129], v221 offset:8192
    ds_read_b64_tr_b16 v[130:131], v221 offset:10240
    v_mfma_f32_16x16x32_bf16 v[16:19], v[144:147], a[120:123], v[16:19]
    ds_read_b128 a[128:131], v220 offset:32768
    ds_read_b128 a[132:135], v220 offset:33792
    v_mfma_f32_16x16x32_bf16 v[24:27], v[144:147], a[124:127], v[24:27]
    buffer_load_dwordx4 v248, s[8:11], s22 offen offset:0 lds
    v_mfma_f32_16x16x32_bf16 v[4:7], v[148:151], a[112:115], v[4:7]
    ds_read_b128 a[136:139], v220 offset:34816
    ds_read_b128 a[140:143], v220 offset:35840
    v_mfma_f32_16x16x32_bf16 v[12:15], v[148:151], a[116:119], v[12:15]
    ds_read_b64_tr_b16 v[132:133], v222 offset:8192
    ds_read_b64_tr_b16 v[134:135], v222 offset:10240
    v_mfma_f32_16x16x32_bf16 v[20:23], v[148:151], a[120:123], v[20:23]
    ds_read_b64_tr_b16 v[136:137], v223 offset:8192
    ds_read_b64_tr_b16 v[138:139], v223 offset:10240
    v_mfma_f32_16x16x32_bf16 v[28:31], v[148:151], a[124:127], v[28:31]
    buffer_load_dwordx4 v249, s[8:11], s22 offen offset:1024 lds
    v_mfma_f32_16x16x32_bf16 v[32:35], v[152:155], a[112:115], v[32:35]
    s_lshl_b32 s52, s20, 10
    v_lshrrev_b32 v236, 10, v248
    v_mul_u32_u24 v231, 3584, v236
    v_mfma_f32_16x16x32_bf16 v[40:43], v[152:155], a[116:119], v[40:43]
    v_and_b32 v236, 0x3ff, v248
    v_add_u32 v231, v231, v236
    s_lshl_b32 s61, s20, 13
    v_mfma_f32_16x16x32_bf16 v[48:51], v[152:155], a[120:123], v[48:51]
    ds_read_b64_tr_b16 v[140:141], v224 offset:8192
    ds_read_b64_tr_b16 v[142:143], v224 offset:10240
    v_mfma_f32_16x16x32_bf16 v[56:59], v[152:155], a[124:127], v[56:59]
    buffer_load_dwordx4 v250, s[8:11], s22 offen offset:2048 lds
    v_mfma_f32_16x16x32_bf16 v[36:39], v[156:159], a[112:115], v[36:39]
    v_mfma_f32_16x16x32_bf16 v[44:47], v[156:159], a[116:119], v[44:47]
    v_mfma_f32_16x16x32_bf16 v[52:55], v[156:159], a[120:123], v[52:55]
    v_mfma_f32_16x16x32_bf16 v[60:63], v[156:159], a[124:127], v[60:63]
    s_waitcnt lgkmcnt(0)
    buffer_load_dwordx4 v251, s[8:11], s22 offen offset:3072 lds
    v_mfma_f32_16x16x32_bf16 v[0:3], v[128:131], a[128:131], v[0:3]
    s_waitcnt vmcnt(16)
    s_add_u32 m0, s23, 8192
    v_mfma_f32_16x16x32_bf16 v[8:11], v[128:131], a[132:135], v[8:11]
    s_add_u32 s22, s21, 458752
    ds_read_b64_tr_b16 v[144:145], v221 offset:12288
    ds_read_b64_tr_b16 v[146:147], v221 offset:14336
    v_mfma_f32_16x16x32_bf16 v[16:19], v[128:131], a[136:139], v[16:19]
    ds_read_b128 a[144:147], v220 offset:36864
    ds_read_b128 a[148:151], v220 offset:37888
    v_mfma_f32_16x16x32_bf16 v[24:27], v[128:131], a[140:143], v[24:27]
    buffer_load_dwordx4 v248, s[8:11], s22 offen offset:0 lds
    v_mfma_f32_16x16x32_bf16 v[4:7], v[132:135], a[128:131], v[4:7]
    ds_read_b128 a[152:155], v220 offset:38912
    ds_read_b128 a[156:159], v220 offset:39936
    v_mfma_f32_16x16x32_bf16 v[12:15], v[132:135], a[132:135], v[12:15]
    ds_read_b64_tr_b16 v[148:149], v222 offset:12288
    ds_read_b64_tr_b16 v[150:151], v222 offset:14336
    v_mfma_f32_16x16x32_bf16 v[20:23], v[132:135], a[136:139], v[20:23]
    ds_read_b64_tr_b16 v[152:153], v223 offset:12288
    ds_read_b64_tr_b16 v[154:155], v223 offset:14336
    v_mfma_f32_16x16x32_bf16 v[28:31], v[132:135], a[140:143], v[28:31]
    buffer_load_dwordx4 v249, s[8:11], s22 offen offset:1024 lds
    v_mfma_f32_16x16x32_bf16 v[32:35], v[136:139], a[128:131], v[32:35]
    s_lshl_b32 s62, s20, 14
    s_mul_i32 s60, s20, 458752
    s_lshr_b32 s63, s39, 2
    v_mfma_f32_16x16x32_bf16 v[40:43], v[136:139], a[132:135], v[40:43]
    s_lshl_b32 s63, s63, 7
    s_add_u32 s60, s60, s63
    s_mov_b32 s56, s80
    v_mfma_f32_16x16x32_bf16 v[48:51], v[136:139], a[136:139], v[48:51]
    ds_read_b64_tr_b16 v[156:157], v224 offset:12288
    ds_read_b64_tr_b16 v[158:159], v224 offset:14336
    v_mfma_f32_16x16x32_bf16 v[56:59], v[136:139], a[140:143], v[56:59]
    buffer_load_dwordx4 v250, s[8:11], s22 offen offset:2048 lds
    v_mfma_f32_16x16x32_bf16 v[36:39], v[140:143], a[128:131], v[36:39]
    v_mfma_f32_16x16x32_bf16 v[44:47], v[140:143], a[132:135], v[44:47]
    v_mfma_f32_16x16x32_bf16 v[52:55], v[140:143], a[136:139], v[52:55]
    v_mfma_f32_16x16x32_bf16 v[60:63], v[140:143], a[140:143], v[60:63]
    s_waitcnt lgkmcnt(0)
    buffer_load_dwordx4 v251, s[8:11], s22 offen offset:3072 lds
    v_mfma_f32_16x16x32_bf16 v[0:3], v[144:147], a[144:147], v[0:3]
    s_waitcnt vmcnt(16)
    s_add_u32 m0, s23, 12288
    v_mfma_f32_16x16x32_bf16 v[8:11], v[144:147], a[148:151], v[8:11]
    s_add_u32 s22, s21, 491520
    ds_read_b64_tr_b16 v[128:129], v225 offset:0
    ds_read_b64_tr_b16 v[130:131], v225 offset:2048
    v_mfma_f32_16x16x32_bf16 v[16:19], v[144:147], a[152:155], v[16:19]
    ds_read_b128 a[160:163], v220 offset:40960
    ds_read_b128 a[164:167], v220 offset:41984
    v_mfma_f32_16x16x32_bf16 v[24:27], v[144:147], a[156:159], v[24:27]
    buffer_load_dwordx4 v248, s[8:11], s22 offen offset:0 lds
    v_mfma_f32_16x16x32_bf16 v[4:7], v[148:151], a[144:147], v[4:7]
    ds_read_b128 a[168:171], v220 offset:43008
    ds_read_b128 a[172:175], v220 offset:44032
    v_mfma_f32_16x16x32_bf16 v[12:15], v[148:151], a[148:151], v[12:15]
    ds_read_b64_tr_b16 v[132:133], v226 offset:0
    ds_read_b64_tr_b16 v[134:135], v226 offset:2048
    v_mfma_f32_16x16x32_bf16 v[20:23], v[148:151], a[152:155], v[20:23]
    ds_read_b64_tr_b16 v[136:137], v227 offset:0
    ds_read_b64_tr_b16 v[138:139], v227 offset:2048
    v_mfma_f32_16x16x32_bf16 v[28:31], v[148:151], a[156:159], v[28:31]
    buffer_load_dwordx4 v249, s[8:11], s22 offen offset:1024 lds
    v_mfma_f32_16x16x32_bf16 v[32:35], v[152:155], a[144:147], v[32:35]
    ds_read_b64_tr_b16 v[140:141], v228 offset:0
    ds_read_b64_tr_b16 v[142:143], v228 offset:2048
    v_mfma_f32_16x16x32_bf16 v[40:43], v[152:155], a[148:151], v[40:43]
    s_mov_b32 s57, s81
    s_mov_b32 s58, 0x1c0000
    s_mov_b32 s59, 0x20000
    s_cmp_ge_u32 s39, 28
    s_cselect_b32 s50, 0, s50
    v_mfma_f32_16x16x32_bf16 v[48:51], v[152:155], a[152:155], v[48:51]
    v_mfma_f32_16x16x32_bf16 v[56:59], v[152:155], a[156:159], v[56:59]
    buffer_load_dwordx4 v250, s[8:11], s22 offen offset:2048 lds
    v_mfma_f32_16x16x32_bf16 v[36:39], v[156:159], a[144:147], v[36:39]
    v_mfma_f32_16x16x32_bf16 v[44:47], v[156:159], a[148:151], v[44:47]
    v_mfma_f32_16x16x32_bf16 v[52:55], v[156:159], a[152:155], v[52:55]
    v_mfma_f32_16x16x32_bf16 v[60:63], v[156:159], a[156:159], v[60:63]
    s_waitcnt lgkmcnt(0)
    buffer_load_dwordx4 v251, s[8:11], s22 offen offset:3072 lds
    v_mfma_f32_16x16x32_bf16 v[0:3], v[128:131], a[160:163], v[0:3]
    s_waitcnt vmcnt(16)
    s_add_u32 m0, s29, 65536
    v_mfma_f32_16x16x32_bf16 v[8:11], v[128:131], a[164:167], v[8:11]
    s_add_u32 s22, s21, 128
    ds_read_b64_tr_b16 v[144:145], v225 offset:4096
    ds_read_b64_tr_b16 v[146:147], v225 offset:6144
    v_mfma_f32_16x16x32_bf16 v[16:19], v[128:131], a[168:171], v[16:19]
    ds_read_b128 a[176:179], v220 offset:45056
    ds_read_b128 a[180:183], v220 offset:46080
    v_mfma_f32_16x16x32_bf16 v[24:27], v[128:131], a[172:175], v[24:27]
    buffer_load_dwordx4 v248, s[8:11], s22 offen offset:0 lds
    v_mfma_f32_16x16x32_bf16 v[4:7], v[132:135], a[160:163], v[4:7]
    ds_read_b128 a[184:187], v220 offset:47104
    ds_read_b128 a[188:191], v220 offset:48128
    v_mfma_f32_16x16x32_bf16 v[12:15], v[132:135], a[164:167], v[12:15]
    ds_read_b64_tr_b16 v[148:149], v226 offset:4096
    ds_read_b64_tr_b16 v[150:151], v226 offset:6144
    v_mfma_f32_16x16x32_bf16 v[20:23], v[132:135], a[168:171], v[20:23]
    ds_read_b64_tr_b16 v[152:153], v227 offset:4096
    ds_read_b64_tr_b16 v[154:155], v227 offset:6144
    v_mfma_f32_16x16x32_bf16 v[28:31], v[132:135], a[172:175], v[28:31]
    buffer_load_dwordx4 v249, s[8:11], s22 offen offset:1024 lds
    v_mfma_f32_16x16x32_bf16 v[32:35], v[136:139], a[160:163], v[32:35]
    ds_read_b64_tr_b16 v[156:157], v228 offset:4096
    ds_read_b64_tr_b16 v[158:159], v228 offset:6144
    v_mfma_f32_16x16x32_bf16 v[40:43], v[136:139], a[164:167], v[40:43]
    v_mfma_f32_16x16x32_bf16 v[48:51], v[136:139], a[168:171], v[48:51]
    v_mfma_f32_16x16x32_bf16 v[56:59], v[136:139], a[172:175], v[56:59]
    buffer_load_dwordx4 v250, s[8:11], s22 offen offset:2048 lds
    v_mfma_f32_16x16x32_bf16 v[36:39], v[140:143], a[160:163], v[36:39]
    v_mfma_f32_16x16x32_bf16 v[44:47], v[140:143], a[164:167], v[44:47]
    v_mfma_f32_16x16x32_bf16 v[52:55], v[140:143], a[168:171], v[52:55]
    v_mfma_f32_16x16x32_bf16 v[60:63], v[140:143], a[172:175], v[60:63]
    s_waitcnt lgkmcnt(0)
    buffer_load_dwordx4 v251, s[8:11], s22 offen offset:3072 lds
    v_mfma_f32_16x16x32_bf16 v[0:3], v[144:147], a[176:179], v[0:3]
    s_waitcnt vmcnt(16)
    s_add_u32 m0, s29, 69632
    v_mfma_f32_16x16x32_bf16 v[8:11], v[144:147], a[180:183], v[8:11]
    s_add_u32 s22, s21, 32896
    ds_read_b64_tr_b16 v[128:129], v221 offset:0
    ds_read_b64_tr_b16 v[130:131], v221 offset:2048
    v_mfma_f32_16x16x32_bf16 v[16:19], v[144:147], a[184:187], v[16:19]
    ds_read_b128 a[192:195], v220 offset:49152
    ds_read_b128 a[196:199], v220 offset:50176
    v_mfma_f32_16x16x32_bf16 v[24:27], v[144:147], a[188:191], v[24:27]
    buffer_load_dwordx4 v248, s[8:11], s22 offen offset:0 lds
    v_mfma_f32_16x16x32_bf16 v[4:7], v[148:151], a[176:179], v[4:7]
    ds_read_b128 a[200:203], v220 offset:51200
    ds_read_b128 a[204:207], v220 offset:52224
    v_mfma_f32_16x16x32_bf16 v[12:15], v[148:151], a[180:183], v[12:15]
    ds_read_b64_tr_b16 v[132:133], v222 offset:0
    ds_read_b64_tr_b16 v[134:135], v222 offset:2048
    v_mfma_f32_16x16x32_bf16 v[20:23], v[148:151], a[184:187], v[20:23]
    ds_read_b64_tr_b16 v[136:137], v223 offset:0
    ds_read_b64_tr_b16 v[138:139], v223 offset:2048
    v_mfma_f32_16x16x32_bf16 v[28:31], v[148:151], a[188:191], v[28:31]
    buffer_load_dwordx4 v249, s[8:11], s22 offen offset:1024 lds
    v_mfma_f32_16x16x32_bf16 v[32:35], v[152:155], a[176:179], v[32:35]
    ds_read_b64_tr_b16 v[140:141], v224 offset:0
    ds_read_b64_tr_b16 v[142:143], v224 offset:2048
    v_mfma_f32_16x16x32_bf16 v[40:43], v[152:155], a[180:183], v[40:43]
    v_mfma_f32_16x16x32_bf16 v[48:51], v[152:155], a[184:187], v[48:51]
    v_mfma_f32_16x16x32_bf16 v[56:59], v[152:155], a[188:191], v[56:59]
    buffer_load_dwordx4 v250, s[8:11], s22 offen offset:2048 lds
    v_mfma_f32_16x16x32_bf16 v[36:39], v[156:159], a[176:179], v[36:39]
    v_mfma_f32_16x16x32_bf16 v[44:47], v[156:159], a[180:183], v[44:47]
    v_mfma_f32_16x16x32_bf16 v[52:55], v[156:159], a[184:187], v[52:55]
    v_mfma_f32_16x16x32_bf16 v[60:63], v[156:159], a[188:191], v[60:63]
    s_waitcnt lgkmcnt(0)
    buffer_load_dwordx4 v251, s[8:11], s22 offen offset:3072 lds
    v_mfma_f32_16x16x32_bf16 v[0:3], v[128:131], a[192:195], v[0:3]
    s_waitcnt vmcnt(16)
    s_add_u32 m0, s23, 0
    v_mfma_f32_16x16x32_bf16 v[8:11], v[128:131], a[196:199], v[8:11]
    s_add_u32 s22, s21, 65664
    ds_read_b64_tr_b16 v[144:145], v221 offset:4096
    ds_read_b64_tr_b16 v[146:147], v221 offset:6144
    v_mfma_f32_16x16x32_bf16 v[16:19], v[128:131], a[200:203], v[16:19]
    ds_read_b128 a[208:211], v220 offset:53248
    ds_read_b128 a[212:215], v220 offset:54272
    v_mfma_f32_16x16x32_bf16 v[24:27], v[128:131], a[204:207], v[24:27]
    buffer_load_dwordx4 v248, s[8:11], s22 offen offset:0 lds
    v_mfma_f32_16x16x32_bf16 v[4:7], v[132:135], a[192:195], v[4:7]
    ds_read_b128 a[216:219], v220 offset:55296
    ds_read_b128 a[220:223], v220 offset:56320
    v_mfma_f32_16x16x32_bf16 v[12:15], v[132:135], a[196:199], v[12:15]
    ds_read_b64_tr_b16 v[148:149], v222 offset:4096
    ds_read_b64_tr_b16 v[150:151], v222 offset:6144
    v_mfma_f32_16x16x32_bf16 v[20:23], v[132:135], a[200:203], v[20:23]
    ds_read_b64_tr_b16 v[152:153], v223 offset:4096
    ds_read_b64_tr_b16 v[154:155], v223 offset:6144
    v_mfma_f32_16x16x32_bf16 v[28:31], v[132:135], a[204:207], v[28:31]
    buffer_load_dwordx4 v249, s[8:11], s22 offen offset:1024 lds
    v_mfma_f32_16x16x32_bf16 v[32:35], v[136:139], a[192:195], v[32:35]
    ds_read_b64_tr_b16 v[156:157], v224 offset:4096
    ds_read_b64_tr_b16 v[158:159], v224 offset:6144
    v_mfma_f32_16x16x32_bf16 v[40:43], v[136:139], a[196:199], v[40:43]
    v_mfma_f32_16x16x32_bf16 v[48:51], v[136:139], a[200:203], v[48:51]
    v_mfma_f32_16x16x32_bf16 v[56:59], v[136:139], a[204:207], v[56:59]
    buffer_load_dwordx4 v250, s[8:11], s22 offen offset:2048 lds
    v_mfma_f32_16x16x32_bf16 v[36:39], v[140:143], a[192:195], v[36:39]
    v_mfma_f32_16x16x32_bf16 v[44:47], v[140:143], a[196:199], v[44:47]
    v_mfma_f32_16x16x32_bf16 v[52:55], v[140:143], a[200:203], v[52:55]
    v_mfma_f32_16x16x32_bf16 v[60:63], v[140:143], a[204:207], v[60:63]
    s_waitcnt lgkmcnt(0)
    buffer_load_dwordx4 v251, s[8:11], s22 offen offset:3072 lds
    v_mfma_f32_16x16x32_bf16 v[0:3], v[144:147], a[208:211], v[0:3]
    s_waitcnt vmcnt(16)
    s_add_u32 m0, s23, 4096
    v_mfma_f32_16x16x32_bf16 v[8:11], v[144:147], a[212:215], v[8:11]
    s_add_u32 s22, s21, 98432
    ds_read_b64_tr_b16 v[128:129], v221 offset:8192
    ds_read_b64_tr_b16 v[130:131], v221 offset:10240
    v_mfma_f32_16x16x32_bf16 v[16:19], v[144:147], a[216:219], v[16:19]
    ds_read_b128 a[224:227], v220 offset:57344
    ds_read_b128 a[228:231], v220 offset:58368
    v_mfma_f32_16x16x32_bf16 v[24:27], v[144:147], a[220:223], v[24:27]
    buffer_load_dwordx4 v248, s[8:11], s22 offen offset:0 lds
    v_mfma_f32_16x16x32_bf16 v[4:7], v[148:151], a[208:211], v[4:7]
    ds_read_b128 a[232:235], v220 offset:59392
    ds_read_b128 a[236:239], v220 offset:60416
    v_mfma_f32_16x16x32_bf16 v[12:15], v[148:151], a[212:215], v[12:15]
    ds_read_b64_tr_b16 v[132:133], v222 offset:8192
    ds_read_b64_tr_b16 v[134:135], v222 offset:10240
    v_mfma_f32_16x16x32_bf16 v[20:23], v[148:151], a[216:219], v[20:23]
    ds_read_b64_tr_b16 v[136:137], v223 offset:8192
    ds_read_b64_tr_b16 v[138:139], v223 offset:10240
    v_mfma_f32_16x16x32_bf16 v[28:31], v[148:151], a[220:223], v[28:31]
    buffer_load_dwordx4 v249, s[8:11], s22 offen offset:1024 lds
    v_mfma_f32_16x16x32_bf16 v[32:35], v[152:155], a[208:211], v[32:35]
    ds_read_b64_tr_b16 v[140:141], v224 offset:8192
    ds_read_b64_tr_b16 v[142:143], v224 offset:10240
    v_mfma_f32_16x16x32_bf16 v[40:43], v[152:155], a[212:215], v[40:43]
    v_mfma_f32_16x16x32_bf16 v[48:51], v[152:155], a[216:219], v[48:51]
    v_mfma_f32_16x16x32_bf16 v[56:59], v[152:155], a[220:223], v[56:59]
    buffer_load_dwordx4 v250, s[8:11], s22 offen offset:2048 lds
    v_mfma_f32_16x16x32_bf16 v[36:39], v[156:159], a[208:211], v[36:39]
    v_mfma_f32_16x16x32_bf16 v[44:47], v[156:159], a[212:215], v[44:47]
    v_mfma_f32_16x16x32_bf16 v[52:55], v[156:159], a[216:219], v[52:55]
    v_mfma_f32_16x16x32_bf16 v[60:63], v[156:159], a[220:223], v[60:63]
    s_waitcnt lgkmcnt(0)
    buffer_load_dwordx4 v251, s[8:11], s22 offen offset:3072 lds
    v_mfma_f32_16x16x32_bf16 v[0:3], v[128:131], a[224:227], v[0:3]
    s_waitcnt vmcnt(16)
    s_add_u32 m0, s23, 8192
    v_mfma_f32_16x16x32_bf16 v[8:11], v[128:131], a[228:231], v[8:11]
    s_add_u32 s22, s21, 131200
    ds_read_b64_tr_b16 v[144:145], v221 offset:12288
    ds_read_b64_tr_b16 v[146:147], v221 offset:14336
    v_mfma_f32_16x16x32_bf16 v[16:19], v[128:131], a[232:235], v[16:19]
    ds_read_b128 a[240:243], v220 offset:61440
    ds_read_b128 a[244:247], v220 offset:62464
    v_mfma_f32_16x16x32_bf16 v[24:27], v[128:131], a[236:239], v[24:27]
    buffer_load_dwordx4 v248, s[8:11], s22 offen offset:0 lds
    v_mfma_f32_16x16x32_bf16 v[4:7], v[132:135], a[224:227], v[4:7]
    ds_read_b128 a[248:251], v220 offset:63488
    ds_read_b128 a[252:255], v220 offset:64512
    v_mfma_f32_16x16x32_bf16 v[12:15], v[132:135], a[228:231], v[12:15]
    ds_read_b64_tr_b16 v[148:149], v222 offset:12288
    ds_read_b64_tr_b16 v[150:151], v222 offset:14336
    v_mfma_f32_16x16x32_bf16 v[20:23], v[132:135], a[232:235], v[20:23]
    ds_read_b64_tr_b16 v[152:153], v223 offset:12288
    ds_read_b64_tr_b16 v[154:155], v223 offset:14336
    v_mfma_f32_16x16x32_bf16 v[28:31], v[132:135], a[236:239], v[28:31]
    buffer_load_dwordx4 v249, s[8:11], s22 offen offset:1024 lds
    v_mfma_f32_16x16x32_bf16 v[32:35], v[136:139], a[224:227], v[32:35]
    ds_read_b64_tr_b16 v[156:157], v224 offset:12288
    ds_read_b64_tr_b16 v[158:159], v224 offset:14336
    v_mfma_f32_16x16x32_bf16 v[40:43], v[136:139], a[228:231], v[40:43]
    v_mfma_f32_16x16x32_bf16 v[48:51], v[136:139], a[232:235], v[48:51]
    v_mfma_f32_16x16x32_bf16 v[56:59], v[136:139], a[236:239], v[56:59]
    buffer_load_dwordx4 v250, s[8:11], s22 offen offset:2048 lds
    v_mfma_f32_16x16x32_bf16 v[36:39], v[140:143], a[224:227], v[36:39]
    v_mfma_f32_16x16x32_bf16 v[44:47], v[140:143], a[228:231], v[44:47]
    v_mfma_f32_16x16x32_bf16 v[52:55], v[140:143], a[232:235], v[52:55]
    v_mfma_f32_16x16x32_bf16 v[60:63], v[140:143], a[236:239], v[60:63]
    s_waitcnt lgkmcnt(0)
    buffer_load_dwordx4 v251, s[8:11], s22 offen offset:3072 lds
    v_mfma_f32_16x16x32_bf16 v[0:3], v[144:147], a[240:243], v[0:3]
    s_waitcnt vmcnt(16)
    s_add_u32 m0, s23, 12288
    v_mfma_f32_16x16x32_bf16 v[8:11], v[144:147], a[244:247], v[8:11]
    s_add_u32 s22, s21, 163968
    ds_read_b64_tr_b16 v[128:129], v225 offset:0
    v_mfma_f32_16x16x32_bf16 v[16:19], v[144:147], a[248:251], v[16:19]
    ds_read_b64_tr_b16 v[130:131], v225 offset:2048
    v_mfma_f32_16x16x32_bf16 v[24:27], v[144:147], a[252:255], v[24:27]
    buffer_load_dwordx4 v248, s[8:11], s22 offen offset:0 lds
    v_mfma_f32_16x16x32_bf16 v[4:7], v[148:151], a[240:243], v[4:7]
    ds_read_b64_tr_b16 v[132:133], v226 offset:0
    v_mfma_f32_16x16x32_bf16 v[12:15], v[148:151], a[244:247], v[12:15]
    ds_read_b64_tr_b16 v[134:135], v226 offset:2048
    v_mfma_f32_16x16x32_bf16 v[20:23], v[148:151], a[248:251], v[20:23]
    ds_read_b64_tr_b16 v[136:137], v227 offset:0
    v_mfma_f32_16x16x32_bf16 v[28:31], v[148:151], a[252:255], v[28:31]
    buffer_load_dwordx4 v249, s[8:11], s22 offen offset:1024 lds
    v_mfma_f32_16x16x32_bf16 v[32:35], v[152:155], a[240:243], v[32:35]
    ds_read_b64_tr_b16 v[138:139], v227 offset:2048
    v_mfma_f32_16x16x32_bf16 v[40:43], v[152:155], a[244:247], v[40:43]
    ds_read_b64_tr_b16 v[140:141], v228 offset:0
    v_mfma_f32_16x16x32_bf16 v[48:51], v[152:155], a[248:251], v[48:51]
    ds_read_b64_tr_b16 v[142:143], v228 offset:2048
    v_mfma_f32_16x16x32_bf16 v[56:59], v[152:155], a[252:255], v[56:59]
    buffer_load_dwordx4 v250, s[8:11], s22 offen offset:2048 lds
    v_mfma_f32_16x16x32_bf16 v[36:39], v[156:159], a[240:243], v[36:39]
    v_mfma_f32_16x16x32_bf16 v[44:47], v[156:159], a[244:247], v[44:47]
    v_mfma_f32_16x16x32_bf16 v[52:55], v[156:159], a[248:251], v[52:55]
    v_mfma_f32_16x16x32_bf16 v[60:63], v[156:159], a[252:255], v[60:63]
    s_waitcnt lgkmcnt(0)
    buffer_load_dwordx4 v251, s[8:11], s22 offen offset:3072 lds
    v_mfma_f32_16x16x32_bf16 v[64:67], v[128:131], a[0:3], 0
    s_waitcnt vmcnt(16)
    s_add_u32 m0, s29, 65536
    v_mfma_f32_16x16x32_bf16 v[72:75], v[128:131], a[4:7], 0
    s_add_u32 s22, s21, 196736
    ds_read_b64_tr_b16 v[144:145], v225 offset:4096
    v_mfma_f32_16x16x32_bf16 v[80:83], v[128:131], a[8:11], 0
    ds_read_b64_tr_b16 v[146:147], v225 offset:6144
    v_mfma_f32_16x16x32_bf16 v[88:91], v[128:131], a[12:15], 0
    buffer_load_dwordx4 v248, s[8:11], s22 offen offset:0 lds
    v_mfma_f32_16x16x32_bf16 v[68:71], v[132:135], a[0:3], 0
    ds_read_b64_tr_b16 v[148:149], v226 offset:4096
    v_mfma_f32_16x16x32_bf16 v[76:79], v[132:135], a[4:7], 0
    ds_read_b64_tr_b16 v[150:151], v226 offset:6144
    v_mfma_f32_16x16x32_bf16 v[84:87], v[132:135], a[8:11], 0
    ds_read_b64_tr_b16 v[152:153], v227 offset:4096
    v_mfma_f32_16x16x32_bf16 v[92:95], v[132:135], a[12:15], 0
    buffer_load_dwordx4 v249, s[8:11], s22 offen offset:1024 lds
    v_mfma_f32_16x16x32_bf16 v[96:99], v[136:139], a[0:3], 0
    ds_read_b64_tr_b16 v[154:155], v227 offset:6144
    v_mfma_f32_16x16x32_bf16 v[104:107], v[136:139], a[4:7], 0
    ds_read_b64_tr_b16 v[156:157], v228 offset:4096
    v_mfma_f32_16x16x32_bf16 v[112:115], v[136:139], a[8:11], 0
    ds_read_b64_tr_b16 v[158:159], v228 offset:6144
    v_mfma_f32_16x16x32_bf16 v[120:123], v[136:139], a[12:15], 0
    buffer_load_dwordx4 v250, s[8:11], s22 offen offset:2048 lds
    v_mfma_f32_16x16x32_bf16 v[100:103], v[140:143], a[0:3], 0
    v_mfma_f32_16x16x32_bf16 v[108:111], v[140:143], a[4:7], 0
    v_mfma_f32_16x16x32_bf16 v[116:119], v[140:143], a[8:11], 0
    v_mfma_f32_16x16x32_bf16 v[124:127], v[140:143], a[12:15], 0
    s_waitcnt lgkmcnt(0)
    buffer_load_dwordx4 v251, s[8:11], s22 offen offset:3072 lds
    v_mfma_f32_16x16x32_bf16 v[64:67], v[144:147], a[16:19], v[64:67]
    s_waitcnt vmcnt(16)
    s_add_u32 m0, s29, 69632
    v_mfma_f32_16x16x32_bf16 v[72:75], v[144:147], a[20:23], v[72:75]
    s_add_u32 s22, s21, 229504
    ds_read_b64_tr_b16 v[128:129], v221 offset:0
    v_mfma_f32_16x16x32_bf16 v[80:83], v[144:147], a[24:27], v[80:83]
    ds_read_b64_tr_b16 v[130:131], v221 offset:2048
    v_cvt_pk_bf16_f32 v0, v0, v1
    v_mfma_f32_16x16x32_bf16 v[88:91], v[144:147], a[28:31], v[88:91]
    buffer_load_dwordx4 v248, s[8:11], s22 offen offset:0 lds
    v_mfma_f32_16x16x32_bf16 v[68:71], v[148:151], a[16:19], v[68:71]
    ds_read_b64_tr_b16 v[132:133], v222 offset:0
    v_mfma_f32_16x16x32_bf16 v[76:79], v[148:151], a[20:23], v[76:79]
    ds_read_b64_tr_b16 v[134:135], v222 offset:2048
    v_mfma_f32_16x16x32_bf16 v[84:87], v[148:151], a[24:27], v[84:87]
    ds_read_b64_tr_b16 v[136:137], v223 offset:0
    v_mfma_f32_16x16x32_bf16 v[92:95], v[148:151], a[28:31], v[92:95]
    buffer_load_dwordx4 v249, s[8:11], s22 offen offset:1024 lds
    v_mfma_f32_16x16x32_bf16 v[96:99], v[152:155], a[16:19], v[96:99]
    ds_read_b64_tr_b16 v[138:139], v223 offset:2048
    v_mfma_f32_16x16x32_bf16 v[104:107], v[152:155], a[20:23], v[104:107]
    ds_read_b64_tr_b16 v[140:141], v224 offset:0
    v_mfma_f32_16x16x32_bf16 v[112:115], v[152:155], a[24:27], v[112:115]
    ds_read_b64_tr_b16 v[142:143], v224 offset:2048
    v_mfma_f32_16x16x32_bf16 v[120:123], v[152:155], a[28:31], v[120:123]
    buffer_load_dwordx4 v250, s[8:11], s22 offen offset:2048 lds
    v_mfma_f32_16x16x32_bf16 v[100:103], v[156:159], a[16:19], v[100:103]
    v_cvt_pk_bf16_f32 v1, v2, v3
    v_mfma_f32_16x16x32_bf16 v[108:111], v[156:159], a[20:23], v[108:111]
    v_cvt_pk_bf16_f32 v2, v4, v5
    v_mfma_f32_16x16x32_bf16 v[116:119], v[156:159], a[24:27], v[116:119]
    v_cvt_pk_bf16_f32 v3, v6, v7
    v_mfma_f32_16x16x32_bf16 v[124:127], v[156:159], a[28:31], v[124:127]
    s_waitcnt lgkmcnt(0)
    buffer_load_dwordx4 v251, s[8:11], s22 offen offset:3072 lds
    v_mfma_f32_16x16x32_bf16 v[64:67], v[128:131], a[32:35], v[64:67]
    s_waitcnt vmcnt(16)
    s_add_u32 m0, s23, 0
    v_mfma_f32_16x16x32_bf16 v[72:75], v[128:131], a[36:39], v[72:75]
    s_add_u32 s22, s21, 262272
    ds_read_b64_tr_b16 v[144:145], v221 offset:4096
    v_mfma_f32_16x16x32_bf16 v[80:83], v[128:131], a[40:43], v[80:83]
    ds_read_b64_tr_b16 v[146:147], v221 offset:6144
    v_cvt_pk_bf16_f32 v8, v8, v9
    v_mfma_f32_16x16x32_bf16 v[88:91], v[128:131], a[44:47], v[88:91]
    buffer_load_dwordx4 v248, s[8:11], s22 offen offset:0 lds
    v_mfma_f32_16x16x32_bf16 v[68:71], v[132:135], a[32:35], v[68:71]
    ds_read_b64_tr_b16 v[148:149], v222 offset:4096
    v_mfma_f32_16x16x32_bf16 v[76:79], v[132:135], a[36:39], v[76:79]
    ds_read_b64_tr_b16 v[150:151], v222 offset:6144
    v_mfma_f32_16x16x32_bf16 v[84:87], v[132:135], a[40:43], v[84:87]
    ds_read_b64_tr_b16 v[152:153], v223 offset:4096
    v_mfma_f32_16x16x32_bf16 v[92:95], v[132:135], a[44:47], v[92:95]
    buffer_load_dwordx4 v249, s[8:11], s22 offen offset:1024 lds
    v_mfma_f32_16x16x32_bf16 v[96:99], v[136:139], a[32:35], v[96:99]
    ds_read_b64_tr_b16 v[154:155], v223 offset:6144
    v_mfma_f32_16x16x32_bf16 v[104:107], v[136:139], a[36:39], v[104:107]
    ds_read_b64_tr_b16 v[156:157], v224 offset:4096
    v_mfma_f32_16x16x32_bf16 v[112:115], v[136:139], a[40:43], v[112:115]
    ds_read_b64_tr_b16 v[158:159], v224 offset:6144
    v_mfma_f32_16x16x32_bf16 v[120:123], v[136:139], a[44:47], v[120:123]
    buffer_load_dwordx4 v250, s[8:11], s22 offen offset:2048 lds
    v_mfma_f32_16x16x32_bf16 v[100:103], v[140:143], a[32:35], v[100:103]
    v_cvt_pk_bf16_f32 v9, v10, v11
    v_mfma_f32_16x16x32_bf16 v[108:111], v[140:143], a[36:39], v[108:111]
    v_cvt_pk_bf16_f32 v10, v12, v13
    v_mfma_f32_16x16x32_bf16 v[116:119], v[140:143], a[40:43], v[116:119]
    v_cvt_pk_bf16_f32 v11, v14, v15
    v_mfma_f32_16x16x32_bf16 v[124:127], v[140:143], a[44:47], v[124:127]
    s_waitcnt lgkmcnt(0)
    buffer_load_dwordx4 v251, s[8:11], s22 offen offset:3072 lds
    v_mfma_f32_16x16x32_bf16 v[64:67], v[144:147], a[48:51], v[64:67]
    s_waitcnt vmcnt(16)
    s_add_u32 m0, s23, 4096
    v_mfma_f32_16x16x32_bf16 v[72:75], v[144:147], a[52:55], v[72:75]
    s_add_u32 s22, s21, 295040
    ds_read_b64_tr_b16 v[128:129], v221 offset:8192
    v_mfma_f32_16x16x32_bf16 v[80:83], v[144:147], a[56:59], v[80:83]
    ds_read_b64_tr_b16 v[130:131], v221 offset:10240
    v_cvt_pk_bf16_f32 v16, v16, v17
    v_mfma_f32_16x16x32_bf16 v[88:91], v[144:147], a[60:63], v[88:91]
    buffer_load_dwordx4 v248, s[8:11], s22 offen offset:0 lds
    v_mfma_f32_16x16x32_bf16 v[68:71], v[148:151], a[48:51], v[68:71]
    ds_read_b64_tr_b16 v[132:133], v222 offset:8192
    v_mfma_f32_16x16x32_bf16 v[76:79], v[148:151], a[52:55], v[76:79]
    ds_read_b64_tr_b16 v[134:135], v222 offset:10240
    v_mfma_f32_16x16x32_bf16 v[84:87], v[148:151], a[56:59], v[84:87]
    ds_read_b64_tr_b16 v[136:137], v223 offset:8192
    v_mfma_f32_16x16x32_bf16 v[92:95], v[148:151], a[60:63], v[92:95]
    buffer_load_dwordx4 v249, s[8:11], s22 offen offset:1024 lds
    v_mfma_f32_16x16x32_bf16 v[96:99], v[152:155], a[48:51], v[96:99]
    ds_read_b64_tr_b16 v[138:139], v223 offset:10240
    v_mfma_f32_16x16x32_bf16 v[104:107], v[152:155], a[52:55], v[104:107]
    ds_read_b64_tr_b16 v[140:141], v224 offset:8192
    v_mfma_f32_16x16x32_bf16 v[112:115], v[152:155], a[56:59], v[112:115]
    ds_read_b64_tr_b16 v[142:143], v224 offset:10240
    v_mfma_f32_16x16x32_bf16 v[120:123], v[152:155], a[60:63], v[120:123]
    buffer_load_dwordx4 v250, s[8:11], s22 offen offset:2048 lds
    v_mfma_f32_16x16x32_bf16 v[100:103], v[156:159], a[48:51], v[100:103]
    v_cvt_pk_bf16_f32 v17, v18, v19
    v_mfma_f32_16x16x32_bf16 v[108:111], v[156:159], a[52:55], v[108:111]
    v_cvt_pk_bf16_f32 v18, v20, v21
    v_mfma_f32_16x16x32_bf16 v[116:119], v[156:159], a[56:59], v[116:119]
    v_cvt_pk_bf16_f32 v19, v22, v23
    v_mfma_f32_16x16x32_bf16 v[124:127], v[156:159], a[60:63], v[124:127]
    s_waitcnt lgkmcnt(0)
    buffer_load_dwordx4 v251, s[8:11], s22 offen offset:3072 lds
    v_mfma_f32_16x16x32_bf16 v[64:67], v[128:131], a[64:67], v[64:67]
    s_waitcnt vmcnt(16)
    s_add_u32 m0, s23, 8192
    v_mfma_f32_16x16x32_bf16 v[72:75], v[128:131], a[68:71], v[72:75]
    s_add_u32 s22, s21, 327808
    s_barrier
    ds_read_b64_tr_b16 v[144:145], v221 offset:12288
    v_mfma_f32_16x16x32_bf16 v[80:83], v[128:131], a[72:75], v[80:83]
    ds_read_b64_tr_b16 v[146:147], v221 offset:14336
    ds_read_b64_tr_b16 v[148:149], v222 offset:12288
    v_mfma_f32_16x16x32_bf16 v[88:91], v[128:131], a[76:79], v[88:91]
    buffer_load_dwordx4 v248, s[8:11], s22 offen offset:0 lds
    v_mfma_f32_16x16x32_bf16 v[68:71], v[132:135], a[64:67], v[68:71]
    ds_read_b64_tr_b16 v[150:151], v222 offset:14336
    ds_read_b64_tr_b16 v[152:153], v223 offset:12288
    v_mfma_f32_16x16x32_bf16 v[76:79], v[132:135], a[68:71], v[76:79]
    ds_read_b64_tr_b16 v[154:155], v223 offset:14336
    ds_read_b64_tr_b16 v[156:157], v224 offset:12288
    v_mfma_f32_16x16x32_bf16 v[84:87], v[132:135], a[72:75], v[84:87]
    ds_read_b64_tr_b16 v[158:159], v224 offset:14336
    v_mfma_f32_16x16x32_bf16 v[92:95], v[132:135], a[76:79], v[92:95]
    buffer_load_dwordx4 v249, s[8:11], s22 offen offset:1024 lds
    v_mfma_f32_16x16x32_bf16 v[96:99], v[136:139], a[64:67], v[96:99]
    v_mfma_f32_16x16x32_bf16 v[104:107], v[136:139], a[68:71], v[104:107]
    v_mfma_f32_16x16x32_bf16 v[112:115], v[136:139], a[72:75], v[112:115]
    v_cvt_pk_bf16_f32 v24, v24, v25
    v_mfma_f32_16x16x32_bf16 v[120:123], v[136:139], a[76:79], v[120:123]
    buffer_load_dwordx4 v250, s[8:11], s22 offen offset:2048 lds
    v_mfma_f32_16x16x32_bf16 v[100:103], v[140:143], a[64:67], v[100:103]
    v_cvt_pk_bf16_f32 v25, v26, v27
    v_mfma_f32_16x16x32_bf16 v[108:111], v[140:143], a[68:71], v[108:111]
    v_cvt_pk_bf16_f32 v26, v28, v29
    v_mfma_f32_16x16x32_bf16 v[116:119], v[140:143], a[72:75], v[116:119]
    v_cvt_pk_bf16_f32 v27, v30, v31
    v_mfma_f32_16x16x32_bf16 v[124:127], v[140:143], a[76:79], v[124:127]
    s_waitcnt lgkmcnt(0)
    buffer_load_dwordx4 v251, s[8:11], s22 offen offset:3072 lds
    v_mfma_f32_16x16x32_bf16 v[64:67], v[144:147], a[80:83], v[64:67]
    s_waitcnt vmcnt(16)
    s_add_u32 m0, s23, 12288
    v_mfma_f32_16x16x32_bf16 v[72:75], v[144:147], a[84:87], v[72:75]
    s_add_u32 s22, s21, 360576
    ds_read_b64_tr_b16 v[128:129], v225 offset:0
    v_mfma_f32_16x16x32_bf16 v[80:83], v[144:147], a[88:91], v[80:83]
    ds_read_b64_tr_b16 v[130:131], v225 offset:2048
    v_cvt_pk_bf16_f32 v32, v32, v33
    v_mfma_f32_16x16x32_bf16 v[88:91], v[144:147], a[92:95], v[88:91]
    buffer_load_dwordx4 v248, s[8:11], s22 offen offset:0 lds
    v_mfma_f32_16x16x32_bf16 v[68:71], v[148:151], a[80:83], v[68:71]
    ds_read_b64_tr_b16 v[132:133], v226 offset:0
    v_mfma_f32_16x16x32_bf16 v[76:79], v[148:151], a[84:87], v[76:79]
    ds_read_b64_tr_b16 v[134:135], v226 offset:2048
    v_mfma_f32_16x16x32_bf16 v[84:87], v[148:151], a[88:91], v[84:87]
    ds_read_b64_tr_b16 v[136:137], v227 offset:0
    v_mfma_f32_16x16x32_bf16 v[92:95], v[148:151], a[92:95], v[92:95]
    buffer_load_dwordx4 v249, s[8:11], s22 offen offset:1024 lds
    v_mfma_f32_16x16x32_bf16 v[96:99], v[152:155], a[80:83], v[96:99]
    ds_read_b64_tr_b16 v[138:139], v227 offset:2048
    v_mfma_f32_16x16x32_bf16 v[104:107], v[152:155], a[84:87], v[104:107]
    ds_read_b64_tr_b16 v[140:141], v228 offset:0
    v_mfma_f32_16x16x32_bf16 v[112:115], v[152:155], a[88:91], v[112:115]
    ds_read_b64_tr_b16 v[142:143], v228 offset:2048
    v_mfma_f32_16x16x32_bf16 v[120:123], v[152:155], a[92:95], v[120:123]
    buffer_load_dwordx4 v250, s[8:11], s22 offen offset:2048 lds
    v_mfma_f32_16x16x32_bf16 v[100:103], v[156:159], a[80:83], v[100:103]
    v_cvt_pk_bf16_f32 v33, v34, v35
    v_mfma_f32_16x16x32_bf16 v[108:111], v[156:159], a[84:87], v[108:111]
    v_cvt_pk_bf16_f32 v34, v36, v37
    v_mfma_f32_16x16x32_bf16 v[116:119], v[156:159], a[88:91], v[116:119]
    v_cvt_pk_bf16_f32 v35, v38, v39
    v_mfma_f32_16x16x32_bf16 v[124:127], v[156:159], a[92:95], v[124:127]
    s_waitcnt lgkmcnt(0)
    buffer_load_dwordx4 v251, s[8:11], s22 offen offset:3072 lds
    v_mfma_f32_16x16x32_bf16 v[64:67], v[128:131], a[96:99], v[64:67]
    s_waitcnt vmcnt(16)
    s_add_u32 m0, s29, 65536
    v_mfma_f32_16x16x32_bf16 v[72:75], v[128:131], a[100:103], v[72:75]
    s_add_u32 s22, s21, 393344
    ds_read_b64_tr_b16 v[144:145], v225 offset:4096
    v_mfma_f32_16x16x32_bf16 v[80:83], v[128:131], a[104:107], v[80:83]
    ds_read_b64_tr_b16 v[146:147], v225 offset:6144
    v_cvt_pk_bf16_f32 v40, v40, v41
    v_mfma_f32_16x16x32_bf16 v[88:91], v[128:131], a[108:111], v[88:91]
    buffer_load_dwordx4 v248, s[8:11], s22 offen offset:0 lds
    v_mfma_f32_16x16x32_bf16 v[68:71], v[132:135], a[96:99], v[68:71]
    ds_read_b64_tr_b16 v[148:149], v226 offset:4096
    v_mfma_f32_16x16x32_bf16 v[76:79], v[132:135], a[100:103], v[76:79]
    ds_read_b64_tr_b16 v[150:151], v226 offset:6144
    v_mfma_f32_16x16x32_bf16 v[84:87], v[132:135], a[104:107], v[84:87]
    ds_read_b64_tr_b16 v[152:153], v227 offset:4096
    v_mfma_f32_16x16x32_bf16 v[92:95], v[132:135], a[108:111], v[92:95]
    buffer_load_dwordx4 v249, s[8:11], s22 offen offset:1024 lds
    v_mfma_f32_16x16x32_bf16 v[96:99], v[136:139], a[96:99], v[96:99]
    ds_read_b64_tr_b16 v[154:155], v227 offset:6144
    v_mfma_f32_16x16x32_bf16 v[104:107], v[136:139], a[100:103], v[104:107]
    ds_read_b64_tr_b16 v[156:157], v228 offset:4096
    v_mfma_f32_16x16x32_bf16 v[112:115], v[136:139], a[104:107], v[112:115]
    ds_read_b64_tr_b16 v[158:159], v228 offset:6144
    v_mfma_f32_16x16x32_bf16 v[120:123], v[136:139], a[108:111], v[120:123]
    buffer_load_dwordx4 v250, s[8:11], s22 offen offset:2048 lds
    v_mfma_f32_16x16x32_bf16 v[100:103], v[140:143], a[96:99], v[100:103]
    v_cvt_pk_bf16_f32 v41, v42, v43
    v_mfma_f32_16x16x32_bf16 v[108:111], v[140:143], a[100:103], v[108:111]
    v_cvt_pk_bf16_f32 v42, v44, v45
    v_mfma_f32_16x16x32_bf16 v[116:119], v[140:143], a[104:107], v[116:119]
    v_cvt_pk_bf16_f32 v43, v46, v47
    v_mfma_f32_16x16x32_bf16 v[124:127], v[140:143], a[108:111], v[124:127]
    s_waitcnt lgkmcnt(0)
    buffer_load_dwordx4 v251, s[8:11], s22 offen offset:3072 lds
    v_mfma_f32_16x16x32_bf16 v[64:67], v[144:147], a[112:115], v[64:67]
    s_waitcnt vmcnt(16)
    s_add_u32 m0, s29, 69632
    v_mfma_f32_16x16x32_bf16 v[72:75], v[144:147], a[116:119], v[72:75]
    s_add_u32 s22, s21, 426112
    ds_read_b64_tr_b16 v[128:129], v221 offset:0
    v_mfma_f32_16x16x32_bf16 v[80:83], v[144:147], a[120:123], v[80:83]
    ds_read_b64_tr_b16 v[130:131], v221 offset:2048
    v_cvt_pk_bf16_f32 v48, v48, v49
    v_mfma_f32_16x16x32_bf16 v[88:91], v[144:147], a[124:127], v[88:91]
    buffer_load_dwordx4 v248, s[8:11], s22 offen offset:0 lds
    v_mfma_f32_16x16x32_bf16 v[68:71], v[148:151], a[112:115], v[68:71]
    ds_read_b64_tr_b16 v[132:133], v222 offset:0
    v_mfma_f32_16x16x32_bf16 v[76:79], v[148:151], a[116:119], v[76:79]
    ds_read_b64_tr_b16 v[134:135], v222 offset:2048
    v_mfma_f32_16x16x32_bf16 v[84:87], v[148:151], a[120:123], v[84:87]
    ds_read_b64_tr_b16 v[136:137], v223 offset:0
    v_mfma_f32_16x16x32_bf16 v[92:95], v[148:151], a[124:127], v[92:95]
    buffer_load_dwordx4 v249, s[8:11], s22 offen offset:1024 lds
    v_mfma_f32_16x16x32_bf16 v[96:99], v[152:155], a[112:115], v[96:99]
    ds_read_b64_tr_b16 v[138:139], v223 offset:2048
    v_mfma_f32_16x16x32_bf16 v[104:107], v[152:155], a[116:119], v[104:107]
    ds_read_b64_tr_b16 v[140:141], v224 offset:0
    v_mfma_f32_16x16x32_bf16 v[112:115], v[152:155], a[120:123], v[112:115]
    ds_read_b64_tr_b16 v[142:143], v224 offset:2048
    v_mfma_f32_16x16x32_bf16 v[120:123], v[152:155], a[124:127], v[120:123]
    buffer_load_dwordx4 v250, s[8:11], s22 offen offset:2048 lds
    v_mfma_f32_16x16x32_bf16 v[100:103], v[156:159], a[112:115], v[100:103]
    v_cvt_pk_bf16_f32 v49, v50, v51
    v_mfma_f32_16x16x32_bf16 v[108:111], v[156:159], a[116:119], v[108:111]
    v_cvt_pk_bf16_f32 v50, v52, v53
    v_mfma_f32_16x16x32_bf16 v[116:119], v[156:159], a[120:123], v[116:119]
    v_cvt_pk_bf16_f32 v51, v54, v55
    v_mfma_f32_16x16x32_bf16 v[124:127], v[156:159], a[124:127], v[124:127]
    s_waitcnt lgkmcnt(0)
    buffer_load_dwordx4 v251, s[8:11], s22 offen offset:3072 lds
    v_mfma_f32_16x16x32_bf16 v[64:67], v[128:131], a[128:131], v[64:67]
    s_waitcnt vmcnt(16)
    s_add_u32 m0, s23, 0
    v_mfma_f32_16x16x32_bf16 v[72:75], v[128:131], a[132:135], v[72:75]
    s_add_u32 s22, s21, 458880
    ds_read_b64_tr_b16 v[144:145], v221 offset:4096
    v_mfma_f32_16x16x32_bf16 v[80:83], v[128:131], a[136:139], v[80:83]
    ds_read_b64_tr_b16 v[146:147], v221 offset:6144
    v_cvt_pk_bf16_f32 v56, v56, v57
    v_mfma_f32_16x16x32_bf16 v[88:91], v[128:131], a[140:143], v[88:91]
    buffer_load_dwordx4 v248, s[8:11], s22 offen offset:0 lds
    v_mfma_f32_16x16x32_bf16 v[68:71], v[132:135], a[128:131], v[68:71]
    ds_read_b64_tr_b16 v[148:149], v222 offset:4096
    v_mfma_f32_16x16x32_bf16 v[76:79], v[132:135], a[132:135], v[76:79]
    ds_read_b64_tr_b16 v[150:151], v222 offset:6144
    v_mfma_f32_16x16x32_bf16 v[84:87], v[132:135], a[136:139], v[84:87]
    ds_read_b64_tr_b16 v[152:153], v223 offset:4096
    v_mfma_f32_16x16x32_bf16 v[92:95], v[132:135], a[140:143], v[92:95]
    buffer_load_dwordx4 v249, s[8:11], s22 offen offset:1024 lds
    v_mfma_f32_16x16x32_bf16 v[96:99], v[136:139], a[128:131], v[96:99]
    ds_read_b64_tr_b16 v[154:155], v223 offset:6144
    v_mfma_f32_16x16x32_bf16 v[104:107], v[136:139], a[132:135], v[104:107]
    ds_read_b64_tr_b16 v[156:157], v224 offset:4096
    v_mfma_f32_16x16x32_bf16 v[112:115], v[136:139], a[136:139], v[112:115]
    ds_read_b64_tr_b16 v[158:159], v224 offset:6144
    v_mfma_f32_16x16x32_bf16 v[120:123], v[136:139], a[140:143], v[120:123]
    buffer_load_dwordx4 v250, s[8:11], s22 offen offset:2048 lds
    v_mfma_f32_16x16x32_bf16 v[100:103], v[140:143], a[128:131], v[100:103]
    v_cvt_pk_bf16_f32 v57, v58, v59
    v_mfma_f32_16x16x32_bf16 v[108:111], v[140:143], a[132:135], v[108:111]
    v_cvt_pk_bf16_f32 v58, v60, v61
    v_mfma_f32_16x16x32_bf16 v[116:119], v[140:143], a[136:139], v[116:119]
    v_cvt_pk_bf16_f32 v59, v62, v63
    v_mfma_f32_16x16x32_bf16 v[124:127], v[140:143], a[140:143], v[124:127]
    s_waitcnt lgkmcnt(0)
    buffer_load_dwordx4 v251, s[8:11], s22 offen offset:3072 lds
    v_mfma_f32_16x16x32_bf16 v[64:67], v[144:147], a[144:147], v[64:67]
    s_waitcnt vmcnt(16)
    s_add_u32 m0, s23, 4096
    v_mfma_f32_16x16x32_bf16 v[72:75], v[144:147], a[148:151], v[72:75]
    s_add_u32 s22, s21, 491648
    ds_read_b64_tr_b16 v[128:129], v221 offset:8192
    v_mfma_f32_16x16x32_bf16 v[80:83], v[144:147], a[152:155], v[80:83]
    ds_read_b64_tr_b16 v[130:131], v221 offset:10240
    v_mfma_f32_16x16x32_bf16 v[88:91], v[144:147], a[156:159], v[88:91]
    buffer_load_dwordx4 v248, s[8:11], s22 offen offset:0 lds
    v_mfma_f32_16x16x32_bf16 v[68:71], v[148:151], a[144:147], v[68:71]
    ds_read_b64_tr_b16 v[132:133], v222 offset:8192
    v_mfma_f32_16x16x32_bf16 v[76:79], v[148:151], a[148:151], v[76:79]
    ds_read_b64_tr_b16 v[134:135], v222 offset:10240
    v_mfma_f32_16x16x32_bf16 v[84:87], v[148:151], a[152:155], v[84:87]
    ds_read_b64_tr_b16 v[136:137], v223 offset:8192
    v_mfma_f32_16x16x32_bf16 v[92:95], v[148:151], a[156:159], v[92:95]
    buffer_load_dwordx4 v249, s[8:11], s22 offen offset:1024 lds
    v_mfma_f32_16x16x32_bf16 v[96:99], v[152:155], a[144:147], v[96:99]
    ds_read_b64_tr_b16 v[138:139], v223 offset:10240
    v_mfma_f32_16x16x32_bf16 v[104:107], v[152:155], a[148:151], v[104:107]
    ds_read_b64_tr_b16 v[140:141], v224 offset:8192
    v_mfma_f32_16x16x32_bf16 v[112:115], v[152:155], a[152:155], v[112:115]
    ds_read_b64_tr_b16 v[142:143], v224 offset:10240
    v_mfma_f32_16x16x32_bf16 v[120:123], v[152:155], a[156:159], v[120:123]
    buffer_load_dwordx4 v250, s[8:11], s22 offen offset:2048 lds
    v_mfma_f32_16x16x32_bf16 v[100:103], v[156:159], a[144:147], v[100:103]
    v_mfma_f32_16x16x32_bf16 v[108:111], v[156:159], a[148:151], v[108:111]
    v_mfma_f32_16x16x32_bf16 v[116:119], v[156:159], a[152:155], v[116:119]
    v_mfma_f32_16x16x32_bf16 v[124:127], v[156:159], a[156:159], v[124:127]
    s_waitcnt lgkmcnt(0)
    buffer_load_dwordx4 v251, s[8:11], s22 offen offset:3072 lds
    v_mfma_f32_16x16x32_bf16 v[64:67], v[128:131], a[160:163], v[64:67]
    s_waitcnt vmcnt(16)
    ds_read_b64_tr_b16 v[144:145], v221 offset:12288
    ds_read_b64_tr_b16 v[146:147], v221 offset:14336
    v_mfma_f32_16x16x32_bf16 v[72:75], v[128:131], a[164:167], v[72:75]
    ds_read_b64_tr_b16 v[148:149], v222 offset:12288
    ds_read_b64_tr_b16 v[150:151], v222 offset:14336
    v_mfma_f32_16x16x32_bf16 v[80:83], v[128:131], a[168:171], v[80:83]
    s_mov_b32 m0, s52
    s_add_u32 s52, s52, 4096
    v_mfma_f32_16x16x32_bf16 v[88:91], v[128:131], a[172:175], v[88:91]
    buffer_load_dwordx4 v231, s[48:51], s53 offen lds
    s_add_u32 s53, s53, 57344
    v_mfma_f32_16x16x32_bf16 v[68:71], v[132:135], a[160:163], v[68:71]
    ds_read_b64_tr_b16 v[152:153], v223 offset:12288
    ds_read_b64_tr_b16 v[154:155], v223 offset:14336
    v_mfma_f32_16x16x32_bf16 v[76:79], v[132:135], a[164:167], v[76:79]
    buffer_store_dwordx4 v[0:3], v253, s[12:15], s44 offen offset:0 sc1
    v_mfma_f32_16x16x32_bf16 v[84:87], v[132:135], a[168:171], v[84:87]
    s_mov_b32 m0, s52
    s_add_u32 s52, s52, 4096
    v_mfma_f32_16x16x32_bf16 v[92:95], v[132:135], a[172:175], v[92:95]
    buffer_load_dwordx4 v231, s[48:51], s53 offen lds
    s_add_u32 s53, s53, 57344
    v_mfma_f32_16x16x32_bf16 v[96:99], v[136:139], a[160:163], v[96:99]
    ds_read_b64_tr_b16 v[156:157], v224 offset:12288
    ds_read_b64_tr_b16 v[158:159], v224 offset:14336
    v_mfma_f32_16x16x32_bf16 v[104:107], v[136:139], a[164:167], v[104:107]
    v_mfma_f32_16x16x32_bf16 v[112:115], v[136:139], a[168:171], v[112:115]
    s_mov_b32 m0, s52
    s_add_u32 s52, s52, 4096
    v_mfma_f32_16x16x32_bf16 v[120:123], v[136:139], a[172:175], v[120:123]
    buffer_load_dwordx4 v231, s[48:51], s53 offen lds
    s_add_u32 s53, s53, 57344
    v_mfma_f32_16x16x32_bf16 v[100:103], v[140:143], a[160:163], v[100:103]
    v_mfma_f32_16x16x32_bf16 v[108:111], v[140:143], a[164:167], v[108:111]
    buffer_store_dwordx4 v[8:11], v253, s[12:15], s45 offen offset:0 sc1
    v_mfma_f32_16x16x32_bf16 v[116:119], v[140:143], a[168:171], v[116:119]
    v_mfma_f32_16x16x32_bf16 v[124:127], v[140:143], a[172:175], v[124:127]
    s_waitcnt lgkmcnt(0)
    s_mov_b32 m0, s52
    s_add_u32 s52, s52, 4096
    buffer_load_dwordx4 v231, s[48:51], s53 offen lds
    s_add_u32 s53, s53, 57344
    v_mfma_f32_16x16x32_bf16 v[64:67], v[144:147], a[176:179], v[64:67]
    s_waitcnt vmcnt(18)
    ds_read_b64_tr_b16 v[128:129], v225 offset:0
    ds_read_b64_tr_b16 v[130:131], v225 offset:2048
    v_mfma_f32_16x16x32_bf16 v[72:75], v[144:147], a[180:183], v[72:75]
    ds_read_b64_tr_b16 v[132:133], v226 offset:0
    ds_read_b64_tr_b16 v[134:135], v226 offset:2048
    v_mfma_f32_16x16x32_bf16 v[80:83], v[144:147], a[184:187], v[80:83]
    s_mov_b32 m0, s52
    s_add_u32 s52, s52, 4096
    v_mfma_f32_16x16x32_bf16 v[88:91], v[144:147], a[188:191], v[88:91]
    buffer_load_dwordx4 v231, s[48:51], s53 offen lds
    s_add_u32 s53, s53, 57344
    v_mfma_f32_16x16x32_bf16 v[68:71], v[148:151], a[176:179], v[68:71]
    ds_read_b64_tr_b16 v[136:137], v227 offset:0
    ds_read_b64_tr_b16 v[138:139], v227 offset:2048
    v_mfma_f32_16x16x32_bf16 v[76:79], v[148:151], a[180:183], v[76:79]
    buffer_store_dwordx4 v[16:19], v253, s[12:15], s24 offen offset:0 sc1
    v_mfma_f32_16x16x32_bf16 v[84:87], v[148:151], a[184:187], v[84:87]
    s_mov_b32 m0, s52
    s_add_u32 s52, s52, 4096
    v_mfma_f32_16x16x32_bf16 v[92:95], v[148:151], a[188:191], v[92:95]
    buffer_load_dwordx4 v231, s[48:51], s53 offen lds
    s_add_u32 s53, s53, 57344
    v_mfma_f32_16x16x32_bf16 v[96:99], v[152:155], a[176:179], v[96:99]
    ds_read_b64_tr_b16 v[140:141], v228 offset:0
    ds_read_b64_tr_b16 v[142:143], v228 offset:2048
    v_mfma_f32_16x16x32_bf16 v[104:107], v[152:155], a[180:183], v[104:107]
    v_mfma_f32_16x16x32_bf16 v[112:115], v[152:155], a[184:187], v[112:115]
    s_mov_b32 m0, s52
    s_add_u32 s52, s52, 4096
    v_mfma_f32_16x16x32_bf16 v[120:123], v[152:155], a[188:191], v[120:123]
    buffer_load_dwordx4 v231, s[48:51], s53 offen lds
    s_add_u32 s53, s53, 57344
    v_mfma_f32_16x16x32_bf16 v[100:103], v[156:159], a[176:179], v[100:103]
    v_mfma_f32_16x16x32_bf16 v[108:111], v[156:159], a[180:183], v[108:111]
    buffer_store_dwordx4 v[24:27], v253, s[12:15], s25 offen offset:0 sc1
    v_mfma_f32_16x16x32_bf16 v[116:119], v[156:159], a[184:187], v[116:119]
    v_mfma_f32_16x16x32_bf16 v[124:127], v[156:159], a[188:191], v[124:127]
    s_waitcnt lgkmcnt(0)
    s_mov_b32 m0, s52
    s_add_u32 s52, s52, 4096
    buffer_load_dwordx4 v231, s[48:51], s53 offen lds
    s_add_u32 s53, s53, 57344
    v_mfma_f32_16x16x32_bf16 v[64:67], v[128:131], a[192:195], v[64:67]
    s_waitcnt vmcnt(20)
    ds_read_b64_tr_b16 v[144:145], v225 offset:4096
    ds_read_b64_tr_b16 v[146:147], v225 offset:6144
    v_mfma_f32_16x16x32_bf16 v[72:75], v[128:131], a[196:199], v[72:75]
    ds_read_b64_tr_b16 v[148:149], v226 offset:4096
    ds_read_b64_tr_b16 v[150:151], v226 offset:6144
    v_mfma_f32_16x16x32_bf16 v[80:83], v[128:131], a[200:203], v[80:83]
    s_mov_b32 m0, s52
    s_add_u32 s52, s52, 4096
    v_mfma_f32_16x16x32_bf16 v[88:91], v[128:131], a[204:207], v[88:91]
    buffer_load_dwordx4 v231, s[48:51], s53 offen lds
    s_add_u32 s53, s53, 57344
    v_mfma_f32_16x16x32_bf16 v[68:71], v[132:135], a[192:195], v[68:71]
    ds_read_b64_tr_b16 v[152:153], v227 offset:4096
    ds_read_b64_tr_b16 v[154:155], v227 offset:6144
    v_mfma_f32_16x16x32_bf16 v[76:79], v[132:135], a[196:199], v[76:79]
    buffer_store_dwordx4 v[32:35], v253, s[12:15], s44 offen offset:512 sc1
    v_mfma_f32_16x16x32_bf16 v[84:87], v[132:135], a[200:203], v[84:87]
    s_mov_b32 m0, s52
    s_add_u32 s52, s52, 4096
    v_mfma_f32_16x16x32_bf16 v[92:95], v[132:135], a[204:207], v[92:95]
    buffer_load_dwordx4 v231, s[48:51], s53 offen lds
    s_add_u32 s53, s53, 57344
    v_mfma_f32_16x16x32_bf16 v[96:99], v[136:139], a[192:195], v[96:99]
    ds_read_b64_tr_b16 v[156:157], v228 offset:4096
    ds_read_b64_tr_b16 v[158:159], v228 offset:6144
    v_mfma_f32_16x16x32_bf16 v[104:107], v[136:139], a[196:199], v[104:107]
    v_mfma_f32_16x16x32_bf16 v[112:115], v[136:139], a[200:203], v[112:115]
    s_mov_b32 m0, s52
    s_add_u32 s52, s52, 4096
    v_mfma_f32_16x16x32_bf16 v[120:123], v[136:139], a[204:207], v[120:123]
    buffer_load_dwordx4 v231, s[48:51], s53 offen lds
    s_add_u32 s53, s53, 57344
    v_mfma_f32_16x16x32_bf16 v[100:103], v[140:143], a[192:195], v[100:103]
    v_mfma_f32_16x16x32_bf16 v[108:111], v[140:143], a[196:199], v[108:111]
    buffer_store_dwordx4 v[40:43], v253, s[12:15], s45 offen offset:512 sc1
    v_mfma_f32_16x16x32_bf16 v[116:119], v[140:143], a[200:203], v[116:119]
    v_mfma_f32_16x16x32_bf16 v[124:127], v[140:143], a[204:207], v[124:127]
    s_waitcnt lgkmcnt(0)
    s_mov_b32 m0, s52
    s_add_u32 s52, s52, 4096
    buffer_load_dwordx4 v231, s[48:51], s53 offen lds
    s_add_u32 s53, s53, 57344
    v_mfma_f32_16x16x32_bf16 v[64:67], v[144:147], a[208:211], v[64:67]
    s_waitcnt vmcnt(22)
    ds_read_b64_tr_b16 v[128:129], v221 offset:0
    ds_read_b64_tr_b16 v[130:131], v221 offset:2048
    v_mfma_f32_16x16x32_bf16 v[72:75], v[144:147], a[212:215], v[72:75]
    ds_read_b64_tr_b16 v[132:133], v222 offset:0
    ds_read_b64_tr_b16 v[134:135], v222 offset:2048
    v_mfma_f32_16x16x32_bf16 v[80:83], v[144:147], a[216:219], v[80:83]
    s_mov_b32 m0, s52
    s_add_u32 s52, s52, 4096
    v_mfma_f32_16x16x32_bf16 v[88:91], v[144:147], a[220:223], v[88:91]
    buffer_load_dwordx4 v231, s[48:51], s53 offen lds
    s_add_u32 s53, s53, 57344
    v_mfma_f32_16x16x32_bf16 v[68:71], v[148:151], a[208:211], v[68:71]
    ds_read_b64_tr_b16 v[136:137], v223 offset:0
    ds_read_b64_tr_b16 v[138:139], v223 offset:2048
    v_mfma_f32_16x16x32_bf16 v[76:79], v[148:151], a[212:215], v[76:79]
    buffer_store_dwordx4 v[48:51], v253, s[12:15], s24 offen offset:512 sc1
    v_mfma_f32_16x16x32_bf16 v[84:87], v[148:151], a[216:219], v[84:87]
    s_mov_b32 m0, s52
    s_add_u32 s52, s52, 4096
    v_mfma_f32_16x16x32_bf16 v[92:95], v[148:151], a[220:223], v[92:95]
    buffer_load_dwordx4 v231, s[48:51], s53 offen lds
    s_add_u32 s53, s53, 57344
    v_mfma_f32_16x16x32_bf16 v[96:99], v[152:155], a[208:211], v[96:99]
    ds_read_b64_tr_b16 v[140:141], v224 offset:0
    ds_read_b64_tr_b16 v[142:143], v224 offset:2048
    v_mfma_f32_16x16x32_bf16 v[104:107], v[152:155], a[212:215], v[104:107]
    v_mfma_f32_16x16x32_bf16 v[112:115], v[152:155], a[216:219], v[112:115]
    s_mov_b32 m0, s52
    s_add_u32 s52, s52, 4096
    v_mfma_f32_16x16x32_bf16 v[120:123], v[152:155], a[220:223], v[120:123]
    buffer_load_dwordx4 v231, s[48:51], s53 offen lds
    s_add_u32 s53, s53, 57344
    v_mfma_f32_16x16x32_bf16 v[100:103], v[156:159], a[208:211], v[100:103]
    v_mfma_f32_16x16x32_bf16 v[108:111], v[156:159], a[212:215], v[108:111]
    buffer_store_dwordx4 v[56:59], v253, s[12:15], s25 offen offset:512 sc1
    v_mfma_f32_16x16x32_bf16 v[116:119], v[156:159], a[216:219], v[116:119]
    v_mfma_f32_16x16x32_bf16 v[124:127], v[156:159], a[220:223], v[124:127]
    s_waitcnt lgkmcnt(0)
    s_mov_b32 m0, s52
    s_add_u32 s52, s52, 4096
    buffer_load_dwordx4 v231, s[48:51], s53 offen lds
    s_add_u32 s53, s53, 57344
    v_mfma_f32_16x16x32_bf16 v[64:67], v[128:131], a[224:227], v[64:67]
    s_waitcnt vmcnt(24)
    ds_read_b64_tr_b16 v[144:145], v221 offset:4096
    v_mfma_f32_16x16x32_bf16 v[72:75], v[128:131], a[228:231], v[72:75]
    ds_read_b64_tr_b16 v[146:147], v221 offset:6144
    v_mfma_f32_16x16x32_bf16 v[80:83], v[128:131], a[232:235], v[80:83]
    ds_read_b64_tr_b16 v[148:149], v222 offset:4096
    v_mfma_f32_16x16x32_bf16 v[88:91], v[128:131], a[236:239], v[88:91]
    ds_read_b64_tr_b16 v[150:151], v222 offset:6144
    v_mfma_f32_16x16x32_bf16 v[68:71], v[132:135], a[224:227], v[68:71]
    ds_read_b64_tr_b16 v[152:153], v223 offset:4096
    v_mfma_f32_16x16x32_bf16 v[76:79], v[132:135], a[228:231], v[76:79]
    ds_read_b64_tr_b16 v[154:155], v223 offset:6144
    v_mfma_f32_16x16x32_bf16 v[84:87], v[132:135], a[232:235], v[84:87]
    ds_read_b64_tr_b16 v[156:157], v224 offset:4096
    v_mfma_f32_16x16x32_bf16 v[92:95], v[132:135], a[236:239], v[92:95]
    ds_read_b64_tr_b16 v[158:159], v224 offset:6144
    v_mfma_f32_16x16x32_bf16 v[96:99], v[136:139], a[224:227], v[96:99]
    v_mfma_f32_16x16x32_bf16 v[104:107], v[136:139], a[228:231], v[104:107]
    v_mfma_f32_16x16x32_bf16 v[112:115], v[136:139], a[232:235], v[112:115]
    v_mfma_f32_16x16x32_bf16 v[120:123], v[136:139], a[236:239], v[120:123]
    v_mfma_f32_16x16x32_bf16 v[100:103], v[140:143], a[224:227], v[100:103]
    v_mfma_f32_16x16x32_bf16 v[108:111], v[140:143], a[228:231], v[108:111]
    v_mfma_f32_16x16x32_bf16 v[116:119], v[140:143], a[232:235], v[116:119]
    v_mfma_f32_16x16x32_bf16 v[124:127], v[140:143], a[236:239], v[124:127]
    s_waitcnt lgkmcnt(0)
    v_mfma_f32_16x16x32_bf16 v[64:67], v[144:147], a[240:243], v[64:67]
    v_mfma_f32_16x16x32_bf16 v[72:75], v[144:147], a[244:247], v[72:75]
    v_mfma_f32_16x16x32_bf16 v[80:83], v[144:147], a[248:251], v[80:83]
    v_mfma_f32_16x16x32_bf16 v[88:91], v[144:147], a[252:255], v[88:91]
    v_mfma_f32_16x16x32_bf16 v[68:71], v[148:151], a[240:243], v[68:71]
    v_mfma_f32_16x16x32_bf16 v[76:79], v[148:151], a[244:247], v[76:79]
    v_mfma_f32_16x16x32_bf16 v[84:87], v[148:151], a[248:251], v[84:87]
    v_mfma_f32_16x16x32_bf16 v[92:95], v[148:151], a[252:255], v[92:95]
    v_mfma_f32_16x16x32_bf16 v[96:99], v[152:155], a[240:243], v[96:99]
    v_mfma_f32_16x16x32_bf16 v[104:107], v[152:155], a[244:247], v[104:107]
    v_mfma_f32_16x16x32_bf16 v[112:115], v[152:155], a[248:251], v[112:115]
    v_mfma_f32_16x16x32_bf16 v[120:123], v[152:155], a[252:255], v[120:123]
    v_mfma_f32_16x16x32_bf16 v[100:103], v[156:159], a[240:243], v[100:103]
    v_mfma_f32_16x16x32_bf16 v[108:111], v[156:159], a[244:247], v[108:111]
    v_mfma_f32_16x16x32_bf16 v[116:119], v[156:159], a[248:251], v[116:119]
    v_mfma_f32_16x16x32_bf16 v[124:127], v[156:159], a[252:255], v[124:127]
    s_nop 7
    s_nop 3
    v_cvt_pk_bf16_f32 v64, v64, v65
    v_cvt_pk_bf16_f32 v65, v66, v67
    v_cvt_pk_bf16_f32 v66, v68, v69
    v_cvt_pk_bf16_f32 v67, v70, v71
    buffer_store_dwordx4 v[64:67], v253, s[12:15], s44 offen offset:1024 sc1
    v_cvt_pk_bf16_f32 v72, v72, v73
    v_cvt_pk_bf16_f32 v73, v74, v75
    v_cvt_pk_bf16_f32 v74, v76, v77
    v_cvt_pk_bf16_f32 v75, v78, v79
    buffer_store_dwordx4 v[72:75], v253, s[12:15], s45 offen offset:1024 sc1
    v_cvt_pk_bf16_f32 v80, v80, v81
    v_cvt_pk_bf16_f32 v81, v82, v83
    v_cvt_pk_bf16_f32 v82, v84, v85
    v_cvt_pk_bf16_f32 v83, v86, v87
    buffer_store_dwordx4 v[80:83], v253, s[12:15], s24 offen offset:1024 sc1
    v_cvt_pk_bf16_f32 v88, v88, v89
    v_cvt_pk_bf16_f32 v89, v90, v91
    v_cvt_pk_bf16_f32 v90, v92, v93
    v_cvt_pk_bf16_f32 v91, v94, v95
    buffer_store_dwordx4 v[88:91], v253, s[12:15], s25 offen offset:1024 sc1
    v_cvt_pk_bf16_f32 v96, v96, v97
    v_cvt_pk_bf16_f32 v97, v98, v99
    v_cvt_pk_bf16_f32 v98, v100, v101
    v_cvt_pk_bf16_f32 v99, v102, v103
    buffer_store_dwordx4 v[96:99], v253, s[12:15], s44 offen offset:1536 sc1
    v_cvt_pk_bf16_f32 v104, v104, v105
    v_cvt_pk_bf16_f32 v105, v106, v107
    v_cvt_pk_bf16_f32 v106, v108, v109
    v_cvt_pk_bf16_f32 v107, v110, v111
    buffer_store_dwordx4 v[104:107], v253, s[12:15], s45 offen offset:1536 sc1
    v_cvt_pk_bf16_f32 v112, v112, v113
    v_cvt_pk_bf16_f32 v113, v114, v115
    v_cvt_pk_bf16_f32 v114, v116, v117
    v_cvt_pk_bf16_f32 v115, v118, v119
    buffer_store_dwordx4 v[112:115], v253, s[12:15], s24 offen offset:1536 sc1
    v_cvt_pk_bf16_f32 v120, v120, v121
    v_cvt_pk_bf16_f32 v121, v122, v123
    v_cvt_pk_bf16_f32 v122, v124, v125
    v_cvt_pk_bf16_f32 v123, v126, v127
    buffer_store_dwordx4 v[120:123], v253, s[12:15], s25 offen offset:1536 sc1
    s_lshl_b32 s46, s37, 10
    s_lshl_b32 s47, s3, 7
    s_add_u32 s46, s46, s47
    s_add_u32 s46, s46, 0x20000
    s_waitcnt vmcnt(0) lgkmcnt(0)
    s_barrier
    s_cmp_lg_u32 s20, 0
    s_cbranch_scc1 KB_PUB
    v_mov_b32 v245, 0
    v_mov_b32 v246, s4
    v_mov_b32 v247, s5
    s_mov_b64 exec, 1
    buffer_store_dwordx2 v[246:247], v245, s[12:15], s46 offen sc1
    s_mov_b64 exec, -1
KB_PUB:
    s_lshr_b32 s32, s40, 3
    s_lshl_b32 s32, s32, 10
    s_add_u32 s32, s32, 0x20000
    v_lshlrev_b32 v245, 3, v220
    v_min_u32 v245, 896, v245
    buffer_load_dwordx2 v[246:247], v245, s[12:15], s32 offen sc1
    v_add_f32 v200, 1.0, v200
    v_add_f32 v201, 1.0, v201
    v_add_f32 v202, 1.0, v202
    v_add_f32 v203, 1.0, v203
    v_add_f32 v204, 1.0, v204
    v_add_f32 v205, 1.0, v205
    v_add_f32 v206, 1.0, v206
    v_add_f32 v207, 1.0, v207
    v_add_f32 v208, 1.0, v208
    v_add_f32 v209, 1.0, v209
    v_add_f32 v210, 1.0, v210
    v_add_f32 v211, 1.0, v211
    v_add_f32 v212, 1.0, v212
    v_add_f32 v213, 1.0, v213
    v_add_f32 v214, 1.0, v214
    v_add_f32 v215, 1.0, v215
    v_cvt_pk_bf16_f32 v144, v200, v201
    v_cvt_pk_bf16_f32 v145, v202, v203
    v_cvt_pk_bf16_f32 v146, v204, v205
    v_cvt_pk_bf16_f32 v147, v206, v207
    v_cvt_pk_bf16_f32 v148, v208, v209
    v_cvt_pk_bf16_f32 v149, v210, v211
    v_cvt_pk_bf16_f32 v150, v212, v213
    v_cvt_pk_bf16_f32 v151, v214, v215
    v_lshlrev_b32 v200, 16, v144
    v_and_b32 v201, 0xffff0000, v144
    v_lshlrev_b32 v202, 16, v145
    v_and_b32 v203, 0xffff0000, v145
    v_lshlrev_b32 v204, 16, v146
    v_and_b32 v205, 0xffff0000, v146
    v_lshlrev_b32 v206, 16, v147
    v_and_b32 v207, 0xffff0000, v147
    v_lshlrev_b32 v208, 16, v148
    v_and_b32 v209, 0xffff0000, v148
    v_lshlrev_b32 v210, 16, v149
    v_and_b32 v211, 0xffff0000, v149
    v_lshlrev_b32 v212, 16, v150
    v_and_b32 v213, 0xffff0000, v150
    v_lshlrev_b32 v214, 16, v151
    v_and_b32 v215, 0xffff0000, v151
    v_lshlrev_b32 v64, 16, v160
    v_and_b32 v65, 0xffff0000, v160
    v_lshlrev_b32 v66, 16, v161
    v_and_b32 v67, 0xffff0000, v161
    v_lshlrev_b32 v68, 16, v162
    v_and_b32 v69, 0xffff0000, v162
    v_lshlrev_b32 v70, 16, v163
    v_and_b32 v71, 0xffff0000, v163
    v_lshlrev_b32 v72, 16, v164
    v_and_b32 v73, 0xffff0000, v164
    v_lshlrev_b32 v74, 16, v165
    v_and_b32 v75, 0xffff0000, v165
    v_lshlrev_b32 v76, 16, v166
    v_and_b32 v77, 0xffff0000, v166
    v_lshlrev_b32 v78, 16, v167
    v_and_b32 v79, 0xffff0000, v167
    s_add_u32 s43, s42, 0xff500000
    v_lshrrev_b32 v80, 9, v220
    v_lshlrev_b32 v80, 7, v80
    v_lshl_add_u32 v80, v232, 4, v80
    s_lshl_b32 s44, s20, 2
    s_add_u32 s44, s44, 131072
    v_add_u32 v80, s44, v80
    v_lshlrev_b32 v81, 4, v232
    v_add_u32 v81, 131072, v81
    v_lshrrev_b32 v82, 2, v233
    v_lshlrev_b32 v82, 12, v82
    v_and_b32 v83, 3, v233
    v_lshl_add_u32 v82, v83, 8, v82
    v_lshl_add_u32 v82, v232, 4, v82
    s_lshr_b32 s44, s40, 3
    s_lshl_b32 s44, s44, 16
    s_bfe_u32 s45, s40, 0x20001
    s_lshl_b32 s45, s45, 10
    s_add_u32 s44, s44, s45
    s_and_b32 s45, s40, 1
    s_lshl_b32 s45, s45, 7
    s_add_u32 s44, s44, s45
    s_lshl_b32 s45, s20, 14
    s_add_u32 s44, s44, s45
    s_add_u32 s44, s44, 0x700000
    s_add_u32 s45, s44, 8192
    s_lshl_b32 s46, s40, 7
    s_add_u32 s46, s46, 0x28000
    v_mov_b32 v84, 0
    v_mov_b32 v85, 0
    v_mov_b32 v86, 0
    v_mov_b32 v87, 0
    v_mov_b32 v88, 0
    v_mov_b32 v89, 0
    v_mov_b32 v90, 0
    v_mov_b32 v91, 0
    v_mov_b32 v92, 0
    v_mov_b32 v93, 0
    v_mov_b32 v94, 0
    v_mov_b32 v95, 0
    v_mov_b32 v96, 0
    v_mov_b32 v97, 0
    v_mov_b32 v98, 0
    v_mov_b32 v99, 0
    s_mov_b32 s34, 0
    s_mov_b32 s35, 0
    s_mov_b32 s47, 32768
    s_waitcnt vmcnt(0)
    v_cmp_ne_u64 vcc, s[4:5], v[246:247]
    s_cbranch_vccnz KC_DYN
    s_add_u32 s33, s42, 0
    buffer_load_dwordx4 v[0:3], v220, s[12:15], s33 offen offset:0 sc1
    buffer_load_dwordx4 v[4:7], v220, s[12:15], s33 offen offset:1024 sc1
    s_add_u32 s33, s42, 2097152
    buffer_load_dwordx4 v[8:11], v220, s[12:15], s33 offen offset:0 sc1
    buffer_load_dwordx4 v[12:15], v220, s[12:15], s33 offen offset:1024 sc1
    s_add_u32 s33, s42, 4194304
    buffer_load_dwordx4 v[16:19], v220, s[12:15], s33 offen offset:0 sc1
    buffer_load_dwordx4 v[20:23], v220, s[12:15], s33 offen offset:1024 sc1
    s_add_u32 s33, s42, 6291456
    buffer_load_dwordx4 v[24:27], v220, s[12:15], s33 offen offset:0 sc1
    buffer_load_dwordx4 v[28:31], v220, s[12:15], s33 offen offset:1024 sc1
    s_add_u32 s33, s42, 8388608
    buffer_load_dwordx4 v[32:35], v220, s[12:15], s33 offen offset:0 sc1
    buffer_load_dwordx4 v[36:39], v220, s[12:15], s33 offen offset:1024 sc1
    s_add_u32 s33, s42, 10485760
    buffer_load_dwordx4 v[40:43], v220, s[12:15], s33 offen offset:0 sc1
    buffer_load_dwordx4 v[44:47], v220, s[12:15], s33 offen offset:1024 sc1
    s_add_u32 s33, s42, 12582912
    buffer_load_dwordx4 v[48:51], v220, s[12:15], s33 offen offset:0 sc1
    buffer_load_dwordx4 v[52:55], v220, s[12:15], s33 offen offset:1024 sc1
    s_add_u32 s33, s42, 14680064
    buffer_load_dwordx4 v[56:59], v220, s[12:15], s33 offen offset:0 sc1
    buffer_load_dwordx4 v[60:63], v220, s[12:15], s33 offen offset:1024 sc1
    s_waitcnt vmcnt(14)
    v_lshlrev_b32 v144, 16, v0
    v_and_b32 v145, 0xffff0000, v0
    v_lshlrev_b32 v146, 16, v1
    v_and_b32 v147, 0xffff0000, v1
    v_lshlrev_b32 v148, 16, v2
    v_and_b32 v149, 0xffff0000, v2
    v_lshlrev_b32 v150, 16, v3
    v_and_b32 v151, 0xffff0000, v3
    v_lshlrev_b32 v152, 16, v4
    v_and_b32 v153, 0xffff0000, v4
    v_lshlrev_b32 v154, 16, v5
    v_and_b32 v155, 0xffff0000, v5
    v_lshlrev_b32 v156, 16, v6
    v_and_b32 v157, 0xffff0000, v6
    v_lshlrev_b32 v158, 16, v7
    v_and_b32 v159, 0xffff0000, v7
    v_pk_add_f32 v[84:85], v[84:85], v[144:145]
    v_pk_add_f32 v[86:87], v[86:87], v[146:147]
    v_pk_add_f32 v[88:89], v[88:89], v[148:149]
    v_pk_add_f32 v[90:91], v[90:91], v[150:151]
    v_pk_add_f32 v[92:93], v[92:93], v[152:153]
    v_pk_add_f32 v[94:95], v[94:95], v[154:155]
    v_pk_add_f32 v[96:97], v[96:97], v[156:157]
    v_pk_add_f32 v[98:99], v[98:99], v[158:159]
    s_waitcnt vmcnt(12)
    v_lshlrev_b32 v144, 16, v8
    v_and_b32 v145, 0xffff0000, v8
    v_lshlrev_b32 v146, 16, v9
    v_and_b32 v147, 0xffff0000, v9
    v_lshlrev_b32 v148, 16, v10
    v_and_b32 v149, 0xffff0000, v10
    v_lshlrev_b32 v150, 16, v11
    v_and_b32 v151, 0xffff0000, v11
    v_lshlrev_b32 v152, 16, v12
    v_and_b32 v153, 0xffff0000, v12
    v_lshlrev_b32 v154, 16, v13
    v_and_b32 v155, 0xffff0000, v13
    v_lshlrev_b32 v156, 16, v14
    v_and_b32 v157, 0xffff0000, v14
    v_lshlrev_b32 v158, 16, v15
    v_and_b32 v159, 0xffff0000, v15
    v_pk_add_f32 v[84:85], v[84:85], v[144:145]
    v_pk_add_f32 v[86:87], v[86:87], v[146:147]
    v_pk_add_f32 v[88:89], v[88:89], v[148:149]
    v_pk_add_f32 v[90:91], v[90:91], v[150:151]
    v_pk_add_f32 v[92:93], v[92:93], v[152:153]
    v_pk_add_f32 v[94:95], v[94:95], v[154:155]
    v_pk_add_f32 v[96:97], v[96:97], v[156:157]
    v_pk_add_f32 v[98:99], v[98:99], v[158:159]
    s_waitcnt vmcnt(10)
    v_lshlrev_b32 v144, 16, v16
    v_and_b32 v145, 0xffff0000, v16
    v_lshlrev_b32 v146, 16, v17
    v_and_b32 v147, 0xffff0000, v17
    v_lshlrev_b32 v148, 16, v18
    v_and_b32 v149, 0xffff0000, v18
    v_lshlrev_b32 v150, 16, v19
    v_and_b32 v151, 0xffff0000, v19
    v_lshlrev_b32 v152, 16, v20
    v_and_b32 v153, 0xffff0000, v20
    v_lshlrev_b32 v154, 16, v21
    v_and_b32 v155, 0xffff0000, v21
    v_lshlrev_b32 v156, 16, v22
    v_and_b32 v157, 0xffff0000, v22
    v_lshlrev_b32 v158, 16, v23
    v_and_b32 v159, 0xffff0000, v23
    v_pk_add_f32 v[84:85], v[84:85], v[144:145]
    v_pk_add_f32 v[86:87], v[86:87], v[146:147]
    v_pk_add_f32 v[88:89], v[88:89], v[148:149]
    v_pk_add_f32 v[90:91], v[90:91], v[150:151]
    v_pk_add_f32 v[92:93], v[92:93], v[152:153]
    v_pk_add_f32 v[94:95], v[94:95], v[154:155]
    v_pk_add_f32 v[96:97], v[96:97], v[156:157]
    v_pk_add_f32 v[98:99], v[98:99], v[158:159]
    s_waitcnt vmcnt(8)
    v_lshlrev_b32 v144, 16, v24
    v_and_b32 v145, 0xffff0000, v24
    v_lshlrev_b32 v146, 16, v25
    v_and_b32 v147, 0xffff0000, v25
    v_lshlrev_b32 v148, 16, v26
    v_and_b32 v149, 0xffff0000, v26
    v_lshlrev_b32 v150, 16, v27
    v_and_b32 v151, 0xffff0000, v27
    v_lshlrev_b32 v152, 16, v28
    v_and_b32 v153, 0xffff0000, v28
    v_lshlrev_b32 v154, 16, v29
    v_and_b32 v155, 0xffff0000, v29
    v_lshlrev_b32 v156, 16, v30
    v_and_b32 v157, 0xffff0000, v30
    v_lshlrev_b32 v158, 16, v31
    v_and_b32 v159, 0xffff0000, v31
    v_pk_add_f32 v[84:85], v[84:85], v[144:145]
    v_pk_add_f32 v[86:87], v[86:87], v[146:147]
    v_pk_add_f32 v[88:89], v[88:89], v[148:149]
    v_pk_add_f32 v[90:91], v[90:91], v[150:151]
    v_pk_add_f32 v[92:93], v[92:93], v[152:153]
    v_pk_add_f32 v[94:95], v[94:95], v[154:155]
    v_pk_add_f32 v[96:97], v[96:97], v[156:157]
    v_pk_add_f32 v[98:99], v[98:99], v[158:159]
    s_waitcnt vmcnt(6)
    v_lshlrev_b32 v144, 16, v32
    v_and_b32 v145, 0xffff0000, v32
    v_lshlrev_b32 v146, 16, v33
    v_and_b32 v147, 0xffff0000, v33
    v_lshlrev_b32 v148, 16, v34
    v_and_b32 v149, 0xffff0000, v34
    v_lshlrev_b32 v150, 16, v35
    v_and_b32 v151, 0xffff0000, v35
    v_lshlrev_b32 v152, 16, v36
    v_and_b32 v153, 0xffff0000, v36
    v_lshlrev_b32 v154, 16, v37
    v_and_b32 v155, 0xffff0000, v37
    v_lshlrev_b32 v156, 16, v38
    v_and_b32 v157, 0xffff0000, v38
    v_lshlrev_b32 v158, 16, v39
    v_and_b32 v159, 0xffff0000, v39
    v_pk_add_f32 v[84:85], v[84:85], v[144:145]
    v_pk_add_f32 v[86:87], v[86:87], v[146:147]
    v_pk_add_f32 v[88:89], v[88:89], v[148:149]
    v_pk_add_f32 v[90:91], v[90:91], v[150:151]
    v_pk_add_f32 v[92:93], v[92:93], v[152:153]
    v_pk_add_f32 v[94:95], v[94:95], v[154:155]
    v_pk_add_f32 v[96:97], v[96:97], v[156:157]
    v_pk_add_f32 v[98:99], v[98:99], v[158:159]
    s_waitcnt vmcnt(4)
    v_lshlrev_b32 v144, 16, v40
    v_and_b32 v145, 0xffff0000, v40
    v_lshlrev_b32 v146, 16, v41
    v_and_b32 v147, 0xffff0000, v41
    v_lshlrev_b32 v148, 16, v42
    v_and_b32 v149, 0xffff0000, v42
    v_lshlrev_b32 v150, 16, v43
    v_and_b32 v151, 0xffff0000, v43
    v_lshlrev_b32 v152, 16, v44
    v_and_b32 v153, 0xffff0000, v44
    v_lshlrev_b32 v154, 16, v45
    v_and_b32 v155, 0xffff0000, v45
    v_lshlrev_b32 v156, 16, v46
    v_and_b32 v157, 0xffff0000, v46
    v_lshlrev_b32 v158, 16, v47
    v_and_b32 v159, 0xffff0000, v47
    v_pk_add_f32 v[84:85], v[84:85], v[144:145]
    v_pk_add_f32 v[86:87], v[86:87], v[146:147]
    v_pk_add_f32 v[88:89], v[88:89], v[148:149]
    v_pk_add_f32 v[90:91], v[90:91], v[150:151]
    v_pk_add_f32 v[92:93], v[92:93], v[152:153]
    v_pk_add_f32 v[94:95], v[94:95], v[154:155]
    v_pk_add_f32 v[96:97], v[96:97], v[156:157]
    v_pk_add_f32 v[98:99], v[98:99], v[158:159]
    s_waitcnt vmcnt(2)
    v_lshlrev_b32 v144, 16, v48
    v_and_b32 v145, 0xffff0000, v48
    v_lshlrev_b32 v146, 16, v49
    v_and_b32 v147, 0xffff0000, v49
    v_lshlrev_b32 v148, 16, v50
    v_and_b32 v149, 0xffff0000, v50
    v_lshlrev_b32 v150, 16, v51
    v_and_b32 v151, 0xffff0000, v51
    v_lshlrev_b32 v152, 16, v52
    v_and_b32 v153, 0xffff0000, v52
    v_lshlrev_b32 v154, 16, v53
    v_and_b32 v155, 0xffff0000, v53
    v_lshlrev_b32 v156, 16, v54
    v_and_b32 v157, 0xffff0000, v54
    v_lshlrev_b32 v158, 16, v55
    v_and_b32 v159, 0xffff0000, v55
    v_pk_add_f32 v[84:85], v[84:85], v[144:145]
    v_pk_add_f32 v[86:87], v[86:87], v[146:147]
    v_pk_add_f32 v[88:89], v[88:89], v[148:149]
    v_pk_add_f32 v[90:91], v[90:91], v[150:151]
    v_pk_add_f32 v[92:93], v[92:93], v[152:153]
    v_pk_add_f32 v[94:95], v[94:95], v[154:155]
    v_pk_add_f32 v[96:97], v[96:97], v[156:157]
    v_pk_add_f32 v[98:99], v[98:99], v[158:159]
    s_waitcnt vmcnt(0)
    v_lshlrev_b32 v144, 16, v56
    v_and_b32 v145, 0xffff0000, v56
    v_lshlrev_b32 v146, 16, v57
    v_and_b32 v147, 0xffff0000, v57
    v_lshlrev_b32 v148, 16, v58
    v_and_b32 v149, 0xffff0000, v58
    v_lshlrev_b32 v150, 16, v59
    v_and_b32 v151, 0xffff0000, v59
    v_lshlrev_b32 v152, 16, v60
    v_and_b32 v153, 0xffff0000, v60
    v_lshlrev_b32 v154, 16, v61
    v_and_b32 v155, 0xffff0000, v61
    v_lshlrev_b32 v156, 16, v62
    v_and_b32 v157, 0xffff0000, v62
    v_lshlrev_b32 v158, 16, v63
    v_and_b32 v159, 0xffff0000, v63
    v_pk_add_f32 v[84:85], v[84:85], v[144:145]
    v_pk_add_f32 v[86:87], v[86:87], v[146:147]
    v_pk_add_f32 v[88:89], v[88:89], v[148:149]
    v_pk_add_f32 v[90:91], v[90:91], v[150:151]
    v_pk_add_f32 v[92:93], v[92:93], v[152:153]
    v_pk_add_f32 v[94:95], v[94:95], v[154:155]
    v_pk_add_f32 v[96:97], v[96:97], v[156:157]
    v_pk_add_f32 v[98:99], v[98:99], v[158:159]
    s_branch KC_SUM
KC_LOOP:
    s_cmp_eq_u32 s34, 0xff
    s_cbranch_scc1 KC_NOFL
    buffer_load_dwordx2 v[246:247], v245, s[12:15], s32 offen sc1
KC_NOFL:
    s_waitcnt vmcnt(0)
    v_cmp_ne_u64 vcc, s[4:5], v[246:247]
KC_DYN:
    s_sub_u32 s47, s47, 1
    s_cmp_eq_u32 s47, 0
    s_cselect_b32 s36, 0, vcc_lo
    s_or_b32 s36, s36, s34
    s_andn2_b32 s36, 0xff, s36
    s_or_b32 s34, s34, s36
    s_bitcmp1_b32 s36, 0
    s_cbranch_scc0 KC_L0
    s_add_u32 s33, s42, 0
    buffer_load_dwordx4 v[0:3], v220, s[12:15], s33 offen offset:0 sc1
    buffer_load_dwordx4 v[4:7], v220, s[12:15], s33 offen offset:1024 sc1
KC_L0:
    s_bitcmp1_b32 s36, 1
    s_cbranch_scc0 KC_L1
    s_add_u32 s33, s42, 2097152
    buffer_load_dwordx4 v[8:11], v220, s[12:15], s33 offen offset:0 sc1
    buffer_load_dwordx4 v[12:15], v220, s[12:15], s33 offen offset:1024 sc1
KC_L1:
    s_bitcmp1_b32 s36, 2
    s_cbranch_scc0 KC_L2
    s_add_u32 s33, s42, 4194304
    buffer_load_dwordx4 v[16:19], v220, s[12:15], s33 offen offset:0 sc1
    buffer_load_dwordx4 v[20:23], v220, s[12:15], s33 offen offset:1024 sc1
KC_L2:
    s_bitcmp1_b32 s36, 3
    s_cbranch_scc0 KC_L3
    s_add_u32 s33, s42, 6291456
    buffer_load_dwordx4 v[24:27], v220, s[12:15], s33 offen offset:0 sc1
    buffer_load_dwordx4 v[28:31], v220, s[12:15], s33 offen offset:1024 sc1
KC_L3:
    s_bitcmp1_b32 s36, 4
    s_cbranch_scc0 KC_L4
    s_add_u32 s33, s42, 8388608
    buffer_load_dwordx4 v[32:35], v220, s[12:15], s33 offen offset:0 sc1
    buffer_load_dwordx4 v[36:39], v220, s[12:15], s33 offen offset:1024 sc1
KC_L4:
    s_bitcmp1_b32 s36, 5
    s_cbranch_scc0 KC_L5
    s_add_u32 s33, s42, 10485760
    buffer_load_dwordx4 v[40:43], v220, s[12:15], s33 offen offset:0 sc1
    buffer_load_dwordx4 v[44:47], v220, s[12:15], s33 offen offset:1024 sc1
KC_L5:
    s_bitcmp1_b32 s36, 6
    s_cbranch_scc0 KC_L6
    s_add_u32 s33, s42, 12582912
    buffer_load_dwordx4 v[48:51], v220, s[12:15], s33 offen offset:0 sc1
    buffer_load_dwordx4 v[52:55], v220, s[12:15], s33 offen offset:1024 sc1
KC_L6:
    s_bitcmp1_b32 s36, 7
    s_cbranch_scc0 KC_L7
    s_add_u32 s33, s42, 14680064
    buffer_load_dwordx4 v[56:59], v220, s[12:15], s33 offen offset:0 sc1
    buffer_load_dwordx4 v[60:63], v220, s[12:15], s33 offen offset:1024 sc1
KC_L7:
    s_cmp_eq_u32 s35, 0
    s_cbranch_scc1 KC_A7
    s_bitcmp1_b32 s35, 0
    s_cbranch_scc0 KC_A0
    v_lshlrev_b32 v144, 16, v0
    v_and_b32 v145, 0xffff0000, v0
    v_lshlrev_b32 v146, 16, v1
    v_and_b32 v147, 0xffff0000, v1
    v_lshlrev_b32 v148, 16, v2
    v_and_b32 v149, 0xffff0000, v2
    v_lshlrev_b32 v150, 16, v3
    v_and_b32 v151, 0xffff0000, v3
    v_lshlrev_b32 v152, 16, v4
    v_and_b32 v153, 0xffff0000, v4
    v_lshlrev_b32 v154, 16, v5
    v_and_b32 v155, 0xffff0000, v5
    v_lshlrev_b32 v156, 16, v6
    v_and_b32 v157, 0xffff0000, v6
    v_lshlrev_b32 v158, 16, v7
    v_and_b32 v159, 0xffff0000, v7
    v_pk_add_f32 v[84:85], v[84:85], v[144:145]
    v_pk_add_f32 v[86:87], v[86:87], v[146:147]
    v_pk_add_f32 v[88:89], v[88:89], v[148:149]
    v_pk_add_f32 v[90:91], v[90:91], v[150:151]
    v_pk_add_f32 v[92:93], v[92:93], v[152:153]
    v_pk_add_f32 v[94:95], v[94:95], v[154:155]
    v_pk_add_f32 v[96:97], v[96:97], v[156:157]
    v_pk_add_f32 v[98:99], v[98:99], v[158:159]
KC_A0:
    s_bitcmp1_b32 s35, 1
    s_cbranch_scc0 KC_A1
    v_lshlrev_b32 v144, 16, v8
    v_and_b32 v145, 0xffff0000, v8
    v_lshlrev_b32 v146, 16, v9
    v_and_b32 v147, 0xffff0000, v9
    v_lshlrev_b32 v148, 16, v10
    v_and_b32 v149, 0xffff0000, v10
    v_lshlrev_b32 v150, 16, v11
    v_and_b32 v151, 0xffff0000, v11
    v_lshlrev_b32 v152, 16, v12
    v_and_b32 v153, 0xffff0000, v12
    v_lshlrev_b32 v154, 16, v13
    v_and_b32 v155, 0xffff0000, v13
    v_lshlrev_b32 v156, 16, v14
    v_and_b32 v157, 0xffff0000, v14
    v_lshlrev_b32 v158, 16, v15
    v_and_b32 v159, 0xffff0000, v15
    v_pk_add_f32 v[84:85], v[84:85], v[144:145]
    v_pk_add_f32 v[86:87], v[86:87], v[146:147]
    v_pk_add_f32 v[88:89], v[88:89], v[148:149]
    v_pk_add_f32 v[90:91], v[90:91], v[150:151]
    v_pk_add_f32 v[92:93], v[92:93], v[152:153]
    v_pk_add_f32 v[94:95], v[94:95], v[154:155]
    v_pk_add_f32 v[96:97], v[96:97], v[156:157]
    v_pk_add_f32 v[98:99], v[98:99], v[158:159]
KC_A1:
    s_bitcmp1_b32 s35, 2
    s_cbranch_scc0 KC_A2
    v_lshlrev_b32 v144, 16, v16
    v_and_b32 v145, 0xffff0000, v16
    v_lshlrev_b32 v146, 16, v17
    v_and_b32 v147, 0xffff0000, v17
    v_lshlrev_b32 v148, 16, v18
    v_and_b32 v149, 0xffff0000, v18
    v_lshlrev_b32 v150, 16, v19
    v_and_b32 v151, 0xffff0000, v19
    v_lshlrev_b32 v152, 16, v20
    v_and_b32 v153, 0xffff0000, v20
    v_lshlrev_b32 v154, 16, v21
    v_and_b32 v155, 0xffff0000, v21
    v_lshlrev_b32 v156, 16, v22
    v_and_b32 v157, 0xffff0000, v22
    v_lshlrev_b32 v158, 16, v23
    v_and_b32 v159, 0xffff0000, v23
    v_pk_add_f32 v[84:85], v[84:85], v[144:145]
    v_pk_add_f32 v[86:87], v[86:87], v[146:147]
    v_pk_add_f32 v[88:89], v[88:89], v[148:149]
    v_pk_add_f32 v[90:91], v[90:91], v[150:151]
    v_pk_add_f32 v[92:93], v[92:93], v[152:153]
    v_pk_add_f32 v[94:95], v[94:95], v[154:155]
    v_pk_add_f32 v[96:97], v[96:97], v[156:157]
    v_pk_add_f32 v[98:99], v[98:99], v[158:159]
KC_A2:
    s_bitcmp1_b32 s35, 3
    s_cbranch_scc0 KC_A3
    v_lshlrev_b32 v144, 16, v24
    v_and_b32 v145, 0xffff0000, v24
    v_lshlrev_b32 v146, 16, v25
    v_and_b32 v147, 0xffff0000, v25
    v_lshlrev_b32 v148, 16, v26
    v_and_b32 v149, 0xffff0000, v26
    v_lshlrev_b32 v150, 16, v27
    v_and_b32 v151, 0xffff0000, v27
    v_lshlrev_b32 v152, 16, v28
    v_and_b32 v153, 0xffff0000, v28
    v_lshlrev_b32 v154, 16, v29
    v_and_b32 v155, 0xffff0000, v29
    v_lshlrev_b32 v156, 16, v30
    v_and_b32 v157, 0xffff0000, v30
    v_lshlrev_b32 v158, 16, v31
    v_and_b32 v159, 0xffff0000, v31
    v_pk_add_f32 v[84:85], v[84:85], v[144:145]
    v_pk_add_f32 v[86:87], v[86:87], v[146:147]
    v_pk_add_f32 v[88:89], v[88:89], v[148:149]
    v_pk_add_f32 v[90:91], v[90:91], v[150:151]
    v_pk_add_f32 v[92:93], v[92:93], v[152:153]
    v_pk_add_f32 v[94:95], v[94:95], v[154:155]
    v_pk_add_f32 v[96:97], v[96:97], v[156:157]
    v_pk_add_f32 v[98:99], v[98:99], v[158:159]
KC_A3:
    s_bitcmp1_b32 s35, 4
    s_cbranch_scc0 KC_A4
    v_lshlrev_b32 v144, 16, v32
    v_and_b32 v145, 0xffff0000, v32
    v_lshlrev_b32 v146, 16, v33
    v_and_b32 v147, 0xffff0000, v33
    v_lshlrev_b32 v148, 16, v34
    v_and_b32 v149, 0xffff0000, v34
    v_lshlrev_b32 v150, 16, v35
    v_and_b32 v151, 0xffff0000, v35
    v_lshlrev_b32 v152, 16, v36
    v_and_b32 v153, 0xffff0000, v36
    v_lshlrev_b32 v154, 16, v37
    v_and_b32 v155, 0xffff0000, v37
    v_lshlrev_b32 v156, 16, v38
    v_and_b32 v157, 0xffff0000, v38
    v_lshlrev_b32 v158, 16, v39
    v_and_b32 v159, 0xffff0000, v39
    v_pk_add_f32 v[84:85], v[84:85], v[144:145]
    v_pk_add_f32 v[86:87], v[86:87], v[146:147]
    v_pk_add_f32 v[88:89], v[88:89], v[148:149]
    v_pk_add_f32 v[90:91], v[90:91], v[150:151]
    v_pk_add_f32 v[92:93], v[92:93], v[152:153]
    v_pk_add_f32 v[94:95], v[94:95], v[154:155]
    v_pk_add_f32 v[96:97], v[96:97], v[156:157]
    v_pk_add_f32 v[98:99], v[98:99], v[158:159]
KC_A4:
    s_bitcmp1_b32 s35, 5
    s_cbranch_scc0 KC_A5
    v_lshlrev_b32 v144, 16, v40
    v_and_b32 v145, 0xffff0000, v40
    v_lshlrev_b32 v146, 16, v41
    v_and_b32 v147, 0xffff0000, v41
    v_lshlrev_b32 v148, 16, v42
    v_and_b32 v149, 0xffff0000, v42
    v_lshlrev_b32 v150, 16, v43
    v_and_b32 v151, 0xffff0000, v43
    v_lshlrev_b32 v152, 16, v44
    v_and_b32 v153, 0xffff0000, v44
    v_lshlrev_b32 v154, 16, v45
    v_and_b32 v155, 0xffff0000, v45
    v_lshlrev_b32 v156, 16, v46
    v_and_b32 v157, 0xffff0000, v46
    v_lshlrev_b32 v158, 16, v47
    v_and_b32 v159, 0xffff0000, v47
    v_pk_add_f32 v[84:85], v[84:85], v[144:145]
    v_pk_add_f32 v[86:87], v[86:87], v[146:147]
    v_pk_add_f32 v[88:89], v[88:89], v[148:149]
    v_pk_add_f32 v[90:91], v[90:91], v[150:151]
    v_pk_add_f32 v[92:93], v[92:93], v[152:153]
    v_pk_add_f32 v[94:95], v[94:95], v[154:155]
    v_pk_add_f32 v[96:97], v[96:97], v[156:157]
    v_pk_add_f32 v[98:99], v[98:99], v[158:159]
KC_A5:
    s_bitcmp1_b32 s35, 6
    s_cbranch_scc0 KC_A6
    v_lshlrev_b32 v144, 16, v48
    v_and_b32 v145, 0xffff0000, v48
    v_lshlrev_b32 v146, 16, v49
    v_and_b32 v147, 0xffff0000, v49
    v_lshlrev_b32 v148, 16, v50
    v_and_b32 v149, 0xffff0000, v50
    v_lshlrev_b32 v150, 16, v51
    v_and_b32 v151, 0xffff0000, v51
    v_lshlrev_b32 v152, 16, v52
    v_and_b32 v153, 0xffff0000, v52
    v_lshlrev_b32 v154, 16, v53
    v_and_b32 v155, 0xffff0000, v53
    v_lshlrev_b32 v156, 16, v54
    v_and_b32 v157, 0xffff0000, v54
    v_lshlrev_b32 v158, 16, v55
    v_and_b32 v159, 0xffff0000, v55
    v_pk_add_f32 v[84:85], v[84:85], v[144:145]
    v_pk_add_f32 v[86:87], v[86:87], v[146:147]
    v_pk_add_f32 v[88:89], v[88:89], v[148:149]
    v_pk_add_f32 v[90:91], v[90:91], v[150:151]
    v_pk_add_f32 v[92:93], v[92:93], v[152:153]
    v_pk_add_f32 v[94:95], v[94:95], v[154:155]
    v_pk_add_f32 v[96:97], v[96:97], v[156:157]
    v_pk_add_f32 v[98:99], v[98:99], v[158:159]
KC_A6:
    s_bitcmp1_b32 s35, 7
    s_cbranch_scc0 KC_A7
    v_lshlrev_b32 v144, 16, v56
    v_and_b32 v145, 0xffff0000, v56
    v_lshlrev_b32 v146, 16, v57
    v_and_b32 v147, 0xffff0000, v57
    v_lshlrev_b32 v148, 16, v58
    v_and_b32 v149, 0xffff0000, v58
    v_lshlrev_b32 v150, 16, v59
    v_and_b32 v151, 0xffff0000, v59
    v_lshlrev_b32 v152, 16, v60
    v_and_b32 v153, 0xffff0000, v60
    v_lshlrev_b32 v154, 16, v61
    v_and_b32 v155, 0xffff0000, v61
    v_lshlrev_b32 v156, 16, v62
    v_and_b32 v157, 0xffff0000, v62
    v_lshlrev_b32 v158, 16, v63
    v_and_b32 v159, 0xffff0000, v63
    v_pk_add_f32 v[84:85], v[84:85], v[144:145]
    v_pk_add_f32 v[86:87], v[86:87], v[146:147]
    v_pk_add_f32 v[88:89], v[88:89], v[148:149]
    v_pk_add_f32 v[90:91], v[90:91], v[150:151]
    v_pk_add_f32 v[92:93], v[92:93], v[152:153]
    v_pk_add_f32 v[94:95], v[94:95], v[154:155]
    v_pk_add_f32 v[96:97], v[96:97], v[156:157]
    v_pk_add_f32 v[98:99], v[98:99], v[158:159]
KC_A7:
    s_mov_b32 s35, s36
    s_cmp_lg_u32 s36, 0
    s_cbranch_scc1 KC_LOOP
    s_cmp_eq_u32 s34, 0xff
    s_cbranch_scc1 KC_SUM
    s_branch KC_LOOP
KC_SUM:
    v_pk_fma_f32 v[64:65], v[84:85], v[168:169], v[64:65]
    v_pk_fma_f32 v[66:67], v[86:87], v[170:171], v[66:67]
    v_pk_fma_f32 v[68:69], v[88:89], v[172:173], v[68:69]
    v_pk_fma_f32 v[70:71], v[90:91], v[174:175], v[70:71]
    v_pk_fma_f32 v[72:73], v[92:93], v[176:177], v[72:73]
    v_pk_fma_f32 v[74:75], v[94:95], v[178:179], v[74:75]
    v_pk_fma_f32 v[76:77], v[96:97], v[180:181], v[76:77]
    v_pk_fma_f32 v[78:79], v[98:99], v[182:183], v[78:79]
    v_pk_add_f32 v[0:1], v[64:65], v[66:67]
    v_pk_mul_f32 v[2:3], v[64:65], v[64:65]
    v_pk_fma_f32 v[2:3], v[66:67], v[66:67], v[2:3]
    v_pk_add_f32 v[0:1], v[0:1], v[68:69]
    v_pk_fma_f32 v[2:3], v[68:69], v[68:69], v[2:3]
    v_pk_add_f32 v[0:1], v[0:1], v[70:71]
    v_pk_fma_f32 v[2:3], v[70:71], v[70:71], v[2:3]
    v_pk_add_f32 v[0:1], v[0:1], v[72:73]
    v_pk_fma_f32 v[2:3], v[72:73], v[72:73], v[2:3]
    v_pk_add_f32 v[0:1], v[0:1], v[74:75]
    v_pk_fma_f32 v[2:3], v[74:75], v[74:75], v[2:3]
    v_pk_add_f32 v[0:1], v[0:1], v[76:77]
    v_pk_fma_f32 v[2:3], v[76:77], v[76:77], v[2:3]
    v_pk_add_f32 v[0:1], v[0:1], v[78:79]
    v_pk_fma_f32 v[2:3], v[78:79], v[78:79], v[2:3]
    v_add_f32 v6, v0, v1
    v_add_f32 v7, v2, v3
    s_nop 1
    v_permlane32_swap_b32 v6, v7
    s_nop 0
    v_add_f32 v6, v6, v7
    v_mov_b32 v7, v6
    s_nop 1
    v_permlane16_swap_b32 v6, v7
    s_nop 0
    v_add_f32 v6, v6, v7
    s_nop 1
    v_add_f32_dpp v6, v6, v6 row_ror:8 row_mask:0xf bank_mask:0xf
    ds_write_b32 v80, v6
    v_cvt_pk_bf16_f32 v160, v64, v65
    v_cvt_pk_bf16_f32 v161, v66, v67
    v_cvt_pk_bf16_f32 v162, v68, v69
    v_cvt_pk_bf16_f32 v163, v70, v71
    v_cvt_pk_bf16_f32 v164, v72, v73
    v_cvt_pk_bf16_f32 v165, v74, v75
    v_cvt_pk_bf16_f32 v166, v76, v77
    v_cvt_pk_bf16_f32 v167, v78, v79
    s_waitcnt lgkmcnt(0)
    s_barrier
    ds_read_b128 v[16:19], v81
    ds_read_b128 v[20:23], v81 offset:128
    buffer_store_dwordx4 v[160:163], v220, s[12:15], s43 offen offset:0 sc1
    buffer_store_dwordx4 v[164:167], v220, s[12:15], s43 offen offset:1024 sc1
    s_waitcnt lgkmcnt(0)
    v_pk_add_f32 v[16:17], v[16:17], v[18:19]
    v_pk_add_f32 v[20:21], v[20:21], v[22:23]
    v_add_f32 v16, v16, v17
    v_add_f32 v20, v20, v21
    v_mul_f32 v16, 0x3b000000, v16
    v_mul_f32 v20, 0x3b000000, v20
    v_fma_f32 v20, -v16, v16, v20
    v_max_f32 v20, 0, v20
    v_add_f32 v20, 0x3727c5ac, v20
    v_rsq_f32 v20, v20
    s_nop 0
    v_mul_f32 v16, v16, v20
    v_sub_f32 v21, 0, v16
    v_pk_fma_f32 v[64:65], v[64:65], v[20:21], v[20:21] op_sel:[0,0,1] op_sel_hi:[1,0,1]
    v_pk_fma_f32 v[66:67], v[66:67], v[20:21], v[20:21] op_sel:[0,0,1] op_sel_hi:[1,0,1]
    v_pk_fma_f32 v[68:69], v[68:69], v[20:21], v[20:21] op_sel:[0,0,1] op_sel_hi:[1,0,1]
    v_pk_fma_f32 v[70:71], v[70:71], v[20:21], v[20:21] op_sel:[0,0,1] op_sel_hi:[1,0,1]
    v_pk_fma_f32 v[72:73], v[72:73], v[20:21], v[20:21] op_sel:[0,0,1] op_sel_hi:[1,0,1]
    v_pk_fma_f32 v[74:75], v[74:75], v[20:21], v[20:21] op_sel:[0,0,1] op_sel_hi:[1,0,1]
    v_pk_fma_f32 v[76:77], v[76:77], v[20:21], v[20:21] op_sel:[0,0,1] op_sel_hi:[1,0,1]
    v_pk_fma_f32 v[78:79], v[78:79], v[20:21], v[20:21] op_sel:[0,0,1] op_sel_hi:[1,0,1]
    v_pk_fma_f32 v[64:65], v[64:65], v[200:201], v[184:185]
    v_pk_fma_f32 v[66:67], v[66:67], v[202:203], v[186:187]
    v_pk_fma_f32 v[68:69], v[68:69], v[204:205], v[188:189]
    v_pk_fma_f32 v[70:71], v[70:71], v[206:207], v[190:191]
    v_pk_fma_f32 v[72:73], v[72:73], v[208:209], v[192:193]
    v_pk_fma_f32 v[74:75], v[74:75], v[210:211], v[194:195]
    v_pk_fma_f32 v[76:77], v[76:77], v[212:213], v[196:197]
    v_pk_fma_f32 v[78:79], v[78:79], v[214:215], v[198:199]
    v_cvt_pk_bf16_f32 v24, v64, v65
    v_cvt_pk_bf16_f32 v25, v66, v67
    v_cvt_pk_bf16_f32 v26, v68, v69
    v_cvt_pk_bf16_f32 v27, v70, v71
    buffer_store_dwordx4 v[24:27], v82, s[12:15], s44 offen sc1
    v_cvt_pk_bf16_f32 v28, v72, v73
    v_cvt_pk_bf16_f32 v29, v74, v75
    v_cvt_pk_bf16_f32 v30, v76, v77
    v_cvt_pk_bf16_f32 v31, v78, v79
    buffer_store_dwordx4 v[28:31], v82, s[12:15], s45 offen sc1
    s_waitcnt vmcnt(0) lgkmcnt(0)
    s_barrier
    s_cmp_lg_u32 s20, 0
    s_cbranch_scc1 KC_PUB
    v_mov_b32 v245, 0
    v_mov_b32 v246, s4
    v_mov_b32 v247, s5
    s_mov_b64 exec, 1
    buffer_store_dwordx2 v[246:247], v245, s[12:15], s46 offen sc1
    s_mov_b64 exec, -1
KC_PUB:
    s_add_u32 s30, s61, 131072
    v_add_u32 v208, s30, v252
    v_xor_b32 v209, 32, v208
    v_xor_b32 v210, 64, v208
    v_xor_b32 v211, 96, v208
    v_add_u32 v212, s62, v252
    v_xor_b32 v213, 32, v212
    v_xor_b32 v214, 64, v212
    v_xor_b32 v215, 96, v212
    s_cmp_ge_u32 s39, 28
    s_cbranch_scc1 KD_SKIP
    s_lshl_b32 s40, s54, 2
    s_add_u32 s40, s40, s20
    s_lshl_b32 s41, s40, 16
    s_add_u32 s41, s41, 0x700000
    s_lshl_b32 s42, s40, 10
    s_add_u32 s42, s42, 0x28000
    s_mul_i32 s44, s40, 229376
    s_lshl_b32 s45, s55, 13
    s_add_u32 s44, s44, s45
    s_add_u32 s44, s44, 0x900000
    s_add_u32 s45, s44, 4096
    v_mov_b32 v240, 0xbdd2d3e8
    v_mov_b32 v241, v240
    v_mov_b32 v242, 0xc0135761
    v_mov_b32 v243, v242
    v_add_u32 v221, 0, v252
    v_xor_b32 v222, 32, v221
    v_xor_b32 v223, 64, v221
    v_xor_b32 v224, 96, v221
    v_add_u32 v225, 65536, v252
    v_xor_b32 v226, 32, v225
    v_xor_b32 v227, 64, v225
    v_xor_b32 v228, 96, v225
    ds_read_b64_tr_b16 v[128:129], v221 offset:0
    ds_read_b64_tr_b16 v[130:131], v221 offset:4096
    ds_read_b64_tr_b16 v[132:133], v222 offset:0
    ds_read_b64_tr_b16 v[134:135], v222 offset:4096
    ds_read_b64_tr_b16 v[136:137], v221 offset:2048
    ds_read_b64_tr_b16 v[138:139], v221 offset:6144
    ds_read_b64_tr_b16 v[140:141], v222 offset:2048
    ds_read_b64_tr_b16 v[142:143], v222 offset:6144
    v_lshlrev_b32 v245, 3, v220
    v_min_u32 v245, 896, v245
    s_mov_b32 s47, 32768
KD_POLL:
    buffer_load_dwordx2 v[246:247], v245, s[12:15], s42 offen sc1
    s_sub_u32 s47, s47, 1
    s_waitcnt vmcnt(0)
    v_cmp_ne_u64 vcc, s[4:5], v[246:247]
    s_cbranch_vccz KD_GO
    s_cmp_eq_u32 s47, 0
    s_cbranch_scc1 KD_GO
    s_cmp_ge_u32 s52, 131072
    s_cbranch_scc1 KD_POLL
    s_mov_b32 m0, s52
    s_add_u32 s52, s52, 4096
    buffer_load_dwordx4 v231, s[48:51], s53 offen lds
    s_add_u32 s53, s53, 57344
    s_mov_b32 m0, s52
    s_add_u32 s52, s52, 4096
    buffer_load_dwordx4 v231, s[48:51], s53 offen lds
    s_add_u32 s53, s53, 57344
    s_mov_b32 m0, s52
    s_add_u32 s52, s52, 4096
    buffer_load_dwordx4 v231, s[48:51], s53 offen lds
    s_add_u32 s53, s53, 57344
    s_mov_b32 m0, s52
    s_add_u32 s52, s52, 4096
    buffer_load_dwordx4 v231, s[48:51], s53 offen lds
    s_add_u32 s53, s53, 57344
    s_mov_b32 m0, s52
    s_add_u32 s52, s52, 4096
    buffer_load_dwordx4 v231, s[48:51], s53 offen lds
    s_add_u32 s53, s53, 57344
    s_mov_b32 m0, s52
    s_add_u32 s52, s52, 4096
    buffer_load_dwordx4 v231, s[48:51], s53 offen lds
    s_add_u32 s53, s53, 57344
    s_mov_b32 m0, s52
    s_add_u32 s52, s52, 4096
    buffer_load_dwordx4 v231, s[48:51], s53 offen lds
    s_add_u32 s53, s53, 57344
    s_mov_b32 m0, s52
    s_add_u32 s52, s52, 4096
    buffer_load_dwordx4 v231, s[48:51], s53 offen lds
    s_add_u32 s53, s53, 57344
    s_branch KD_POLL
KD_GO:
KD_WL:
    s_cmp_ge_u32 s52, 131072
    s_cbranch_scc1 KD_WD
    s_mov_b32 m0, s52
    s_add_u32 s52, s52, 4096
    buffer_load_dwordx4 v231, s[48:51], s53 offen lds
    s_add_u32 s53, s53, 57344
    s_mov_b32 m0, s52
    s_add_u32 s52, s52, 4096
    buffer_load_dwordx4 v231, s[48:51], s53 offen lds
    s_add_u32 s53, s53, 57344
    s_mov_b32 m0, s52
    s_add_u32 s52, s52, 4096
    buffer_load_dwordx4 v231, s[48:51], s53 offen lds
    s_add_u32 s53, s53, 57344
    s_mov_b32 m0, s52
    s_add_u32 s52, s52, 4096
    buffer_load_dwordx4 v231, s[48:51], s53 offen lds
    s_add_u32 s53, s53, 57344
    s_mov_b32 m0, s52
    s_add_u32 s52, s52, 4096
    buffer_load_dwordx4 v231, s[48:51], s53 offen lds
    s_add_u32 s53, s53, 57344
    s_mov_b32 m0, s52
    s_add_u32 s52, s52, 4096
    buffer_load_dwordx4 v231, s[48:51], s53 offen lds
    s_add_u32 s53, s53, 57344
    s_mov_b32 m0, s52
    s_add_u32 s52, s52, 4096
    buffer_load_dwordx4 v231, s[48:51], s53 offen lds
    s_add_u32 s53, s53, 57344
    s_mov_b32 m0, s52
    s_add_u32 s52, s52, 4096
    buffer_load_dwordx4 v231, s[48:51], s53 offen lds
    s_add_u32 s53, s53, 57344
    s_branch KD_WL
KD_WD:
    buffer_load_dwordx4 a[0:3], v220, s[12:15], s41 offen offset:0 sc1
    buffer_load_dwordx4 a[4:7], v220, s[12:15], s41 offen offset:1024 sc1
    buffer_load_dwordx4 a[8:11], v220, s[12:15], s41 offen offset:2048 sc1
    buffer_load_dwordx4 a[12:15], v220, s[12:15], s41 offen offset:3072 sc1
    s_add_u32 s41, s41, 4096
    buffer_load_dwordx4 a[16:19], v220, s[12:15], s41 offen offset:0 sc1
    buffer_load_dwordx4 a[20:23], v220, s[12:15], s41 offen offset:1024 sc1
    buffer_load_dwordx4 a[24:27], v220, s[12:15], s41 offen offset:2048 sc1
    buffer_load_dwordx4 a[28:31], v220, s[12:15], s41 offen offset:3072 sc1
    s_add_u32 s41, s41, 4096
    buffer_load_dwordx4 a[32:35], v220, s[12:15], s41 offen offset:0 sc1
    buffer_load_dwordx4 a[36:39], v220, s[12:15], s41 offen offset:1024 sc1
    buffer_load_dwordx4 a[40:43], v220, s[12:15], s41 offen offset:2048 sc1
    buffer_load_dwordx4 a[44:47], v220, s[12:15], s41 offen offset:3072 sc1
    s_add_u32 s41, s41, 4096
    buffer_load_dwordx4 a[48:51], v220, s[12:15], s41 offen offset:0 sc1
    buffer_load_dwordx4 a[52:55], v220, s[12:15], s41 offen offset:1024 sc1
    buffer_load_dwordx4 a[56:59], v220, s[12:15], s41 offen offset:2048 sc1
    buffer_load_dwordx4 a[60:63], v220, s[12:15], s41 offen offset:3072 sc1
    s_add_u32 s41, s41, 4096
    s_waitcnt vmcnt(12) lgkmcnt(0)
    v_mfma_f32_16x16x32_bf16 v[0:3], v[128:131], a[0:3], 0
    ds_read_b64_tr_b16 v[144:145], v223 offset:0
    v_mfma_f32_16x16x32_bf16 v[8:11], v[128:131], a[4:7], 0
    ds_read_b64_tr_b16 v[146:147], v223 offset:4096
    v_mfma_f32_16x16x32_bf16 v[16:19], v[128:131], a[8:11], 0
    ds_read_b64_tr_b16 v[148:149], v224 offset:0
    v_mfma_f32_16x16x32_bf16 v[24:27], v[128:131], a[12:15], 0
    buffer_load_dwordx4 a[64:67], v220, s[12:15], s41 offen offset:0 sc1
    v_mfma_f32_16x16x32_bf16 v[4:7], v[132:135], a[0:3], 0
    ds_read_b64_tr_b16 v[150:151], v224 offset:4096
    v_mfma_f32_16x16x32_bf16 v[12:15], v[132:135], a[4:7], 0
    ds_read_b64_tr_b16 v[152:153], v223 offset:2048
    v_mfma_f32_16x16x32_bf16 v[20:23], v[132:135], a[8:11], 0
    ds_read_b64_tr_b16 v[154:155], v223 offset:6144
    v_mfma_f32_16x16x32_bf16 v[28:31], v[132:135], a[12:15], 0
    buffer_load_dwordx4 a[68:71], v220, s[12:15], s41 offen offset:1024 sc1
    v_mfma_f32_16x16x32_bf16 v[32:35], v[136:139], a[0:3], 0
    ds_read_b64_tr_b16 v[156:157], v224 offset:2048
    v_mfma_f32_16x16x32_bf16 v[40:43], v[136:139], a[4:7], 0
    ds_read_b64_tr_b16 v[158:159], v224 offset:6144
    v_mfma_f32_16x16x32_bf16 v[48:51], v[136:139], a[8:11], 0
    v_mfma_f32_16x16x32_bf16 v[56:59], v[136:139], a[12:15], 0
    buffer_load_dwordx4 a[72:75], v220, s[12:15], s41 offen offset:2048 sc1
    v_mfma_f32_16x16x32_bf16 v[36:39], v[140:143], a[0:3], 0
    v_mfma_f32_16x16x32_bf16 v[44:47], v[140:143], a[4:7], 0
    buffer_load_dwordx4 a[76:79], v220, s[12:15], s41 offen offset:3072 sc1
    s_add_u32 s41, s41, 4096
    v_mfma_f32_16x16x32_bf16 v[52:55], v[140:143], a[8:11], 0
    v_mfma_f32_16x16x32_bf16 v[60:63], v[140:143], a[12:15], 0
    s_waitcnt lgkmcnt(0)
    v_mfma_f32_16x16x32_bf16 v[64:67], v[144:147], a[0:3], 0
    ds_read_b64_tr_b16 v[128:129], v221 offset:8192
    v_mfma_f32_16x16x32_bf16 v[72:75], v[144:147], a[4:7], 0
    ds_read_b64_tr_b16 v[130:131], v221 offset:12288
    v_mfma_f32_16x16x32_bf16 v[80:83], v[144:147], a[8:11], 0
    ds_read_b64_tr_b16 v[132:133], v222 offset:8192
    v_mfma_f32_16x16x32_bf16 v[88:91], v[144:147], a[12:15], 0
    buffer_load_dwordx4 a[80:83], v220, s[12:15], s41 offen offset:0 sc1
    v_mfma_f32_16x16x32_bf16 v[68:71], v[148:151], a[0:3], 0
    ds_read_b64_tr_b16 v[134:135], v222 offset:12288
    v_mfma_f32_16x16x32_bf16 v[76:79], v[148:151], a[4:7], 0
    ds_read_b64_tr_b16 v[136:137], v221 offset:10240
    v_mfma_f32_16x16x32_bf16 v[84:87], v[148:151], a[8:11], 0
    ds_read_b64_tr_b16 v[138:139], v221 offset:14336
    v_mfma_f32_16x16x32_bf16 v[92:95], v[148:151], a[12:15], 0
    buffer_load_dwordx4 a[84:87], v220, s[12:15], s41 offen offset:1024 sc1
    v_mfma_f32_16x16x32_bf16 v[96:99], v[152:155], a[0:3], 0
    ds_read_b64_tr_b16 v[140:141], v222 offset:10240
    v_mfma_f32_16x16x32_bf16 v[104:107], v[152:155], a[4:7], 0
    ds_read_b64_tr_b16 v[142:143], v222 offset:14336
    v_mfma_f32_16x16x32_bf16 v[112:115], v[152:155], a[8:11], 0
    v_mfma_f32_16x16x32_bf16 v[120:123], v[152:155], a[12:15], 0
    buffer_load_dwordx4 a[88:91], v220, s[12:15], s41 offen offset:2048 sc1
    v_mfma_f32_16x16x32_bf16 v[100:103], v[156:159], a[0:3], 0
    v_mfma_f32_16x16x32_bf16 v[108:111], v[156:159], a[4:7], 0
    buffer_load_dwordx4 a[92:95], v220, s[12:15], s41 offen offset:3072 sc1
    s_add_u32 s41, s41, 4096
    v_mfma_f32_16x16x32_bf16 v[116:119], v[156:159], a[8:11], 0
    v_mfma_f32_16x16x32_bf16 v[124:127], v[156:159], a[12:15], 0
    s_waitcnt lgkmcnt(0)
    s_waitcnt vmcnt(16)
    v_mfma_f32_16x16x32_bf16 v[0:3], v[128:131], a[16:19], v[0:3]
    ds_read_b64_tr_b16 v[144:145], v223 offset:8192
    v_mfma_f32_16x16x32_bf16 v[8:11], v[128:131], a[20:23], v[8:11]
    ds_read_b64_tr_b16 v[146:147], v223 offset:12288
    v_mfma_f32_16x16x32_bf16 v[16:19], v[128:131], a[24:27], v[16:19]
    ds_read_b64_tr_b16 v[148:149], v224 offset:8192
    v_mfma_f32_16x16x32_bf16 v[24:27], v[128:131], a[28:31], v[24:27]
    buffer_load_dwordx4 a[96:99], v220, s[12:15], s41 offen offset:0 sc1
    v_mfma_f32_16x16x32_bf16 v[4:7], v[132:135], a[16:19], v[4:7]
    ds_read_b64_tr_b16 v[150:151], v224 offset:12288
    v_mfma_f32_16x16x32_bf16 v[12:15], v[132:135], a[20:23], v[12:15]
    ds_read_b64_tr_b16 v[152:153], v223 offset:10240
    v_mfma_f32_16x16x32_bf16 v[20:23], v[132:135], a[24:27], v[20:23]
    ds_read_b64_tr_b16 v[154:155], v223 offset:14336
    v_mfma_f32_16x16x32_bf16 v[28:31], v[132:135], a[28:31], v[28:31]
    buffer_load_dwordx4 a[100:103], v220, s[12:15], s41 offen offset:1024 sc1
    v_mfma_f32_16x16x32_bf16 v[32:35], v[136:139], a[16:19], v[32:35]
    ds_read_b64_tr_b16 v[156:157], v224 offset:10240
    v_mfma_f32_16x16x32_bf16 v[40:43], v[136:139], a[20:23], v[40:43]
    ds_read_b64_tr_b16 v[158:159], v224 offset:14336
    v_mfma_f32_16x16x32_bf16 v[48:51], v[136:139], a[24:27], v[48:51]
    v_mfma_f32_16x16x32_bf16 v[56:59], v[136:139], a[28:31], v[56:59]
    buffer_load_dwordx4 a[104:107], v220, s[12:15], s41 offen offset:2048 sc1
    v_mfma_f32_16x16x32_bf16 v[36:39], v[140:143], a[16:19], v[36:39]
    v_mfma_f32_16x16x32_bf16 v[44:47], v[140:143], a[20:23], v[44:47]
    buffer_load_dwordx4 a[108:111], v220, s[12:15], s41 offen offset:3072 sc1
    s_add_u32 s41, s41, 4096
    v_mfma_f32_16x16x32_bf16 v[52:55], v[140:143], a[24:27], v[52:55]
    v_mfma_f32_16x16x32_bf16 v[60:63], v[140:143], a[28:31], v[60:63]
    s_waitcnt lgkmcnt(0)
    v_mfma_f32_16x16x32_bf16 v[64:67], v[144:147], a[16:19], v[64:67]
    ds_read_b64_tr_b16 v[128:129], v221 offset:16384
    v_mfma_f32_16x16x32_bf16 v[72:75], v[144:147], a[20:23], v[72:75]
    ds_read_b64_tr_b16 v[130:131], v221 offset:20480
    v_mfma_f32_16x16x32_bf16 v[80:83], v[144:147], a[24:27], v[80:83]
    ds_read_b64_tr_b16 v[132:133], v222 offset:16384
    v_mfma_f32_16x16x32_bf16 v[88:91], v[144:147], a[28:31], v[88:91]
    buffer_load_dwordx4 a[112:115], v220, s[12:15], s41 offen offset:0 sc1
    v_mfma_f32_16x16x32_bf16 v[68:71], v[148:151], a[16:19], v[68:71]
    ds_read_b64_tr_b16 v[134:135], v222 offset:20480
    v_mfma_f32_16x16x32_bf16 v[76:79], v[148:151], a[20:23], v[76:79]
    ds_read_b64_tr_b16 v[136:137], v221 offset:18432
    v_mfma_f32_16x16x32_bf16 v[84:87], v[148:151], a[24:27], v[84:87]
    ds_read_b64_tr_b16 v[138:139], v221 offset:22528
    v_mfma_f32_16x16x32_bf16 v[92:95], v[148:151], a[28:31], v[92:95]
    buffer_load_dwordx4 a[116:119], v220, s[12:15], s41 offen offset:1024 sc1
    v_mfma_f32_16x16x32_bf16 v[96:99], v[152:155], a[16:19], v[96:99]
    ds_read_b64_tr_b16 v[140:141], v222 offset:18432
    v_mfma_f32_16x16x32_bf16 v[104:107], v[152:155], a[20:23], v[104:107]
    ds_read_b64_tr_b16 v[142:143], v222 offset:22528
    v_mfma_f32_16x16x32_bf16 v[112:115], v[152:155], a[24:27], v[112:115]
    v_mfma_f32_16x16x32_bf16 v[120:123], v[152:155], a[28:31], v[120:123]
    buffer_load_dwordx4 a[120:123], v220, s[12:15], s41 offen offset:2048 sc1
    v_mfma_f32_16x16x32_bf16 v[100:103], v[156:159], a[16:19], v[100:103]
    v_mfma_f32_16x16x32_bf16 v[108:111], v[156:159], a[20:23], v[108:111]
    buffer_load_dwordx4 a[124:127], v220, s[12:15], s41 offen offset:3072 sc1
    s_add_u32 s41, s41, 4096
    v_mfma_f32_16x16x32_bf16 v[116:119], v[156:159], a[24:27], v[116:119]
    v_mfma_f32_16x16x32_bf16 v[124:127], v[156:159], a[28:31], v[124:127]
    s_waitcnt lgkmcnt(0)
    s_waitcnt vmcnt(20)
    v_mfma_f32_16x16x32_bf16 v[0:3], v[128:131], a[32:35], v[0:3]
    ds_read_b64_tr_b16 v[144:145], v223 offset:16384
    v_mfma_f32_16x16x32_bf16 v[8:11], v[128:131], a[36:39], v[8:11]
    ds_read_b64_tr_b16 v[146:147], v223 offset:20480
    v_mfma_f32_16x16x32_bf16 v[16:19], v[128:131], a[40:43], v[16:19]
    ds_read_b64_tr_b16 v[148:149], v224 offset:16384
    v_mfma_f32_16x16x32_bf16 v[24:27], v[128:131], a[44:47], v[24:27]
    buffer_load_dwordx4 a[128:131], v220, s[12:15], s41 offen offset:0 sc1
    v_mfma_f32_16x16x32_bf16 v[4:7], v[132:135], a[32:35], v[4:7]
    ds_read_b64_tr_b16 v[150:151], v224 offset:20480
    v_mfma_f32_16x16x32_bf16 v[12:15], v[132:135], a[36:39], v[12:15]
    ds_read_b64_tr_b16 v[152:153], v223 offset:18432
    v_mfma_f32_16x16x32_bf16 v[20:23], v[132:135], a[40:43], v[20:23]
    ds_read_b64_tr_b16 v[154:155], v223 offset:22528
    v_mfma_f32_16x16x32_bf16 v[28:31], v[132:135], a[44:47], v[28:31]
    buffer_load_dwordx4 a[132:135], v220, s[12:15], s41 offen offset:1024 sc1
    v_mfma_f32_16x16x32_bf16 v[32:35], v[136:139], a[32:35], v[32:35]
    ds_read_b64_tr_b16 v[156:157], v224 offset:18432
    v_mfma_f32_16x16x32_bf16 v[40:43], v[136:139], a[36:39], v[40:43]
    ds_read_b64_tr_b16 v[158:159], v224 offset:22528
    v_mfma_f32_16x16x32_bf16 v[48:51], v[136:139], a[40:43], v[48:51]
    v_mfma_f32_16x16x32_bf16 v[56:59], v[136:139], a[44:47], v[56:59]
    buffer_load_dwordx4 a[136:139], v220, s[12:15], s41 offen offset:2048 sc1
    v_mfma_f32_16x16x32_bf16 v[36:39], v[140:143], a[32:35], v[36:39]
    v_mfma_f32_16x16x32_bf16 v[44:47], v[140:143], a[36:39], v[44:47]
    buffer_load_dwordx4 a[140:143], v220, s[12:15], s41 offen offset:3072 sc1
    s_add_u32 s41, s41, 4096
    v_mfma_f32_16x16x32_bf16 v[52:55], v[140:143], a[40:43], v[52:55]
    v_mfma_f32_16x16x32_bf16 v[60:63], v[140:143], a[44:47], v[60:63]
    s_waitcnt lgkmcnt(0)
    v_mfma_f32_16x16x32_bf16 v[64:67], v[144:147], a[32:35], v[64:67]
    ds_read_b64_tr_b16 v[128:129], v221 offset:24576
    v_mfma_f32_16x16x32_bf16 v[72:75], v[144:147], a[36:39], v[72:75]
    ds_read_b64_tr_b16 v[130:131], v221 offset:28672
    v_mfma_f32_16x16x32_bf16 v[80:83], v[144:147], a[40:43], v[80:83]
    ds_read_b64_tr_b16 v[132:133], v222 offset:24576
    v_mfma_f32_16x16x32_bf16 v[88:91], v[144:147], a[44:47], v[88:91]
    buffer_load_dwordx4 a[144:147], v220, s[12:15], s41 offen offset:0 sc1
    v_mfma_f32_16x16x32_bf16 v[68:71], v[148:151], a[32:35], v[68:71]
    ds_read_b64_tr_b16 v[134:135], v222 offset:28672
    v_mfma_f32_16x16x32_bf16 v[76:79], v[148:151], a[36:39], v[76:79]
    ds_read_b64_tr_b16 v[136:137], v221 offset:26624
    v_mfma_f32_16x16x32_bf16 v[84:87], v[148:151], a[40:43], v[84:87]
    ds_read_b64_tr_b16 v[138:139], v221 offset:30720
    v_mfma_f32_16x16x32_bf16 v[92:95], v[148:151], a[44:47], v[92:95]
    buffer_load_dwordx4 a[148:151], v220, s[12:15], s41 offen offset:1024 sc1
    v_mfma_f32_16x16x32_bf16 v[96:99], v[152:155], a[32:35], v[96:99]
    ds_read_b64_tr_b16 v[140:141], v222 offset:26624
    v_mfma_f32_16x16x32_bf16 v[104:107], v[152:155], a[36:39], v[104:107]
    ds_read_b64_tr_b16 v[142:143], v222 offset:30720
    v_mfma_f32_16x16x32_bf16 v[112:115], v[152:155], a[40:43], v[112:115]
    v_mfma_f32_16x16x32_bf16 v[120:123], v[152:155], a[44:47], v[120:123]
    buffer_load_dwordx4 a[152:155], v220, s[12:15], s41 offen offset:2048 sc1
    v_mfma_f32_16x16x32_bf16 v[100:103], v[156:159], a[32:35], v[100:103]
    v_mfma_f32_16x16x32_bf16 v[108:111], v[156:159], a[36:39], v[108:111]
    buffer_load_dwordx4 a[156:159], v220, s[12:15], s41 offen offset:3072 sc1
    s_add_u32 s41, s41, 4096
    v_mfma_f32_16x16x32_bf16 v[116:119], v[156:159], a[40:43], v[116:119]
    v_mfma_f32_16x16x32_bf16 v[124:127], v[156:159], a[44:47], v[124:127]
    s_waitcnt lgkmcnt(0)
    s_waitcnt vmcnt(24)
    v_mfma_f32_16x16x32_bf16 v[0:3], v[128:131], a[48:51], v[0:3]
    ds_read_b64_tr_b16 v[144:145], v223 offset:24576
    v_mfma_f32_16x16x32_bf16 v[8:11], v[128:131], a[52:55], v[8:11]
    ds_read_b64_tr_b16 v[146:147], v223 offset:28672
    v_mfma_f32_16x16x32_bf16 v[16:19], v[128:131], a[56:59], v[16:19]
    ds_read_b64_tr_b16 v[148:149], v224 offset:24576
    v_mfma_f32_16x16x32_bf16 v[24:27], v[128:131], a[60:63], v[24:27]
    buffer_load_dwordx4 a[160:163], v220, s[12:15], s41 offen offset:0 sc1
    v_mfma_f32_16x16x32_bf16 v[4:7], v[132:135], a[48:51], v[4:7]
    ds_read_b64_tr_b16 v[150:151], v224 offset:28672
    v_mfma_f32_16x16x32_bf16 v[12:15], v[132:135], a[52:55], v[12:15]
    ds_read_b64_tr_b16 v[152:153], v223 offset:26624
    v_mfma_f32_16x16x32_bf16 v[20:23], v[132:135], a[56:59], v[20:23]
    ds_read_b64_tr_b16 v[154:155], v223 offset:30720
    v_mfma_f32_16x16x32_bf16 v[28:31], v[132:135], a[60:63], v[28:31]
    buffer_load_dwordx4 a[164:167], v220, s[12:15], s41 offen offset:1024 sc1
    v_mfma_f32_16x16x32_bf16 v[32:35], v[136:139], a[48:51], v[32:35]
    ds_read_b64_tr_b16 v[156:157], v224 offset:26624
    v_mfma_f32_16x16x32_bf16 v[40:43], v[136:139], a[52:55], v[40:43]
    ds_read_b64_tr_b16 v[158:159], v224 offset:30720
    v_mfma_f32_16x16x32_bf16 v[48:51], v[136:139], a[56:59], v[48:51]
    v_mfma_f32_16x16x32_bf16 v[56:59], v[136:139], a[60:63], v[56:59]
    buffer_load_dwordx4 a[168:171], v220, s[12:15], s41 offen offset:2048 sc1
    v_mfma_f32_16x16x32_bf16 v[36:39], v[140:143], a[48:51], v[36:39]
    v_mfma_f32_16x16x32_bf16 v[44:47], v[140:143], a[52:55], v[44:47]
    buffer_load_dwordx4 a[172:175], v220, s[12:15], s41 offen offset:3072 sc1
    s_add_u32 s41, s41, 4096
    v_mfma_f32_16x16x32_bf16 v[52:55], v[140:143], a[56:59], v[52:55]
    v_mfma_f32_16x16x32_bf16 v[60:63], v[140:143], a[60:63], v[60:63]
    s_waitcnt lgkmcnt(0)
    v_mfma_f32_16x16x32_bf16 v[64:67], v[144:147], a[48:51], v[64:67]
    ds_read_b64_tr_b16 v[128:129], v221 offset:32768
    v_mfma_f32_16x16x32_bf16 v[72:75], v[144:147], a[52:55], v[72:75]
    ds_read_b64_tr_b16 v[130:131], v221 offset:36864
    v_mfma_f32_16x16x32_bf16 v[80:83], v[144:147], a[56:59], v[80:83]
    ds_read_b64_tr_b16 v[132:133], v222 offset:32768
    v_mfma_f32_16x16x32_bf16 v[88:91], v[144:147], a[60:63], v[88:91]
    buffer_load_dwordx4 a[176:179], v220, s[12:15], s41 offen offset:0 sc1
    v_mfma_f32_16x16x32_bf16 v[68:71], v[148:151], a[48:51], v[68:71]
    ds_read_b64_tr_b16 v[134:135], v222 offset:36864
    v_mfma_f32_16x16x32_bf16 v[76:79], v[148:151], a[52:55], v[76:79]
    ds_read_b64_tr_b16 v[136:137], v221 offset:34816
    v_mfma_f32_16x16x32_bf16 v[84:87], v[148:151], a[56:59], v[84:87]
    ds_read_b64_tr_b16 v[138:139], v221 offset:38912
    v_mfma_f32_16x16x32_bf16 v[92:95], v[148:151], a[60:63], v[92:95]
    buffer_load_dwordx4 a[180:183], v220, s[12:15], s41 offen offset:1024 sc1
    v_mfma_f32_16x16x32_bf16 v[96:99], v[152:155], a[48:51], v[96:99]
    ds_read_b64_tr_b16 v[140:141], v222 offset:34816
    v_mfma_f32_16x16x32_bf16 v[104:107], v[152:155], a[52:55], v[104:107]
    ds_read_b64_tr_b16 v[142:143], v222 offset:38912
    v_mfma_f32_16x16x32_bf16 v[112:115], v[152:155], a[56:59], v[112:115]
    v_mfma_f32_16x16x32_bf16 v[120:123], v[152:155], a[60:63], v[120:123]
    buffer_load_dwordx4 a[184:187], v220, s[12:15], s41 offen offset:2048 sc1
    v_mfma_f32_16x16x32_bf16 v[100:103], v[156:159], a[48:51], v[100:103]
    v_mfma_f32_16x16x32_bf16 v[108:111], v[156:159], a[52:55], v[108:111]
    buffer_load_dwordx4 a[188:191], v220, s[12:15], s41 offen offset:3072 sc1
    s_add_u32 s41, s41, 4096
    v_mfma_f32_16x16x32_bf16 v[116:119], v[156:159], a[56:59], v[116:119]
    v_mfma_f32_16x16x32_bf16 v[124:127], v[156:159], a[60:63], v[124:127]
    s_waitcnt lgkmcnt(0)
    s_waitcnt vmcnt(28)
    v_mfma_f32_16x16x32_bf16 v[0:3], v[128:131], a[64:67], v[0:3]
    ds_read_b64_tr_b16 v[144:145], v223 offset:32768
    v_mfma_f32_16x16x32_bf16 v[8:11], v[128:131], a[68:71], v[8:11]
    ds_read_b64_tr_b16 v[146:147], v223 offset:36864
    v_mfma_f32_16x16x32_bf16 v[16:19], v[128:131], a[72:75], v[16:19]
    ds_read_b64_tr_b16 v[148:149], v224 offset:32768
    v_mfma_f32_16x16x32_bf16 v[24:27], v[128:131], a[76:79], v[24:27]
    buffer_load_dwordx4 a[192:195], v220, s[12:15], s41 offen offset:0 sc1
    v_mfma_f32_16x16x32_bf16 v[4:7], v[132:135], a[64:67], v[4:7]
    ds_read_b64_tr_b16 v[150:151], v224 offset:36864
    v_mfma_f32_16x16x32_bf16 v[12:15], v[132:135], a[68:71], v[12:15]
    ds_read_b64_tr_b16 v[152:153], v223 offset:34816
    v_mfma_f32_16x16x32_bf16 v[20:23], v[132:135], a[72:75], v[20:23]
    ds_read_b64_tr_b16 v[154:155], v223 offset:38912
    v_mfma_f32_16x16x32_bf16 v[28:31], v[132:135], a[76:79], v[28:31]
    buffer_load_dwordx4 a[196:199], v220, s[12:15], s41 offen offset:1024 sc1
    v_mfma_f32_16x16x32_bf16 v[32:35], v[136:139], a[64:67], v[32:35]
    ds_read_b64_tr_b16 v[156:157], v224 offset:34816
    v_mfma_f32_16x16x32_bf16 v[40:43], v[136:139], a[68:71], v[40:43]
    ds_read_b64_tr_b16 v[158:159], v224 offset:38912
    v_mfma_f32_16x16x32_bf16 v[48:51], v[136:139], a[72:75], v[48:51]
    v_mfma_f32_16x16x32_bf16 v[56:59], v[136:139], a[76:79], v[56:59]
    buffer_load_dwordx4 a[200:203], v220, s[12:15], s41 offen offset:2048 sc1
    v_mfma_f32_16x16x32_bf16 v[36:39], v[140:143], a[64:67], v[36:39]
    v_mfma_f32_16x16x32_bf16 v[44:47], v[140:143], a[68:71], v[44:47]
    buffer_load_dwordx4 a[204:207], v220, s[12:15], s41 offen offset:3072 sc1
    s_add_u32 s41, s41, 4096
    v_mfma_f32_16x16x32_bf16 v[52:55], v[140:143], a[72:75], v[52:55]
    v_mfma_f32_16x16x32_bf16 v[60:63], v[140:143], a[76:79], v[60:63]
    s_waitcnt lgkmcnt(0)
    v_mfma_f32_16x16x32_bf16 v[64:67], v[144:147], a[64:67], v[64:67]
    ds_read_b64_tr_b16 v[128:129], v221 offset:40960
    v_mfma_f32_16x16x32_bf16 v[72:75], v[144:147], a[68:71], v[72:75]
    ds_read_b64_tr_b16 v[130:131], v221 offset:45056
    v_mfma_f32_16x16x32_bf16 v[80:83], v[144:147], a[72:75], v[80:83]
    ds_read_b64_tr_b16 v[132:133], v222 offset:40960
    v_mfma_f32_16x16x32_bf16 v[88:91], v[144:147], a[76:79], v[88:91]
    buffer_load_dwordx4 a[208:211], v220, s[12:15], s41 offen offset:0 sc1
    v_mfma_f32_16x16x32_bf16 v[68:71], v[148:151], a[64:67], v[68:71]
    ds_read_b64_tr_b16 v[134:135], v222 offset:45056
    v_mfma_f32_16x16x32_bf16 v[76:79], v[148:151], a[68:71], v[76:79]
    ds_read_b64_tr_b16 v[136:137], v221 offset:43008
    v_mfma_f32_16x16x32_bf16 v[84:87], v[148:151], a[72:75], v[84:87]
    ds_read_b64_tr_b16 v[138:139], v221 offset:47104
    v_mfma_f32_16x16x32_bf16 v[92:95], v[148:151], a[76:79], v[92:95]
    buffer_load_dwordx4 a[212:215], v220, s[12:15], s41 offen offset:1024 sc1
    v_mfma_f32_16x16x32_bf16 v[96:99], v[152:155], a[64:67], v[96:99]
    ds_read_b64_tr_b16 v[140:141], v222 offset:43008
    v_mfma_f32_16x16x32_bf16 v[104:107], v[152:155], a[68:71], v[104:107]
    ds_read_b64_tr_b16 v[142:143], v222 offset:47104
    v_mfma_f32_16x16x32_bf16 v[112:115], v[152:155], a[72:75], v[112:115]
    v_mfma_f32_16x16x32_bf16 v[120:123], v[152:155], a[76:79], v[120:123]
    buffer_load_dwordx4 a[216:219], v220, s[12:15], s41 offen offset:2048 sc1
    v_mfma_f32_16x16x32_bf16 v[100:103], v[156:159], a[64:67], v[100:103]
    v_mfma_f32_16x16x32_bf16 v[108:111], v[156:159], a[68:71], v[108:111]
    buffer_load_dwordx4 a[220:223], v220, s[12:15], s41 offen offset:3072 sc1
    s_add_u32 s41, s41, 4096
    v_mfma_f32_16x16x32_bf16 v[116:119], v[156:159], a[72:75], v[116:119]
    v_mfma_f32_16x16x32_bf16 v[124:127], v[156:159], a[76:79], v[124:127]
    s_waitcnt lgkmcnt(0)
    s_waitcnt vmcnt(32)
    v_mfma_f32_16x16x32_bf16 v[0:3], v[128:131], a[80:83], v[0:3]
    ds_read_b64_tr_b16 v[144:145], v223 offset:40960
    v_mfma_f32_16x16x32_bf16 v[8:11], v[128:131], a[84:87], v[8:11]
    ds_read_b64_tr_b16 v[146:147], v223 offset:45056
    v_mfma_f32_16x16x32_bf16 v[16:19], v[128:131], a[88:91], v[16:19]
    ds_read_b64_tr_b16 v[148:149], v224 offset:40960
    v_mfma_f32_16x16x32_bf16 v[24:27], v[128:131], a[92:95], v[24:27]
    buffer_load_dwordx4 a[224:227], v220, s[12:15], s41 offen offset:0 sc1
    v_mfma_f32_16x16x32_bf16 v[4:7], v[132:135], a[80:83], v[4:7]
    ds_read_b64_tr_b16 v[150:151], v224 offset:45056
    v_mfma_f32_16x16x32_bf16 v[12:15], v[132:135], a[84:87], v[12:15]
    ds_read_b64_tr_b16 v[152:153], v223 offset:43008
    v_mfma_f32_16x16x32_bf16 v[20:23], v[132:135], a[88:91], v[20:23]
    ds_read_b64_tr_b16 v[154:155], v223 offset:47104
    v_mfma_f32_16x16x32_bf16 v[28:31], v[132:135], a[92:95], v[28:31]
    buffer_load_dwordx4 a[228:231], v220, s[12:15], s41 offen offset:1024 sc1
    v_mfma_f32_16x16x32_bf16 v[32:35], v[136:139], a[80:83], v[32:35]
    ds_read_b64_tr_b16 v[156:157], v224 offset:43008
    v_mfma_f32_16x16x32_bf16 v[40:43], v[136:139], a[84:87], v[40:43]
    ds_read_b64_tr_b16 v[158:159], v224 offset:47104
    v_mfma_f32_16x16x32_bf16 v[48:51], v[136:139], a[88:91], v[48:51]
    v_mfma_f32_16x16x32_bf16 v[56:59], v[136:139], a[92:95], v[56:59]
    buffer_load_dwordx4 a[232:235], v220, s[12:15], s41 offen offset:2048 sc1
    v_mfma_f32_16x16x32_bf16 v[36:39], v[140:143], a[80:83], v[36:39]
    v_mfma_f32_16x16x32_bf16 v[44:47], v[140:143], a[84:87], v[44:47]
    buffer_load_dwordx4 a[236:239], v220, s[12:15], s41 offen offset:3072 sc1
    s_add_u32 s41, s41, 4096
    v_mfma_f32_16x16x32_bf16 v[52:55], v[140:143], a[88:91], v[52:55]
    v_mfma_f32_16x16x32_bf16 v[60:63], v[140:143], a[92:95], v[60:63]
    s_waitcnt lgkmcnt(0)
    v_mfma_f32_16x16x32_bf16 v[64:67], v[144:147], a[80:83], v[64:67]
    ds_read_b64_tr_b16 v[128:129], v221 offset:49152
    v_mfma_f32_16x16x32_bf16 v[72:75], v[144:147], a[84:87], v[72:75]
    ds_read_b64_tr_b16 v[130:131], v221 offset:53248
    v_mfma_f32_16x16x32_bf16 v[80:83], v[144:147], a[88:91], v[80:83]
    ds_read_b64_tr_b16 v[132:133], v222 offset:49152
    v_mfma_f32_16x16x32_bf16 v[88:91], v[144:147], a[92:95], v[88:91]
    buffer_load_dwordx4 a[240:243], v220, s[12:15], s41 offen offset:0 sc1
    v_mfma_f32_16x16x32_bf16 v[68:71], v[148:151], a[80:83], v[68:71]
    ds_read_b64_tr_b16 v[134:135], v222 offset:53248
    v_mfma_f32_16x16x32_bf16 v[76:79], v[148:151], a[84:87], v[76:79]
    ds_read_b64_tr_b16 v[136:137], v221 offset:51200
    v_mfma_f32_16x16x32_bf16 v[84:87], v[148:151], a[88:91], v[84:87]
    ds_read_b64_tr_b16 v[138:139], v221 offset:55296
    v_mfma_f32_16x16x32_bf16 v[92:95], v[148:151], a[92:95], v[92:95]
    buffer_load_dwordx4 a[244:247], v220, s[12:15], s41 offen offset:1024 sc1
    v_mfma_f32_16x16x32_bf16 v[96:99], v[152:155], a[80:83], v[96:99]
    ds_read_b64_tr_b16 v[140:141], v222 offset:51200
    v_mfma_f32_16x16x32_bf16 v[104:107], v[152:155], a[84:87], v[104:107]
    ds_read_b64_tr_b16 v[142:143], v222 offset:55296
    v_mfma_f32_16x16x32_bf16 v[112:115], v[152:155], a[88:91], v[112:115]
    v_mfma_f32_16x16x32_bf16 v[120:123], v[152:155], a[92:95], v[120:123]
    buffer_load_dwordx4 a[248:251], v220, s[12:15], s41 offen offset:2048 sc1
    v_mfma_f32_16x16x32_bf16 v[100:103], v[156:159], a[80:83], v[100:103]
    v_mfma_f32_16x16x32_bf16 v[108:111], v[156:159], a[84:87], v[108:111]
    buffer_load_dwordx4 a[252:255], v220, s[12:15], s41 offen offset:3072 sc1
    s_add_u32 s41, s41, 4096
    v_mfma_f32_16x16x32_bf16 v[116:119], v[156:159], a[88:91], v[116:119]
    v_mfma_f32_16x16x32_bf16 v[124:127], v[156:159], a[92:95], v[124:127]
    s_waitcnt lgkmcnt(0)
    s_waitcnt vmcnt(36)
    v_mfma_f32_16x16x32_bf16 v[0:3], v[128:131], a[96:99], v[0:3]
    s_add_u32 m0, s61, 131072
    ds_read_b64_tr_b16 v[144:145], v223 offset:49152
    v_mfma_f32_16x16x32_bf16 v[8:11], v[128:131], a[100:103], v[8:11]
    ds_read_b64_tr_b16 v[146:147], v223 offset:53248
    v_mfma_f32_16x16x32_bf16 v[16:19], v[128:131], a[104:107], v[16:19]
    ds_read_b64_tr_b16 v[148:149], v224 offset:49152
    v_mfma_f32_16x16x32_bf16 v[24:27], v[128:131], a[108:111], v[24:27]
    buffer_load_dwordx4 v248, s[56:59], s60 offen offset:0 lds
    v_mfma_f32_16x16x32_bf16 v[4:7], v[132:135], a[96:99], v[4:7]
    ds_read_b64_tr_b16 v[150:151], v224 offset:53248
    v_mfma_f32_16x16x32_bf16 v[12:15], v[132:135], a[100:103], v[12:15]
    ds_read_b64_tr_b16 v[152:153], v223 offset:51200
    v_mfma_f32_16x16x32_bf16 v[20:23], v[132:135], a[104:107], v[20:23]
    ds_read_b64_tr_b16 v[154:155], v223 offset:55296
    v_mfma_f32_16x16x32_bf16 v[28:31], v[132:135], a[108:111], v[28:31]
    buffer_load_dwordx4 v249, s[56:59], s60 offen offset:1024 lds
    v_mfma_f32_16x16x32_bf16 v[32:35], v[136:139], a[96:99], v[32:35]
    ds_read_b64_tr_b16 v[156:157], v224 offset:51200
    v_mfma_f32_16x16x32_bf16 v[40:43], v[136:139], a[100:103], v[40:43]
    ds_read_b64_tr_b16 v[158:159], v224 offset:55296
    v_mfma_f32_16x16x32_bf16 v[48:51], v[136:139], a[104:107], v[48:51]
    v_mfma_f32_16x16x32_bf16 v[56:59], v[136:139], a[108:111], v[56:59]
    buffer_load_dwordx4 v250, s[56:59], s60 offen offset:2048 lds
    v_mfma_f32_16x16x32_bf16 v[36:39], v[140:143], a[96:99], v[36:39]
    v_mfma_f32_16x16x32_bf16 v[44:47], v[140:143], a[100:103], v[44:47]
    buffer_load_dwordx4 v251, s[56:59], s60 offen offset:3072 lds
    s_add_u32 s60, s60, 32768
    v_mfma_f32_16x16x32_bf16 v[52:55], v[140:143], a[104:107], v[52:55]
    v_mfma_f32_16x16x32_bf16 v[60:63], v[140:143], a[108:111], v[60:63]
    s_waitcnt lgkmcnt(0)
    v_mfma_f32_16x16x32_bf16 v[64:67], v[144:147], a[96:99], v[64:67]
    s_add_u32 m0, s61, 135168
    ds_read_b64_tr_b16 v[128:129], v221 offset:57344
    v_mfma_f32_16x16x32_bf16 v[72:75], v[144:147], a[100:103], v[72:75]
    ds_read_b64_tr_b16 v[130:131], v221 offset:61440
    v_mfma_f32_16x16x32_bf16 v[80:83], v[144:147], a[104:107], v[80:83]
    ds_read_b64_tr_b16 v[132:133], v222 offset:57344
    v_mfma_f32_16x16x32_bf16 v[88:91], v[144:147], a[108:111], v[88:91]
    buffer_load_dwordx4 v248, s[56:59], s60 offen offset:0 lds
    v_mfma_f32_16x16x32_bf16 v[68:71], v[148:151], a[96:99], v[68:71]
    ds_read_b64_tr_b16 v[134:135], v222 offset:61440
    v_mfma_f32_16x16x32_bf16 v[76:79], v[148:151], a[100:103], v[76:79]
    ds_read_b64_tr_b16 v[136:137], v221 offset:59392
    v_mfma_f32_16x16x32_bf16 v[84:87], v[148:151], a[104:107], v[84:87]
    ds_read_b64_tr_b16 v[138:139], v221 offset:63488
    v_mfma_f32_16x16x32_bf16 v[92:95], v[148:151], a[108:111], v[92:95]
    buffer_load_dwordx4 v249, s[56:59], s60 offen offset:1024 lds
    v_mfma_f32_16x16x32_bf16 v[96:99], v[152:155], a[96:99], v[96:99]
    ds_read_b64_tr_b16 v[140:141], v222 offset:59392
    v_mfma_f32_16x16x32_bf16 v[104:107], v[152:155], a[100:103], v[104:107]
    ds_read_b64_tr_b16 v[142:143], v222 offset:63488
    v_mfma_f32_16x16x32_bf16 v[112:115], v[152:155], a[104:107], v[112:115]
    v_mfma_f32_16x16x32_bf16 v[120:123], v[152:155], a[108:111], v[120:123]
    buffer_load_dwordx4 v250, s[56:59], s60 offen offset:2048 lds
    v_mfma_f32_16x16x32_bf16 v[100:103], v[156:159], a[96:99], v[100:103]
    v_mfma_f32_16x16x32_bf16 v[108:111], v[156:159], a[100:103], v[108:111]
    buffer_load_dwordx4 v251, s[56:59], s60 offen offset:3072 lds
    s_add_u32 s60, s60, 32768
    v_mfma_f32_16x16x32_bf16 v[116:119], v[156:159], a[104:107], v[116:119]
    v_mfma_f32_16x16x32_bf16 v[124:127], v[156:159], a[108:111], v[124:127]
    s_waitcnt lgkmcnt(0)
    s_waitcnt vmcnt(40)
    v_mfma_f32_16x16x32_bf16 v[0:3], v[128:131], a[112:115], v[0:3]
    ds_read_b64_tr_b16 v[144:145], v223 offset:57344
    v_mfma_f32_16x16x32_bf16 v[8:11], v[128:131], a[116:119], v[8:11]
    ds_read_b64_tr_b16 v[146:147], v223 offset:61440
    v_mfma_f32_16x16x32_bf16 v[16:19], v[128:131], a[120:123], v[16:19]
    ds_read_b64_tr_b16 v[148:149], v224 offset:57344
    v_mfma_f32_16x16x32_bf16 v[24:27], v[128:131], a[124:127], v[24:27]
    ds_read_b64_tr_b16 v[150:151], v224 offset:61440
    v_mfma_f32_16x16x32_bf16 v[4:7], v[132:135], a[112:115], v[4:7]
    ds_read_b64_tr_b16 v[152:153], v223 offset:59392
    v_mfma_f32_16x16x32_bf16 v[12:15], v[132:135], a[116:119], v[12:15]
    ds_read_b64_tr_b16 v[154:155], v223 offset:63488
    v_mfma_f32_16x16x32_bf16 v[20:23], v[132:135], a[120:123], v[20:23]
    ds_read_b64_tr_b16 v[156:157], v224 offset:59392
    v_mfma_f32_16x16x32_bf16 v[28:31], v[132:135], a[124:127], v[28:31]
    ds_read_b64_tr_b16 v[158:159], v224 offset:63488
    v_mfma_f32_16x16x32_bf16 v[32:35], v[136:139], a[112:115], v[32:35]
    v_mfma_f32_16x16x32_bf16 v[40:43], v[136:139], a[116:119], v[40:43]
    v_mfma_f32_16x16x32_bf16 v[48:51], v[136:139], a[120:123], v[48:51]
    v_mfma_f32_16x16x32_bf16 v[56:59], v[136:139], a[124:127], v[56:59]
    v_mfma_f32_16x16x32_bf16 v[36:39], v[140:143], a[112:115], v[36:39]
    v_mfma_f32_16x16x32_bf16 v[44:47], v[140:143], a[116:119], v[44:47]
    v_mfma_f32_16x16x32_bf16 v[52:55], v[140:143], a[120:123], v[52:55]
    v_mfma_f32_16x16x32_bf16 v[60:63], v[140:143], a[124:127], v[60:63]
    s_waitcnt lgkmcnt(0)
    v_mfma_f32_16x16x32_bf16 v[64:67], v[144:147], a[112:115], v[64:67]
    s_barrier
    s_add_u32 m0, s62, 0
    v_mfma_f32_16x16x32_bf16 v[72:75], v[144:147], a[116:119], v[72:75]
    ds_read_b64_tr_b16 v[128:129], v225 offset:0
    v_mfma_f32_16x16x32_bf16 v[80:83], v[144:147], a[120:123], v[80:83]
    ds_read_b64_tr_b16 v[130:131], v225 offset:4096
    v_mfma_f32_16x16x32_bf16 v[88:91], v[144:147], a[124:127], v[88:91]
    buffer_load_dwordx4 v248, s[56:59], s60 offen offset:0 lds
    v_mfma_f32_16x16x32_bf16 v[68:71], v[148:151], a[112:115], v[68:71]
    ds_read_b64_tr_b16 v[132:133], v226 offset:0
    v_mfma_f32_16x16x32_bf16 v[76:79], v[148:151], a[116:119], v[76:79]
    ds_read_b64_tr_b16 v[134:135], v226 offset:4096
    v_mfma_f32_16x16x32_bf16 v[84:87], v[148:151], a[120:123], v[84:87]
    ds_read_b64_tr_b16 v[136:137], v225 offset:2048
    v_mfma_f32_16x16x32_bf16 v[92:95], v[148:151], a[124:127], v[92:95]
    buffer_load_dwordx4 v249, s[56:59], s60 offen offset:1024 lds
    v_mfma_f32_16x16x32_bf16 v[96:99], v[152:155], a[112:115], v[96:99]
    ds_read_b64_tr_b16 v[138:139], v225 offset:6144
    v_mfma_f32_16x16x32_bf16 v[104:107], v[152:155], a[116:119], v[104:107]
    ds_read_b64_tr_b16 v[140:141], v226 offset:2048
    v_mfma_f32_16x16x32_bf16 v[112:115], v[152:155], a[120:123], v[112:115]
    ds_read_b64_tr_b16 v[142:143], v226 offset:6144
    v_mfma_f32_16x16x32_bf16 v[120:123], v[152:155], a[124:127], v[120:123]
    buffer_load_dwordx4 v250, s[56:59], s60 offen offset:2048 lds
    v_mfma_f32_16x16x32_bf16 v[100:103], v[156:159], a[112:115], v[100:103]
    v_mfma_f32_16x16x32_bf16 v[108:111], v[156:159], a[116:119], v[108:111]
    buffer_load_dwordx4 v251, s[56:59], s60 offen offset:3072 lds
    s_add_u32 s60, s60, 32768
    v_mfma_f32_16x16x32_bf16 v[116:119], v[156:159], a[120:123], v[116:119]
    v_mfma_f32_16x16x32_bf16 v[124:127], v[156:159], a[124:127], v[124:127]
    s_waitcnt lgkmcnt(0)
    s_waitcnt vmcnt(40)
    v_mfma_f32_16x16x32_bf16 v[0:3], v[128:131], a[128:131], v[0:3]
    s_waitcnt vmcnt(8)
    s_add_u32 m0, s62, 4096
    ds_read_b64_tr_b16 v[144:145], v225 offset:8192
    v_mfma_f32_16x16x32_bf16 v[8:11], v[128:131], a[132:135], v[8:11]
    ds_read_b64_tr_b16 v[146:147], v225 offset:12288
    ds_read_b64_tr_b16 v[148:149], v226 offset:8192
    v_mfma_f32_16x16x32_bf16 v[16:19], v[128:131], a[136:139], v[16:19]
    ds_read_b64_tr_b16 v[150:151], v226 offset:12288
    ds_read_b64_tr_b16 v[152:153], v225 offset:10240
    v_mfma_f32_16x16x32_bf16 v[24:27], v[128:131], a[140:143], v[24:27]
    buffer_load_dwordx4 v248, s[56:59], s60 offen offset:0 lds
    v_mfma_f32_16x16x32_bf16 v[4:7], v[132:135], a[128:131], v[4:7]
    ds_read_b64_tr_b16 v[154:155], v225 offset:14336
    ds_read_b64_tr_b16 v[156:157], v226 offset:10240
    v_mfma_f32_16x16x32_bf16 v[12:15], v[132:135], a[132:135], v[12:15]
    ds_read_b64_tr_b16 v[158:159], v226 offset:14336
    ds_read_b64_tr_b16 a[0:1], v208 offset:0
    v_mfma_f32_16x16x32_bf16 v[20:23], v[132:135], a[136:139], v[20:23]
    ds_read_b64_tr_b16 a[2:3], v208 offset:2048
    ds_read_b64_tr_b16 a[4:5], v209 offset:0
    v_mfma_f32_16x16x32_bf16 v[28:31], v[132:135], a[140:143], v[28:31]
    buffer_load_dwordx4 v249, s[56:59], s60 offen offset:1024 lds
    v_mfma_f32_16x16x32_bf16 v[32:35], v[136:139], a[128:131], v[32:35]
    ds_read_b64_tr_b16 a[6:7], v209 offset:2048
    ds_read_b64_tr_b16 a[8:9], v210 offset:0
    v_mfma_f32_16x16x32_bf16 v[40:43], v[136:139], a[132:135], v[40:43]
    ds_read_b64_tr_b16 a[10:11], v210 offset:2048
    ds_read_b64_tr_b16 a[12:13], v211 offset:0
    v_mfma_f32_16x16x32_bf16 v[48:51], v[136:139], a[136:139], v[48:51]
    ds_read_b64_tr_b16 a[14:15], v211 offset:2048
    v_mfma_f32_16x16x32_bf16 v[56:59], v[136:139], a[140:143], v[56:59]
    buffer_load_dwordx4 v250, s[56:59], s60 offen offset:2048 lds
    v_mfma_f32_16x16x32_bf16 v[36:39], v[140:143], a[128:131], v[36:39]
    v_mfma_f32_16x16x32_bf16 v[44:47], v[140:143], a[132:135], v[44:47]
    buffer_load_dwordx4 v251, s[56:59], s60 offen offset:3072 lds
    s_add_u32 s60, s60, 32768
    v_mfma_f32_16x16x32_bf16 v[52:55], v[140:143], a[136:139], v[52:55]
    v_mfma_f32_16x16x32_bf16 v[60:63], v[140:143], a[140:143], v[60:63]
    s_waitcnt lgkmcnt(0)
    v_mfma_f32_16x16x32_bf16 v[0:3], v[144:147], a[144:147], v[0:3]
    s_waitcnt vmcnt(8)
    s_add_u32 m0, s62, 8192
    ds_read_b64_tr_b16 v[128:129], v225 offset:16384
    v_mfma_f32_16x16x32_bf16 v[8:11], v[144:147], a[148:151], v[8:11]
    ds_read_b64_tr_b16 v[130:131], v225 offset:20480
    ds_read_b64_tr_b16 v[132:133], v226 offset:16384
    v_mfma_f32_16x16x32_bf16 v[16:19], v[144:147], a[152:155], v[16:19]
    ds_read_b64_tr_b16 v[134:135], v226 offset:20480
    ds_read_b64_tr_b16 v[136:137], v225 offset:18432
    v_mfma_f32_16x16x32_bf16 v[24:27], v[144:147], a[156:159], v[24:27]
    buffer_load_dwordx4 v248, s[56:59], s60 offen offset:0 lds
    v_mfma_f32_16x16x32_bf16 v[4:7], v[148:151], a[144:147], v[4:7]
    ds_read_b64_tr_b16 v[138:139], v225 offset:22528
    ds_read_b64_tr_b16 v[140:141], v226 offset:18432
    v_mfma_f32_16x16x32_bf16 v[12:15], v[148:151], a[148:151], v[12:15]
    ds_read_b64_tr_b16 v[142:143], v226 offset:22528
    ds_read_b64_tr_b16 a[16:17], v208 offset:4096
    v_mfma_f32_16x16x32_bf16 v[20:23], v[148:151], a[152:155], v[20:23]
    ds_read_b64_tr_b16 a[18:19], v208 offset:6144
    ds_read_b64_tr_b16 a[20:21], v209 offset:4096
    v_mfma_f32_16x16x32_bf16 v[28:31], v[148:151], a[156:159], v[28:31]
    buffer_load_dwordx4 v249, s[56:59], s60 offen offset:1024 lds
    v_mfma_f32_16x16x32_bf16 v[32:35], v[152:155], a[144:147], v[32:35]
    ds_read_b64_tr_b16 a[22:23], v209 offset:6144
    ds_read_b64_tr_b16 a[24:25], v210 offset:4096
    v_mfma_f32_16x16x32_bf16 v[40:43], v[152:155], a[148:151], v[40:43]
    ds_read_b64_tr_b16 a[26:27], v210 offset:6144
    ds_read_b64_tr_b16 a[28:29], v211 offset:4096
    v_mfma_f32_16x16x32_bf16 v[48:51], v[152:155], a[152:155], v[48:51]
    ds_read_b64_tr_b16 a[30:31], v211 offset:6144
    v_mfma_f32_16x16x32_bf16 v[56:59], v[152:155], a[156:159], v[56:59]
    buffer_load_dwordx4 v250, s[56:59], s60 offen offset:2048 lds
    v_mfma_f32_16x16x32_bf16 v[36:39], v[156:159], a[144:147], v[36:39]
    v_mfma_f32_16x16x32_bf16 v[44:47], v[156:159], a[148:151], v[44:47]
    buffer_load_dwordx4 v251, s[56:59], s60 offen offset:3072 lds
    s_add_u32 s60, s60, 32768
    v_mfma_f32_16x16x32_bf16 v[52:55], v[156:159], a[152:155], v[52:55]
    v_mfma_f32_16x16x32_bf16 v[60:63], v[156:159], a[156:159], v[60:63]
    s_waitcnt lgkmcnt(0)
    v_mfma_f32_16x16x32_bf16 v[0:3], v[128:131], a[160:163], v[0:3]
    s_add_u32 m0, s62, 12288
    ds_read_b64_tr_b16 v[144:145], v225 offset:24576
    v_mfma_f32_16x16x32_bf16 v[8:11], v[128:131], a[164:167], v[8:11]
    ds_read_b64_tr_b16 v[146:147], v225 offset:28672
    v_mfma_f32_16x16x32_bf16 v[16:19], v[128:131], a[168:171], v[16:19]
    ds_read_b64_tr_b16 v[148:149], v226 offset:24576
    v_mfma_f32_16x16x32_bf16 v[24:27], v[128:131], a[172:175], v[24:27]
    buffer_load_dwordx4 v248, s[56:59], s60 offen offset:0 lds
    v_mfma_f32_16x16x32_bf16 v[4:7], v[132:135], a[160:163], v[4:7]
    ds_read_b64_tr_b16 v[150:151], v226 offset:28672
    v_mfma_f32_16x16x32_bf16 v[12:15], v[132:135], a[164:167], v[12:15]
    ds_read_b64_tr_b16 v[152:153], v225 offset:26624
    v_mfma_f32_16x16x32_bf16 v[20:23], v[132:135], a[168:171], v[20:23]
    ds_read_b64_tr_b16 v[154:155], v225 offset:30720
    v_mfma_f32_16x16x32_bf16 v[28:31], v[132:135], a[172:175], v[28:31]
    buffer_load_dwordx4 v249, s[56:59], s60 offen offset:1024 lds
    v_mfma_f32_16x16x32_bf16 v[32:35], v[136:139], a[160:163], v[32:35]
    ds_read_b64_tr_b16 v[156:157], v226 offset:26624
    v_mfma_f32_16x16x32_bf16 v[40:43], v[136:139], a[164:167], v[40:43]
    ds_read_b64_tr_b16 v[158:159], v226 offset:30720
    v_mfma_f32_16x16x32_bf16 v[48:51], v[136:139], a[168:171], v[48:51]
    v_mfma_f32_16x16x32_bf16 v[56:59], v[136:139], a[172:175], v[56:59]
    buffer_load_dwordx4 v250, s[56:59], s60 offen offset:2048 lds
    v_mfma_f32_16x16x32_bf16 v[36:39], v[140:143], a[160:163], v[36:39]
    v_mfma_f32_16x16x32_bf16 v[44:47], v[140:143], a[164:167], v[44:47]
    buffer_load_dwordx4 v251, s[56:59], s60 offen offset:3072 lds
    s_add_u32 s60, s60, 32768
    v_mfma_f32_16x16x32_bf16 v[52:55], v[140:143], a[168:171], v[52:55]
    v_mfma_f32_16x16x32_bf16 v[60:63], v[140:143], a[172:175], v[60:63]
    s_waitcnt lgkmcnt(0)
    v_mfma_f32_16x16x32_bf16 v[0:3], v[144:147], a[176:179], v[0:3]
    s_add_u32 m0, s61, 131072
    ds_read_b64_tr_b16 v[128:129], v225 offset:32768
    v_mfma_f32_16x16x32_bf16 v[8:11], v[144:147], a[180:183], v[8:11]
    ds_read_b64_tr_b16 v[130:131], v225 offset:36864
    v_mfma_f32_16x16x32_bf16 v[16:19], v[144:147], a[184:187], v[16:19]
    ds_read_b64_tr_b16 v[132:133], v226 offset:32768
    v_mfma_f32_16x16x32_bf16 v[24:27], v[144:147], a[188:191], v[24:27]
    buffer_load_dwordx4 v248, s[56:59], s60 offen offset:0 lds
    v_mfma_f32_16x16x32_bf16 v[4:7], v[148:151], a[176:179], v[4:7]
    ds_read_b64_tr_b16 v[134:135], v226 offset:36864
    v_mfma_f32_16x16x32_bf16 v[12:15], v[148:151], a[180:183], v[12:15]
    ds_read_b64_tr_b16 v[136:137], v225 offset:34816
    v_mfma_f32_16x16x32_bf16 v[20:23], v[148:151], a[184:187], v[20:23]
    ds_read_b64_tr_b16 v[138:139], v225 offset:38912
    v_mfma_f32_16x16x32_bf16 v[28:31], v[148:151], a[188:191], v[28:31]
    buffer_load_dwordx4 v249, s[56:59], s60 offen offset:1024 lds
    v_mfma_f32_16x16x32_bf16 v[32:35], v[152:155], a[176:179], v[32:35]
    ds_read_b64_tr_b16 v[140:141], v226 offset:34816
    v_mfma_f32_16x16x32_bf16 v[40:43], v[152:155], a[180:183], v[40:43]
    ds_read_b64_tr_b16 v[142:143], v226 offset:38912
    v_mfma_f32_16x16x32_bf16 v[48:51], v[152:155], a[184:187], v[48:51]
    v_mfma_f32_16x16x32_bf16 v[56:59], v[152:155], a[188:191], v[56:59]
    buffer_load_dwordx4 v250, s[56:59], s60 offen offset:2048 lds
    v_mfma_f32_16x16x32_bf16 v[36:39], v[156:159], a[176:179], v[36:39]
    v_mfma_f32_16x16x32_bf16 v[44:47], v[156:159], a[180:183], v[44:47]
    buffer_load_dwordx4 v251, s[56:59], s60 offen offset:3072 lds
    s_add_u32 s60, s60, 32768
    v_mfma_f32_16x16x32_bf16 v[52:55], v[156:159], a[184:187], v[52:55]
    v_mfma_f32_16x16x32_bf16 v[60:63], v[156:159], a[188:191], v[60:63]
    s_waitcnt lgkmcnt(0)
    v_mfma_f32_16x16x32_bf16 v[0:3], v[128:131], a[192:195], v[0:3]
    s_waitcnt vmcnt(16)
    s_add_u32 m0, s61, 135168
    ds_read_b64_tr_b16 v[144:145], v225 offset:40960
    v_mfma_f32_16x16x32_bf16 v[8:11], v[128:131], a[196:199], v[8:11]
    ds_read_b64_tr_b16 v[146:147], v225 offset:45056
    ds_read_b64_tr_b16 v[148:149], v226 offset:40960
    v_mfma_f32_16x16x32_bf16 v[16:19], v[128:131], a[200:203], v[16:19]
    ds_read_b64_tr_b16 v[150:151], v226 offset:45056
    ds_read_b64_tr_b16 v[152:153], v225 offset:43008
    v_mfma_f32_16x16x32_bf16 v[24:27], v[128:131], a[204:207], v[24:27]
    buffer_load_dwordx4 v248, s[56:59], s60 offen offset:0 lds
    v_mfma_f32_16x16x32_bf16 v[4:7], v[132:135], a[192:195], v[4:7]
    ds_read_b64_tr_b16 v[154:155], v225 offset:47104
    ds_read_b64_tr_b16 v[156:157], v226 offset:43008
    v_mfma_f32_16x16x32_bf16 v[12:15], v[132:135], a[196:199], v[12:15]
    ds_read_b64_tr_b16 v[158:159], v226 offset:47104
    ds_read_b64_tr_b16 a[32:33], v212 offset:0
    v_mfma_f32_16x16x32_bf16 v[20:23], v[132:135], a[200:203], v[20:23]
    ds_read_b64_tr_b16 a[34:35], v212 offset:2048
    ds_read_b64_tr_b16 a[36:37], v213 offset:0
    v_mfma_f32_16x16x32_bf16 v[28:31], v[132:135], a[204:207], v[28:31]
    buffer_load_dwordx4 v249, s[56:59], s60 offen offset:1024 lds
    v_mfma_f32_16x16x32_bf16 v[32:35], v[136:139], a[192:195], v[32:35]
    ds_read_b64_tr_b16 a[38:39], v213 offset:2048
    ds_read_b64_tr_b16 a[40:41], v214 offset:0
    v_mfma_f32_16x16x32_bf16 v[40:43], v[136:139], a[196:199], v[40:43]
    ds_read_b64_tr_b16 a[42:43], v214 offset:2048
    ds_read_b64_tr_b16 a[44:45], v215 offset:0
    v_mfma_f32_16x16x32_bf16 v[48:51], v[136:139], a[200:203], v[48:51]
    ds_read_b64_tr_b16 a[46:47], v215 offset:2048
    v_mfma_f32_16x16x32_bf16 v[56:59], v[136:139], a[204:207], v[56:59]
    buffer_load_dwordx4 v250, s[56:59], s60 offen offset:2048 lds
    v_mfma_f32_16x16x32_bf16 v[36:39], v[140:143], a[192:195], v[36:39]
    v_mfma_f32_16x16x32_bf16 v[44:47], v[140:143], a[196:199], v[44:47]
    buffer_load_dwordx4 v251, s[56:59], s60 offen offset:3072 lds
    s_add_u32 s60, s60, 32768
    v_mfma_f32_16x16x32_bf16 v[52:55], v[140:143], a[200:203], v[52:55]
    v_mfma_f32_16x16x32_bf16 v[60:63], v[140:143], a[204:207], v[60:63]
    s_waitcnt lgkmcnt(0)
    v_mfma_f32_16x16x32_bf16 v[0:3], v[144:147], a[208:211], v[0:3]
    s_waitcnt vmcnt(16)
    s_add_u32 m0, s62, 0
    ds_read_b64_tr_b16 v[128:129], v225 offset:49152
    v_mfma_f32_16x16x32_bf16 v[8:11], v[144:147], a[212:215], v[8:11]
    ds_read_b64_tr_b16 v[130:131], v225 offset:53248
    ds_read_b64_tr_b16 v[132:133], v226 offset:49152
    v_mfma_f32_16x16x32_bf16 v[16:19], v[144:147], a[216:219], v[16:19]
    ds_read_b64_tr_b16 v[134:135], v226 offset:53248
    ds_read_b64_tr_b16 v[136:137], v225 offset:51200
    v_mfma_f32_16x16x32_bf16 v[24:27], v[144:147], a[220:223], v[24:27]
    buffer_load_dwordx4 v248, s[56:59], s60 offen offset:0 lds
    v_mfma_f32_16x16x32_bf16 v[4:7], v[148:151], a[208:211], v[4:7]
    ds_read_b64_tr_b16 v[138:139], v225 offset:55296
    ds_read_b64_tr_b16 v[140:141], v226 offset:51200
    v_mfma_f32_16x16x32_bf16 v[12:15], v[148:151], a[212:215], v[12:15]
    ds_read_b64_tr_b16 v[142:143], v226 offset:55296
    ds_read_b64_tr_b16 a[48:49], v212 offset:4096
    v_mfma_f32_16x16x32_bf16 v[20:23], v[148:151], a[216:219], v[20:23]
    ds_read_b64_tr_b16 a[50:51], v212 offset:6144
    ds_read_b64_tr_b16 a[52:53], v213 offset:4096
    v_mfma_f32_16x16x32_bf16 v[28:31], v[148:151], a[220:223], v[28:31]
    buffer_load_dwordx4 v249, s[56:59], s60 offen offset:1024 lds
    v_mfma_f32_16x16x32_bf16 v[32:35], v[152:155], a[208:211], v[32:35]
    ds_read_b64_tr_b16 a[54:55], v213 offset:6144
    ds_read_b64_tr_b16 a[56:57], v214 offset:4096
    v_mfma_f32_16x16x32_bf16 v[40:43], v[152:155], a[212:215], v[40:43]
    ds_read_b64_tr_b16 a[58:59], v214 offset:6144
    ds_read_b64_tr_b16 a[60:61], v215 offset:4096
    v_mfma_f32_16x16x32_bf16 v[48:51], v[152:155], a[216:219], v[48:51]
    ds_read_b64_tr_b16 a[62:63], v215 offset:6144
    v_mfma_f32_16x16x32_bf16 v[56:59], v[152:155], a[220:223], v[56:59]
    buffer_load_dwordx4 v250, s[56:59], s60 offen offset:2048 lds
    v_mfma_f32_16x16x32_bf16 v[36:39], v[156:159], a[208:211], v[36:39]
    v_mfma_f32_16x16x32_bf16 v[44:47], v[156:159], a[212:215], v[44:47]
    buffer_load_dwordx4 v251, s[56:59], s60 offen offset:3072 lds
    s_add_u32 s60, s60, 32768
    v_mfma_f32_16x16x32_bf16 v[52:55], v[156:159], a[216:219], v[52:55]
    v_mfma_f32_16x16x32_bf16 v[60:63], v[156:159], a[220:223], v[60:63]
    s_waitcnt lgkmcnt(0)
    v_mfma_f32_16x16x32_bf16 v[0:3], v[128:131], a[224:227], v[0:3]
    s_waitcnt vmcnt(16)
    s_add_u32 m0, s62, 4096
    ds_read_b64_tr_b16 v[144:145], v225 offset:57344
    v_mfma_f32_16x16x32_bf16 v[8:11], v[128:131], a[228:231], v[8:11]
    ds_read_b64_tr_b16 v[146:147], v225 offset:61440
    ds_read_b64_tr_b16 v[148:149], v226 offset:57344
    v_mfma_f32_16x16x32_bf16 v[16:19], v[128:131], a[232:235], v[16:19]
    ds_read_b64_tr_b16 v[150:151], v226 offset:61440
    ds_read_b64_tr_b16 v[152:153], v225 offset:59392
    v_mfma_f32_16x16x32_bf16 v[24:27], v[128:131], a[236:239], v[24:27]
    buffer_load_dwordx4 v248, s[56:59], s60 offen offset:0 lds
    v_mfma_f32_16x16x32_bf16 v[4:7], v[132:135], a[224:227], v[4:7]
    ds_read_b64_tr_b16 v[154:155], v225 offset:63488
    ds_read_b64_tr_b16 v[156:157], v226 offset:59392
    v_mfma_f32_16x16x32_bf16 v[12:15], v[132:135], a[228:231], v[12:15]
    ds_read_b64_tr_b16 v[158:159], v226 offset:63488
    ds_read_b64_tr_b16 a[64:65], v212 offset:8192
    v_mfma_f32_16x16x32_bf16 v[20:23], v[132:135], a[232:235], v[20:23]
    ds_read_b64_tr_b16 a[66:67], v212 offset:10240
    ds_read_b64_tr_b16 a[68:69], v213 offset:8192
    v_mfma_f32_16x16x32_bf16 v[28:31], v[132:135], a[236:239], v[28:31]
    buffer_load_dwordx4 v249, s[56:59], s60 offen offset:1024 lds
    v_mfma_f32_16x16x32_bf16 v[32:35], v[136:139], a[224:227], v[32:35]
    ds_read_b64_tr_b16 a[70:71], v213 offset:10240
    ds_read_b64_tr_b16 a[72:73], v214 offset:8192
    v_mfma_f32_16x16x32_bf16 v[40:43], v[136:139], a[228:231], v[40:43]
    ds_read_b64_tr_b16 a[74:75], v214 offset:10240
    ds_read_b64_tr_b16 a[76:77], v215 offset:8192
    v_mfma_f32_16x16x32_bf16 v[48:51], v[136:139], a[232:235], v[48:51]
    ds_read_b64_tr_b16 a[78:79], v215 offset:10240
    v_mfma_f32_16x16x32_bf16 v[56:59], v[136:139], a[236:239], v[56:59]
    buffer_load_dwordx4 v250, s[56:59], s60 offen offset:2048 lds
    v_mfma_f32_16x16x32_bf16 v[36:39], v[140:143], a[224:227], v[36:39]
    v_mfma_f32_16x16x32_bf16 v[44:47], v[140:143], a[228:231], v[44:47]
    buffer_load_dwordx4 v251, s[56:59], s60 offen offset:3072 lds
    s_add_u32 s60, s60, 32768
    v_mfma_f32_16x16x32_bf16 v[52:55], v[140:143], a[232:235], v[52:55]
    v_mfma_f32_16x16x32_bf16 v[60:63], v[140:143], a[236:239], v[60:63]
    s_waitcnt lgkmcnt(0)
    v_mfma_f32_16x16x32_bf16 v[0:3], v[144:147], a[240:243], v[0:3]
    s_waitcnt vmcnt(16)
    s_add_u32 m0, s62, 8192
    ds_read_b64_tr_b16 v[128:129], v227 offset:0
    v_mfma_f32_16x16x32_bf16 v[8:11], v[144:147], a[244:247], v[8:11]
    ds_read_b64_tr_b16 v[130:131], v227 offset:4096
    ds_read_b64_tr_b16 v[132:133], v228 offset:0
    v_mfma_f32_16x16x32_bf16 v[16:19], v[144:147], a[248:251], v[16:19]
    ds_read_b64_tr_b16 v[134:135], v228 offset:4096
    ds_read_b64_tr_b16 v[136:137], v227 offset:2048
    v_mfma_f32_16x16x32_bf16 v[24:27], v[144:147], a[252:255], v[24:27]
    buffer_load_dwordx4 v248, s[56:59], s60 offen offset:0 lds
    v_mfma_f32_16x16x32_bf16 v[4:7], v[148:151], a[240:243], v[4:7]
    ds_read_b64_tr_b16 v[138:139], v227 offset:6144
    ds_read_b64_tr_b16 v[140:141], v228 offset:2048
    v_mfma_f32_16x16x32_bf16 v[12:15], v[148:151], a[244:247], v[12:15]
    ds_read_b64_tr_b16 v[142:143], v228 offset:6144
    ds_read_b64_tr_b16 a[80:81], v212 offset:12288
    v_mfma_f32_16x16x32_bf16 v[20:23], v[148:151], a[248:251], v[20:23]
    ds_read_b64_tr_b16 a[82:83], v212 offset:14336
    ds_read_b64_tr_b16 a[84:85], v213 offset:12288
    v_mfma_f32_16x16x32_bf16 v[28:31], v[148:151], a[252:255], v[28:31]
    buffer_load_dwordx4 v249, s[56:59], s60 offen offset:1024 lds
    v_mfma_f32_16x16x32_bf16 v[32:35], v[152:155], a[240:243], v[32:35]
    ds_read_b64_tr_b16 a[86:87], v213 offset:14336
    ds_read_b64_tr_b16 a[88:89], v214 offset:12288
    v_mfma_f32_16x16x32_bf16 v[40:43], v[152:155], a[244:247], v[40:43]
    ds_read_b64_tr_b16 a[90:91], v214 offset:14336
    ds_read_b64_tr_b16 a[92:93], v215 offset:12288
    v_mfma_f32_16x16x32_bf16 v[48:51], v[152:155], a[248:251], v[48:51]
    ds_read_b64_tr_b16 a[94:95], v215 offset:14336
    v_mfma_f32_16x16x32_bf16 v[56:59], v[152:155], a[252:255], v[56:59]
    buffer_load_dwordx4 v250, s[56:59], s60 offen offset:2048 lds
    v_mfma_f32_16x16x32_bf16 v[36:39], v[156:159], a[240:243], v[36:39]
    v_mfma_f32_16x16x32_bf16 v[44:47], v[156:159], a[244:247], v[44:47]
    buffer_load_dwordx4 v251, s[56:59], s60 offen offset:3072 lds
    s_add_u32 s60, s60, 32768
    v_mfma_f32_16x16x32_bf16 v[52:55], v[156:159], a[248:251], v[52:55]
    v_mfma_f32_16x16x32_bf16 v[60:63], v[156:159], a[252:255], v[60:63]
    s_waitcnt lgkmcnt(0)
    v_mfma_f32_16x16x32_bf16 v[64:67], v[128:131], a[128:131], v[64:67]
    s_waitcnt vmcnt(16)
    s_add_u32 m0, s62, 12288
    ds_read_b64_tr_b16 v[144:145], v227 offset:8192
    v_mfma_f32_16x16x32_bf16 v[72:75], v[128:131], a[132:135], v[72:75]
    ds_read_b64_tr_b16 v[146:147], v227 offset:12288
    ds_read_b64_tr_b16 v[148:149], v228 offset:8192
    v_mfma_f32_16x16x32_bf16 v[80:83], v[128:131], a[136:139], v[80:83]
    ds_read_b64_tr_b16 v[150:151], v228 offset:12288
    ds_read_b64_tr_b16 v[152:153], v227 offset:10240
    s_nop 7
    v_mfma_f32_16x16x32_bf16 v[88:91], v[128:131], a[140:143], v[88:91]
    buffer_load_dwordx4 v248, s[56:59], s60 offen offset:0 lds
    v_mfma_f32_16x16x32_bf16 v[68:71], v[132:135], a[128:131], v[68:71]
    ds_read_b64_tr_b16 v[154:155], v227 offset:14336
    ds_read_b64_tr_b16 v[156:157], v228 offset:10240
    v_mfma_f32_16x16x32_bf16 v[76:79], v[132:135], a[132:135], v[76:79]
    ds_read_b64_tr_b16 v[158:159], v228 offset:14336
    ds_read_b64_tr_b16 a[96:97], v208 offset:0
    s_nop 3
    v_mfma_f32_16x16x32_bf16 v[84:87], v[132:135], a[136:139], v[84:87]
    ds_read_b64_tr_b16 a[98:99], v208 offset:2048
    ds_read_b64_tr_b16 a[100:101], v209 offset:0
    v_mul_f32 v160, v0, v0
    v_mfma_f32_16x16x32_bf16 v[92:95], v[132:135], a[140:143], v[92:95]
    buffer_load_dwordx4 v249, s[56:59], s60 offen offset:1024 lds
    v_mul_f32 v161, v1, v1
    v_mul_f32 v162, v2, v2
    v_mfma_f32_16x16x32_bf16 v[96:99], v[136:139], a[128:131], v[96:99]
    ds_read_b64_tr_b16 a[102:103], v209 offset:2048
    ds_read_b64_tr_b16 a[104:105], v210 offset:0
    v_mul_f32 v163, v3, v3
    v_mul_f32 v164, v4, v4
    v_mfma_f32_16x16x32_bf16 v[104:107], v[136:139], a[132:135], v[104:107]
    ds_read_b64_tr_b16 a[106:107], v210 offset:2048
    ds_read_b64_tr_b16 a[108:109], v211 offset:0
    v_mul_f32 v165, v5, v5
    v_mul_f32 v166, v6, v6
    v_mfma_f32_16x16x32_bf16 v[112:115], v[136:139], a[136:139], v[112:115]
    ds_read_b64_tr_b16 a[110:111], v211 offset:2048
    v_mul_f32 v167, v7, v7
    v_fma_f32 v160, v160, v240, v242
    v_mfma_f32_16x16x32_bf16 v[120:123], v[136:139], a[140:143], v[120:123]
    buffer_load_dwordx4 v250, s[56:59], s60 offen offset:2048 lds
    v_fma_f32 v161, v161, v240, v242
    v_fma_f32 v162, v162, v240, v242
    v_mfma_f32_16x16x32_bf16 v[100:103], v[140:143], a[128:131], v[100:103]
    v_fma_f32 v163, v163, v240, v242
    v_fma_f32 v164, v164, v240, v242
    v_fma_f32 v165, v165, v240, v242
    v_mfma_f32_16x16x32_bf16 v[108:111], v[140:143], a[132:135], v[108:111]
    buffer_load_dwordx4 v251, s[56:59], s60 offen offset:3072 lds
    s_add_u32 s60, s60, 32768
    v_fma_f32 v166, v166, v240, v242
    v_mfma_f32_16x16x32_bf16 v[116:119], v[140:143], a[136:139], v[116:119]
    v_fma_f32 v167, v167, v240, v242
    v_mul_f32 v160, v160, v0
    v_mul_f32 v161, v161, v1
    v_mfma_f32_16x16x32_bf16 v[124:127], v[140:143], a[140:143], v[124:127]
    s_waitcnt lgkmcnt(0)
    v_mul_f32 v162, v162, v2
    v_mul_f32 v163, v163, v3
    v_mul_f32 v164, v164, v4
    v_mul_f32 v165, v165, v5
    v_mfma_f32_16x16x32_bf16 v[64:67], v[144:147], a[144:147], v[64:67]
    s_waitcnt vmcnt(16)
    s_add_u32 m0, s61, 131072
    ds_read_b64_tr_b16 v[128:129], v227 offset:16384
    v_mul_f32 v166, v166, v6
    v_mul_f32 v167, v167, v7
    v_mfma_f32_16x16x32_bf16 v[72:75], v[144:147], a[148:151], v[72:75]
    ds_read_b64_tr_b16 v[130:131], v227 offset:20480
    ds_read_b64_tr_b16 v[132:133], v228 offset:16384
    v_exp_f32 v160, v160
    v_mul_f32 v0, v0, v32
    v_mfma_f32_16x16x32_bf16 v[80:83], v[144:147], a[152:155], v[80:83]
    ds_read_b64_tr_b16 v[134:135], v228 offset:20480
    ds_read_b64_tr_b16 v[136:137], v227 offset:18432
    v_exp_f32 v161, v161
    v_mul_f32 v1, v1, v33
    v_mfma_f32_16x16x32_bf16 v[88:91], v[144:147], a[156:159], v[88:91]
    buffer_load_dwordx4 v248, s[56:59], s60 offen offset:0 lds
    v_exp_f32 v162, v162
    v_mul_f32 v2, v2, v34
    v_mfma_f32_16x16x32_bf16 v[68:71], v[148:151], a[144:147], v[68:71]
    ds_read_b64_tr_b16 v[138:139], v227 offset:22528
    ds_read_b64_tr_b16 v[140:141], v228 offset:18432
    v_exp_f32 v163, v163
    v_mfma_f32_16x16x32_bf16 v[76:79], v[148:151], a[148:151], v[76:79]
    ds_read_b64_tr_b16 v[142:143], v228 offset:22528
    ds_read_b64_tr_b16 a[112:113], v208 offset:4096
    v_mul_f32 v3, v3, v35
    v_exp_f32 v164, v164
    v_mfma_f32_16x16x32_bf16 v[84:87], v[148:151], a[152:155], v[84:87]
    ds_read_b64_tr_b16 a[114:115], v208 offset:6144
    ds_read_b64_tr_b16 a[116:117], v209 offset:4096
    v_mul_f32 v4, v4, v36
    v_exp_f32 v165, v165
    v_mfma_f32_16x16x32_bf16 v[92:95], v[148:151], a[156:159], v[92:95]
    buffer_load_dwordx4 v249, s[56:59], s60 offen offset:1024 lds
    v_mul_f32 v5, v5, v37
    v_exp_f32 v166, v166
    v_mfma_f32_16x16x32_bf16 v[96:99], v[152:155], a[144:147], v[96:99]
    ds_read_b64_tr_b16 a[118:119], v209 offset:6144
    ds_read_b64_tr_b16 a[120:121], v210 offset:4096
    v_mul_f32 v6, v6, v38
    v_mfma_f32_16x16x32_bf16 v[104:107], v[152:155], a[148:151], v[104:107]
    ds_read_b64_tr_b16 a[122:123], v210 offset:6144
    ds_read_b64_tr_b16 a[124:125], v211 offset:4096
    v_exp_f32 v167, v167
    v_mul_f32 v7, v7, v39
    v_mfma_f32_16x16x32_bf16 v[112:115], v[152:155], a[152:155], v[112:115]
    ds_read_b64_tr_b16 a[126:127], v211 offset:6144
    v_add_f32 v160, 1.0, v160
    v_add_f32 v161, 1.0, v161
    v_add_f32 v162, 1.0, v162
    v_add_f32 v163, 1.0, v163
    v_mfma_f32_16x16x32_bf16 v[120:123], v[152:155], a[156:159], v[120:123]
    buffer_load_dwordx4 v250, s[56:59], s60 offen offset:2048 lds
    v_add_f32 v164, 1.0, v164
    v_add_f32 v165, 1.0, v165
    v_add_f32 v166, 1.0, v166
    v_mfma_f32_16x16x32_bf16 v[100:103], v[156:159], a[144:147], v[100:103]
    v_add_f32 v167, 1.0, v167
    v_rcp_f32 v160, v160
    v_rcp_f32 v161, v161
    v_mfma_f32_16x16x32_bf16 v[108:111], v[156:159], a[148:151], v[108:111]
    buffer_load_dwordx4 v251, s[56:59], s60 offen offset:3072 lds
    s_add_u32 s60, s60, 32768
    v_rcp_f32 v162, v162
    v_mfma_f32_16x16x32_bf16 v[116:119], v[156:159], a[152:155], v[116:119]
    v_rcp_f32 v163, v163
    v_rcp_f32 v164, v164
    v_mfma_f32_16x16x32_bf16 v[124:127], v[156:159], a[156:159], v[124:127]
    s_waitcnt lgkmcnt(0)
    v_rcp_f32 v165, v165
    v_rcp_f32 v166, v166
    v_mfma_f32_16x16x32_bf16 v[64:67], v[128:131], a[160:163], v[64:67]
    s_add_u32 m0, s61, 135168
    ds_read_b64_tr_b16 v[144:145], v227 offset:24576
    v_rcp_f32 v167, v167
    s_nop 0
    v_mfma_f32_16x16x32_bf16 v[72:75], v[128:131], a[164:167], v[72:75]
    ds_read_b64_tr_b16 v[146:147], v227 offset:28672
    v_mul_f32 v0, v0, v160
    v_mul_f32 v1, v1, v161
    v_mul_f32 v2, v2, v162
    v_mfma_f32_16x16x32_bf16 v[80:83], v[128:131], a[168:171], v[80:83]
    ds_read_b64_tr_b16 v[148:149], v228 offset:24576
    v_mul_f32 v3, v3, v163
    v_mul_f32 v4, v4, v164
    v_mul_f32 v5, v5, v165
    v_mfma_f32_16x16x32_bf16 v[88:91], v[128:131], a[172:175], v[88:91]
    buffer_load_dwordx4 v248, s[56:59], s60 offen offset:0 lds
    v_mul_f32 v6, v6, v166
    v_mul_f32 v7, v7, v167
    v_mfma_f32_16x16x32_bf16 v[68:71], v[132:135], a[160:163], v[68:71]
    ds_read_b64_tr_b16 v[150:151], v228 offset:28672
    v_cvt_pk_bf16_f32 v176, v0, v1
    v_cvt_pk_bf16_f32 v177, v2, v3
    v_cvt_pk_bf16_f32 v178, v4, v5
    v_mfma_f32_16x16x32_bf16 v[76:79], v[132:135], a[164:167], v[76:79]
    ds_read_b64_tr_b16 v[152:153], v227 offset:26624
    v_cvt_pk_bf16_f32 v179, v6, v7
    v_mfma_f32_16x16x32_bf16 v[84:87], v[132:135], a[168:171], v[84:87]
    ds_read_b64_tr_b16 v[154:155], v227 offset:30720
    buffer_store_dwordx4 v[176:179], v220, s[12:15], s44 offen offset:0 sc1
    v_mul_f32 v168, v8, v8
    v_mfma_f32_16x16x32_bf16 v[92:95], v[132:135], a[172:175], v[92:95]
    buffer_load_dwordx4 v249, s[56:59], s60 offen offset:1024 lds
    v_mul_f32 v169, v9, v9
    v_mul_f32 v170, v10, v10
    v_mul_f32 v171, v11, v11
    v_mfma_f32_16x16x32_bf16 v[96:99], v[136:139], a[160:163], v[96:99]
    ds_read_b64_tr_b16 v[156:157], v228 offset:26624
    v_mul_f32 v172, v12, v12
    v_mul_f32 v173, v13, v13
    v_mfma_f32_16x16x32_bf16 v[104:107], v[136:139], a[164:167], v[104:107]
    ds_read_b64_tr_b16 v[158:159], v228 offset:30720
    v_mul_f32 v174, v14, v14
    v_mul_f32 v175, v15, v15
    v_fma_f32 v168, v168, v240, v242
    v_mfma_f32_16x16x32_bf16 v[112:115], v[136:139], a[168:171], v[112:115]
    v_fma_f32 v169, v169, v240, v242
    v_fma_f32 v170, v170, v240, v242
    v_fma_f32 v171, v171, v240, v242
    v_mfma_f32_16x16x32_bf16 v[120:123], v[136:139], a[172:175], v[120:123]
    buffer_load_dwordx4 v250, s[56:59], s60 offen offset:2048 lds
    v_fma_f32 v172, v172, v240, v242
    v_fma_f32 v173, v173, v240, v242
    v_mfma_f32_16x16x32_bf16 v[100:103], v[140:143], a[160:163], v[100:103]
    v_fma_f32 v174, v174, v240, v242
    v_fma_f32 v175, v175, v240, v242
    v_mul_f32 v168, v168, v8
    v_mul_f32 v169, v169, v9
    v_mfma_f32_16x16x32_bf16 v[108:111], v[140:143], a[164:167], v[108:111]
    buffer_load_dwordx4 v251, s[56:59], s60 offen offset:3072 lds
    s_add_u32 s60, s60, 32768
    v_mul_f32 v170, v170, v10
    v_mfma_f32_16x16x32_bf16 v[116:119], v[140:143], a[168:171], v[116:119]
    v_mul_f32 v171, v171, v11
    v_mul_f32 v172, v172, v12
    v_mul_f32 v173, v173, v13
    v_mul_f32 v174, v174, v14
    v_mfma_f32_16x16x32_bf16 v[124:127], v[140:143], a[172:175], v[124:127]
    s_waitcnt lgkmcnt(0)
    v_mul_f32 v175, v175, v15
    v_exp_f32 v168, v168
    v_mul_f32 v8, v8, v40
    v_mfma_f32_16x16x32_bf16 v[64:67], v[144:147], a[176:179], v[64:67]
    ds_read_b64_tr_b16 v[128:129], v227 offset:32768
    v_exp_f32 v169, v169
    v_mul_f32 v9, v9, v41
    v_mfma_f32_16x16x32_bf16 v[72:75], v[144:147], a[180:183], v[72:75]
    ds_read_b64_tr_b16 v[130:131], v227 offset:36864
    v_exp_f32 v170, v170
    v_mfma_f32_16x16x32_bf16 v[80:83], v[144:147], a[184:187], v[80:83]
    ds_read_b64_tr_b16 v[132:133], v228 offset:32768
    v_mul_f32 v10, v10, v42
    v_exp_f32 v171, v171
    v_mfma_f32_16x16x32_bf16 v[88:91], v[144:147], a[188:191], v[88:91]
    ds_read_b64_tr_b16 v[134:135], v228 offset:36864
    v_mul_f32 v11, v11, v43
    v_exp_f32 v172, v172
    v_mfma_f32_16x16x32_bf16 v[68:71], v[148:151], a[176:179], v[68:71]
    ds_read_b64_tr_b16 v[136:137], v227 offset:34816
    v_mul_f32 v12, v12, v44
    v_mfma_f32_16x16x32_bf16 v[76:79], v[148:151], a[180:183], v[76:79]
    ds_read_b64_tr_b16 v[138:139], v227 offset:38912
    v_exp_f32 v173, v173
    v_mul_f32 v13, v13, v45
    v_mfma_f32_16x16x32_bf16 v[84:87], v[148:151], a[184:187], v[84:87]
    ds_read_b64_tr_b16 v[140:141], v228 offset:34816
    v_exp_f32 v174, v174
    v_mul_f32 v14, v14, v46
    v_mfma_f32_16x16x32_bf16 v[92:95], v[148:151], a[188:191], v[92:95]
    ds_read_b64_tr_b16 v[142:143], v228 offset:38912
    v_exp_f32 v175, v175
    v_mul_f32 v15, v15, v47
    v_mfma_f32_16x16x32_bf16 v[96:99], v[152:155], a[176:179], v[96:99]
    v_add_f32 v168, 1.0, v168
    v_add_f32 v169, 1.0, v169
    v_add_f32 v170, 1.0, v170
    v_mfma_f32_16x16x32_bf16 v[104:107], v[152:155], a[180:183], v[104:107]
    v_add_f32 v171, 1.0, v171
    v_add_f32 v172, 1.0, v172
    v_add_f32 v173, 1.0, v173
    v_add_f32 v174, 1.0, v174
    v_mfma_f32_16x16x32_bf16 v[112:115], v[152:155], a[184:187], v[112:115]
    v_add_f32 v175, 1.0, v175
    v_rcp_f32 v168, v168
    v_mfma_f32_16x16x32_bf16 v[120:123], v[152:155], a[188:191], v[120:123]
    v_rcp_f32 v169, v169
    v_rcp_f32 v170, v170
    v_mfma_f32_16x16x32_bf16 v[100:103], v[156:159], a[176:179], v[100:103]
    v_rcp_f32 v171, v171
    v_rcp_f32 v172, v172
    v_mfma_f32_16x16x32_bf16 v[108:111], v[156:159], a[180:183], v[108:111]
    v_rcp_f32 v173, v173
    v_mfma_f32_16x16x32_bf16 v[116:119], v[156:159], a[184:187], v[116:119]
    v_rcp_f32 v174, v174
    v_rcp_f32 v175, v175
    v_mfma_f32_16x16x32_bf16 v[124:127], v[156:159], a[188:191], v[124:127]
    s_waitcnt lgkmcnt(0)
    s_nop 0
    v_mul_f32 v8, v8, v168
    v_mul_f32 v9, v9, v169
    v_mul_f32 v10, v10, v170
    v_mfma_f32_16x16x32_bf16 v[64:67], v[128:131], a[192:195], v[64:67]
    ds_read_b64_tr_b16 v[144:145], v227 offset:40960
    v_mul_f32 v11, v11, v171
    v_mul_f32 v12, v12, v172
    v_mul_f32 v13, v13, v173
    v_mfma_f32_16x16x32_bf16 v[72:75], v[128:131], a[196:199], v[72:75]
    ds_read_b64_tr_b16 v[146:147], v227 offset:45056
    v_mul_f32 v14, v14, v174
    v_mul_f32 v15, v15, v175
    v_mfma_f32_16x16x32_bf16 v[80:83], v[128:131], a[200:203], v[80:83]
    ds_read_b64_tr_b16 v[148:149], v228 offset:40960
    v_cvt_pk_bf16_f32 v180, v8, v9
    v_cvt_pk_bf16_f32 v181, v10, v11
    v_mfma_f32_16x16x32_bf16 v[88:91], v[128:131], a[204:207], v[88:91]
    ds_read_b64_tr_b16 v[150:151], v228 offset:45056
    v_cvt_pk_bf16_f32 v182, v12, v13
    v_cvt_pk_bf16_f32 v183, v14, v15
    v_mfma_f32_16x16x32_bf16 v[68:71], v[132:135], a[192:195], v[68:71]
    ds_read_b64_tr_b16 v[152:153], v227 offset:43008
    buffer_store_dwordx4 v[180:183], v220, s[12:15], s44 offen offset:1024 sc1
    v_mfma_f32_16x16x32_bf16 v[76:79], v[132:135], a[196:199], v[76:79]
    ds_read_b64_tr_b16 v[154:155], v227 offset:47104
    v_mul_f32 v160, v16, v16
    v_mul_f32 v161, v17, v17
    v_mfma_f32_16x16x32_bf16 v[84:87], v[132:135], a[200:203], v[84:87]
    ds_read_b64_tr_b16 v[156:157], v228 offset:43008
    v_mul_f32 v162, v18, v18
    v_mul_f32 v163, v19, v19
    v_mul_f32 v164, v20, v20
    v_mfma_f32_16x16x32_bf16 v[92:95], v[132:135], a[204:207], v[92:95]
    ds_read_b64_tr_b16 v[158:159], v228 offset:47104
    v_mul_f32 v165, v21, v21
    v_mul_f32 v166, v22, v22
    v_mfma_f32_16x16x32_bf16 v[96:99], v[136:139], a[192:195], v[96:99]
    v_mul_f32 v167, v23, v23
    v_fma_f32 v160, v160, v240, v242
    v_fma_f32 v161, v161, v240, v242
    v_mfma_f32_16x16x32_bf16 v[104:107], v[136:139], a[196:199], v[104:107]
    v_fma_f32 v162, v162, v240, v242
    v_fma_f32 v163, v163, v240, v242
    v_fma_f32 v164, v164, v240, v242
    v_mfma_f32_16x16x32_bf16 v[112:115], v[136:139], a[200:203], v[112:115]
    v_fma_f32 v165, v165, v240, v242
    v_fma_f32 v166, v166, v240, v242
    v_fma_f32 v167, v167, v240, v242
    v_mfma_f32_16x16x32_bf16 v[120:123], v[136:139], a[204:207], v[120:123]
    v_mul_f32 v160, v160, v16
    v_mul_f32 v161, v161, v17
    v_mul_f32 v162, v162, v18
    v_mfma_f32_16x16x32_bf16 v[100:103], v[140:143], a[192:195], v[100:103]
    v_mul_f32 v163, v163, v19
    v_mul_f32 v164, v164, v20
    v_mul_f32 v165, v165, v21
    v_mul_f32 v166, v166, v22
    v_mfma_f32_16x16x32_bf16 v[108:111], v[140:143], a[196:199], v[108:111]
    v_mul_f32 v167, v167, v23
    v_exp_f32 v160, v160
    v_mfma_f32_16x16x32_bf16 v[116:119], v[140:143], a[200:203], v[116:119]
    v_mul_f32 v16, v16, v48
    v_exp_f32 v161, v161
    v_mul_f32 v17, v17, v49
    v_mfma_f32_16x16x32_bf16 v[124:127], v[140:143], a[204:207], v[124:127]
    s_waitcnt lgkmcnt(0)
    v_exp_f32 v162, v162
    v_mul_f32 v18, v18, v50
    v_mfma_f32_16x16x32_bf16 v[64:67], v[144:147], a[208:211], v[64:67]
    ds_read_b64_tr_b16 v[128:129], v227 offset:49152
    v_exp_f32 v163, v163
    v_mul_f32 v19, v19, v51
    v_mfma_f32_16x16x32_bf16 v[72:75], v[144:147], a[212:215], v[72:75]
    ds_read_b64_tr_b16 v[130:131], v227 offset:53248
    v_exp_f32 v164, v164
    v_mfma_f32_16x16x32_bf16 v[80:83], v[144:147], a[216:219], v[80:83]
    ds_read_b64_tr_b16 v[132:133], v228 offset:49152
    v_mul_f32 v20, v20, v52
    v_exp_f32 v165, v165
    v_mfma_f32_16x16x32_bf16 v[88:91], v[144:147], a[220:223], v[88:91]
    ds_read_b64_tr_b16 v[134:135], v228 offset:53248
    v_mul_f32 v21, v21, v53
    v_exp_f32 v166, v166
    v_mfma_f32_16x16x32_bf16 v[68:71], v[148:151], a[208:211], v[68:71]
    ds_read_b64_tr_b16 v[136:137], v227 offset:51200
    v_mul_f32 v22, v22, v54
    v_mfma_f32_16x16x32_bf16 v[76:79], v[148:151], a[212:215], v[76:79]
    ds_read_b64_tr_b16 v[138:139], v227 offset:55296
    v_exp_f32 v167, v167
    v_mul_f32 v23, v23, v55
    v_mfma_f32_16x16x32_bf16 v[84:87], v[148:151], a[216:219], v[84:87]
    ds_read_b64_tr_b16 v[140:141], v228 offset:51200
    v_add_f32 v160, 1.0, v160
    v_add_f32 v161, 1.0, v161
    v_add_f32 v162, 1.0, v162
    v_mfma_f32_16x16x32_bf16 v[92:95], v[148:151], a[220:223], v[92:95]
    ds_read_b64_tr_b16 v[142:143], v228 offset:55296
    v_add_f32 v163, 1.0, v163
    v_add_f32 v164, 1.0, v164
    v_mfma_f32_16x16x32_bf16 v[96:99], v[152:155], a[208:211], v[96:99]
    v_add_f32 v165, 1.0, v165
    v_add_f32 v166, 1.0, v166
    v_add_f32 v167, 1.0, v167
    v_mfma_f32_16x16x32_bf16 v[104:107], v[152:155], a[212:215], v[104:107]
    v_rcp_f32 v160, v160
    v_rcp_f32 v161, v161
    v_mfma_f32_16x16x32_bf16 v[112:115], v[152:155], a[216:219], v[112:115]
    v_rcp_f32 v162, v162
    v_rcp_f32 v163, v163
    v_mfma_f32_16x16x32_bf16 v[120:123], v[152:155], a[220:223], v[120:123]
    v_rcp_f32 v164, v164
    v_rcp_f32 v165, v165
    v_mfma_f32_16x16x32_bf16 v[100:103], v[156:159], a[208:211], v[100:103]
    v_rcp_f32 v166, v166
    v_mfma_f32_16x16x32_bf16 v[108:111], v[156:159], a[212:215], v[108:111]
    v_rcp_f32 v167, v167
    s_nop 0
    v_mul_f32 v16, v16, v160
    v_mfma_f32_16x16x32_bf16 v[116:119], v[156:159], a[216:219], v[116:119]
    v_mul_f32 v17, v17, v161
    v_mul_f32 v18, v18, v162
    v_mul_f32 v19, v19, v163
    v_mul_f32 v20, v20, v164
    v_mfma_f32_16x16x32_bf16 v[124:127], v[156:159], a[220:223], v[124:127]
    s_waitcnt lgkmcnt(0)
    v_mul_f32 v21, v21, v165
    v_mul_f32 v22, v22, v166
    v_mul_f32 v23, v23, v167
    v_mfma_f32_16x16x32_bf16 v[64:67], v[128:131], a[224:227], v[64:67]
    ds_read_b64_tr_b16 v[144:145], v227 offset:57344
    v_cvt_pk_bf16_f32 v184, v16, v17
    v_cvt_pk_bf16_f32 v185, v18, v19
    v_mfma_f32_16x16x32_bf16 v[72:75], v[128:131], a[228:231], v[72:75]
    ds_read_b64_tr_b16 v[146:147], v227 offset:61440
    v_cvt_pk_bf16_f32 v186, v20, v21
    v_cvt_pk_bf16_f32 v187, v22, v23
    v_mfma_f32_16x16x32_bf16 v[80:83], v[128:131], a[232:235], v[80:83]
    ds_read_b64_tr_b16 v[148:149], v228 offset:57344
    buffer_store_dwordx4 v[184:187], v220, s[12:15], s44 offen offset:2048 sc1
    v_mfma_f32_16x16x32_bf16 v[88:91], v[128:131], a[236:239], v[88:91]
    ds_read_b64_tr_b16 v[150:151], v228 offset:61440
    v_mul_f32 v168, v24, v24
    v_mul_f32 v169, v25, v25
    v_mfma_f32_16x16x32_bf16 v[68:71], v[132:135], a[224:227], v[68:71]
    ds_read_b64_tr_b16 v[152:153], v227 offset:59392
    v_mul_f32 v170, v26, v26
    v_mul_f32 v171, v27, v27
    v_mul_f32 v172, v28, v28
    v_mfma_f32_16x16x32_bf16 v[76:79], v[132:135], a[228:231], v[76:79]
    ds_read_b64_tr_b16 v[154:155], v227 offset:63488
    v_mul_f32 v173, v29, v29
    v_mul_f32 v174, v30, v30
    v_mfma_f32_16x16x32_bf16 v[84:87], v[132:135], a[232:235], v[84:87]
    ds_read_b64_tr_b16 v[156:157], v228 offset:59392
    v_mul_f32 v175, v31, v31
    v_fma_f32 v168, v168, v240, v242
    v_fma_f32 v169, v169, v240, v242
    v_mfma_f32_16x16x32_bf16 v[92:95], v[132:135], a[236:239], v[92:95]
    ds_read_b64_tr_b16 v[158:159], v228 offset:63488
    v_fma_f32 v170, v170, v240, v242
    v_fma_f32 v171, v171, v240, v242
    v_mfma_f32_16x16x32_bf16 v[96:99], v[136:139], a[224:227], v[96:99]
    v_fma_f32 v172, v172, v240, v242
    v_fma_f32 v173, v173, v240, v242
    v_mfma_f32_16x16x32_bf16 v[104:107], v[136:139], a[228:231], v[104:107]
    v_fma_f32 v174, v174, v240, v242
    v_fma_f32 v175, v175, v240, v242
    v_mul_f32 v168, v168, v24
    v_mul_f32 v169, v169, v25
    v_mfma_f32_16x16x32_bf16 v[112:115], v[136:139], a[232:235], v[112:115]
    v_mul_f32 v170, v170, v26
    v_mul_f32 v171, v171, v27
    v_mul_f32 v172, v172, v28
    v_mfma_f32_16x16x32_bf16 v[120:123], v[136:139], a[236:239], v[120:123]
    v_mul_f32 v173, v173, v29
    v_mul_f32 v174, v174, v30
    v_mul_f32 v175, v175, v31
    v_mfma_f32_16x16x32_bf16 v[100:103], v[140:143], a[224:227], v[100:103]
    v_exp_f32 v168, v168
    v_mul_f32 v24, v24, v56
    v_exp_f32 v169, v169
    v_mfma_f32_16x16x32_bf16 v[108:111], v[140:143], a[228:231], v[108:111]
    v_mul_f32 v25, v25, v57
    v_exp_f32 v170, v170
    v_mfma_f32_16x16x32_bf16 v[116:119], v[140:143], a[232:235], v[116:119]
    v_mul_f32 v26, v26, v58
    v_exp_f32 v171, v171
    v_mfma_f32_16x16x32_bf16 v[124:127], v[140:143], a[236:239], v[124:127]
    s_waitcnt lgkmcnt(0)
    v_mul_f32 v27, v27, v59
    v_exp_f32 v172, v172
    v_mul_f32 v28, v28, v60
    v_mfma_f32_16x16x32_bf16 v[64:67], v[144:147], a[240:243], v[64:67]
    v_exp_f32 v173, v173
    v_mul_f32 v29, v29, v61
    v_mfma_f32_16x16x32_bf16 v[72:75], v[144:147], a[244:247], v[72:75]
    v_exp_f32 v174, v174
    v_mul_f32 v30, v30, v62
    v_mfma_f32_16x16x32_bf16 v[80:83], v[144:147], a[248:251], v[80:83]
    v_exp_f32 v175, v175
    v_mul_f32 v31, v31, v63
    v_mfma_f32_16x16x32_bf16 v[88:91], v[144:147], a[252:255], v[88:91]
    v_add_f32 v168, 1.0, v168
    v_add_f32 v169, 1.0, v169
    v_add_f32 v170, 1.0, v170
    v_add_f32 v171, 1.0, v171
    v_mfma_f32_16x16x32_bf16 v[68:71], v[148:151], a[240:243], v[68:71]
    v_add_f32 v172, 1.0, v172
    v_add_f32 v173, 1.0, v173
    v_add_f32 v174, 1.0, v174
    v_mfma_f32_16x16x32_bf16 v[76:79], v[148:151], a[244:247], v[76:79]
    v_add_f32 v175, 1.0, v175
    v_rcp_f32 v168, v168
    v_mfma_f32_16x16x32_bf16 v[84:87], v[148:151], a[248:251], v[84:87]
    v_rcp_f32 v169, v169
    v_mfma_f32_16x16x32_bf16 v[92:95], v[148:151], a[252:255], v[92:95]
    v_rcp_f32 v170, v170
    v_rcp_f32 v171, v171
    v_mfma_f32_16x16x32_bf16 v[96:99], v[152:155], a[240:243], v[96:99]
    v_rcp_f32 v172, v172
    v_rcp_f32 v173, v173
    v_mfma_f32_16x16x32_bf16 v[104:107], v[152:155], a[244:247], v[104:107]
    v_rcp_f32 v174, v174
    v_mfma_f32_16x16x32_bf16 v[112:115], v[152:155], a[248:251], v[112:115]
    v_rcp_f32 v175, v175
    s_nop 0
    v_mfma_f32_16x16x32_bf16 v[120:123], v[152:155], a[252:255], v[120:123]
    v_mul_f32 v24, v24, v168
    v_mul_f32 v25, v25, v169
    v_mul_f32 v26, v26, v170
    v_mul_f32 v27, v27, v171
    v_mfma_f32_16x16x32_bf16 v[100:103], v[156:159], a[240:243], v[100:103]
    v_mul_f32 v28, v28, v172
    v_mul_f32 v29, v29, v173
    v_mul_f32 v30, v30, v174
    v_mfma_f32_16x16x32_bf16 v[108:111], v[156:159], a[244:247], v[108:111]
    v_mul_f32 v31, v31, v175
    v_cvt_pk_bf16_f32 v188, v24, v25
    v_mfma_f32_16x16x32_bf16 v[116:119], v[156:159], a[248:251], v[116:119]
    v_cvt_pk_bf16_f32 v189, v26, v27
    v_cvt_pk_bf16_f32 v190, v28, v29
    v_cvt_pk_bf16_f32 v191, v30, v31
    v_mfma_f32_16x16x32_bf16 v[124:127], v[156:159], a[252:255], v[124:127]
    buffer_store_dwordx4 v[188:191], v220, s[12:15], s44 offen offset:3072 sc1
    s_mov_b32 s16, s86
    s_mov_b32 s17, s87
    s_mov_b32 s18, 0x200000
    s_mov_b32 s19, 0x20000
    s_lshl_b32 s40, s38, 2
    s_and_b32 s30, s39, 3
    s_add_u32 s40, s40, s30
    s_lshr_b32 s41, s39, 2
    s_mul_i32 s42, s40, 229376
    s_mul_i32 s30, s20, 57344
    s_add_u32 s42, s42, s30
    s_add_u32 s42, s42, 0x900000
    s_lshl_b32 s43, s38, 12
    s_mul_i32 s30, s20, 896
    s_add_u32 s43, s43, s30
    s_add_u32 s43, s43, 0x30000
    v_bfe_u32 v234, v220, 4, 4
    v_lshlrev_b32 v234, 10, v234
    v_lshrrev_b32 v235, 8, v220
    v_lshl_add_u32 v234, v235, 3, v234
    v_lshlrev_b32 v235, 4, v235
    s_lshl_b32 s32, s40, 16
    s_lshl_b32 s33, s20, 14
    s_add_u32 s32, s32, s33
    s_lshl_b32 s34, s41, 10
    s_add_u32 s34, s34, s32
    s_add_u32 s34, s34, 0x500000
    s_lshl_b32 s33, s41, 7
    s_add_u32 s32, s32, s33
    s_lshl_b32 s33, s33, 1
    s_add_u32 s33, s33, 10240
    buffer_load_dwordx4 v[192:195], v235, s[12:15], s33 offen sc1
    buffer_load_dwordx4 v[196:199], v235, s[12:15], s33 offen offset:64 sc1
    buffer_load_dwordx4 v[200:203], v235, s[12:15], s33 offen offset:128 sc1
    buffer_load_dwordx4 v[204:207], v235, s[12:15], s33 offen offset:192 sc1
    v_pk_mul_f32 v[160:161], v[64:65], v[64:65]
    v_pk_mul_f32 v[162:163], v[66:67], v[66:67]
    v_pk_mul_f32 v[164:165], v[68:69], v[68:69]
    v_pk_mul_f32 v[166:167], v[70:71], v[70:71]
    v_pk_fma_f32 v[160:161], v[160:161], v[240:241], v[242:243]
    v_pk_fma_f32 v[162:163], v[162:163], v[240:241], v[242:243]
    v_pk_fma_f32 v[164:165], v[164:165], v[240:241], v[242:243]
    v_pk_fma_f32 v[166:167], v[166:167], v[240:241], v[242:243]
    v_pk_mul_f32 v[160:161], v[160:161], v[64:65]
    v_pk_mul_f32 v[162:163], v[162:163], v[66:67]
    v_pk_mul_f32 v[164:165], v[164:165], v[68:69]
    v_pk_mul_f32 v[166:167], v[166:167], v[70:71]
    v_exp_f32 v160, v160
    v_exp_f32 v161, v161
    v_exp_f32 v162, v162
    v_exp_f32 v163, v163
    v_exp_f32 v164, v164
    v_exp_f32 v165, v165
    v_exp_f32 v166, v166
    v_exp_f32 v167, v167
    v_pk_mul_f32 v[64:65], v[64:65], v[96:97]
    v_pk_mul_f32 v[66:67], v[66:67], v[98:99]
    v_pk_mul_f32 v[68:69], v[68:69], v[100:101]
    v_pk_mul_f32 v[70:71], v[70:71], v[102:103]
    v_pk_add_f32 v[160:161], v[160:161], 1.0 op_sel_hi:[1,0]
    v_pk_add_f32 v[162:163], v[162:163], 1.0 op_sel_hi:[1,0]
    v_pk_add_f32 v[164:165], v[164:165], 1.0 op_sel_hi:[1,0]
    v_pk_add_f32 v[166:167], v[166:167], 1.0 op_sel_hi:[1,0]
    v_rcp_f32 v160, v160
    v_rcp_f32 v161, v161
    v_rcp_f32 v162, v162
    v_rcp_f32 v163, v163
    v_rcp_f32 v164, v164
    v_rcp_f32 v165, v165
    v_rcp_f32 v166, v166
    v_rcp_f32 v167, v167
    s_nop 0
    v_pk_mul_f32 v[64:65], v[64:65], v[160:161]
    v_pk_mul_f32 v[66:67], v[66:67], v[162:163]
    v_pk_mul_f32 v[68:69], v[68:69], v[164:165]
    v_pk_mul_f32 v[70:71], v[70:71], v[166:167]
    v_cvt_pk_bf16_f32 v176, v64, v65
    v_cvt_pk_bf16_f32 v177, v66, v67
    v_cvt_pk_bf16_f32 v178, v68, v69
    v_cvt_pk_bf16_f32 v179, v70, v71
    buffer_store_dwordx4 v[176:179], v220, s[12:15], s45 offen offset:0 sc1
    v_pk_mul_f32 v[168:169], v[72:73], v[72:73]
    v_pk_mul_f32 v[170:171], v[74:75], v[74:75]
    v_pk_mul_f32 v[172:173], v[76:77], v[76:77]
    v_pk_mul_f32 v[174:175], v[78:79], v[78:79]
    v_pk_fma_f32 v[168:169], v[168:169], v[240:241], v[242:243]
    v_pk_fma_f32 v[170:171], v[170:171], v[240:241], v[242:243]
    v_pk_fma_f32 v[172:173], v[172:173], v[240:241], v[242:243]
    v_pk_fma_f32 v[174:175], v[174:175], v[240:241], v[242:243]
    v_pk_mul_f32 v[168:169], v[168:169], v[72:73]
    v_pk_mul_f32 v[170:171], v[170:171], v[74:75]
    v_pk_mul_f32 v[172:173], v[172:173], v[76:77]
    v_pk_mul_f32 v[174:175], v[174:175], v[78:79]
    v_exp_f32 v168, v168
    v_exp_f32 v169, v169
    v_exp_f32 v170, v170
    v_exp_f32 v171, v171
    v_exp_f32 v172, v172
    v_exp_f32 v173, v173
    v_exp_f32 v174, v174
    v_exp_f32 v175, v175
    v_pk_mul_f32 v[72:73], v[72:73], v[104:105]
    v_pk_mul_f32 v[74:75], v[74:75], v[106:107]
    v_pk_mul_f32 v[76:77], v[76:77], v[108:109]
    v_pk_mul_f32 v[78:79], v[78:79], v[110:111]
    v_pk_add_f32 v[168:169], v[168:169], 1.0 op_sel_hi:[1,0]
    v_pk_add_f32 v[170:171], v[170:171], 1.0 op_sel_hi:[1,0]
    v_pk_add_f32 v[172:173], v[172:173], 1.0 op_sel_hi:[1,0]
    v_pk_add_f32 v[174:175], v[174:175], 1.0 op_sel_hi:[1,0]
    v_rcp_f32 v168, v168
    v_rcp_f32 v169, v169
    v_rcp_f32 v170, v170
    v_rcp_f32 v171, v171
    v_rcp_f32 v172, v172
    v_rcp_f32 v173, v173
    v_rcp_f32 v174, v174
    v_rcp_f32 v175, v175
    s_nop 0
    v_pk_mul_f32 v[72:73], v[72:73], v[168:169]
    v_pk_mul_f32 v[74:75], v[74:75], v[170:171]
    v_pk_mul_f32 v[76:77], v[76:77], v[172:173]
    v_pk_mul_f32 v[78:79], v[78:79], v[174:175]
    v_cvt_pk_bf16_f32 v180, v72, v73
    v_cvt_pk_bf16_f32 v181, v74, v75
    v_cvt_pk_bf16_f32 v182, v76, v77
    v_cvt_pk_bf16_f32 v183, v78, v79
    buffer_store_dwordx4 v[180:183], v220, s[12:15], s45 offen offset:1024 sc1
    v_pk_mul_f32 v[160:161], v[80:81], v[80:81]
    v_pk_mul_f32 v[162:163], v[82:83], v[82:83]
    v_pk_mul_f32 v[164:165], v[84:85], v[84:85]
    v_pk_mul_f32 v[166:167], v[86:87], v[86:87]
    v_pk_fma_f32 v[160:161], v[160:161], v[240:241], v[242:243]
    v_pk_fma_f32 v[162:163], v[162:163], v[240:241], v[242:243]
    v_pk_fma_f32 v[164:165], v[164:165], v[240:241], v[242:243]
    v_pk_fma_f32 v[166:167], v[166:167], v[240:241], v[242:243]
    v_pk_mul_f32 v[160:161], v[160:161], v[80:81]
    v_pk_mul_f32 v[162:163], v[162:163], v[82:83]
    v_pk_mul_f32 v[164:165], v[164:165], v[84:85]
    v_pk_mul_f32 v[166:167], v[166:167], v[86:87]
    v_exp_f32 v160, v160
    v_exp_f32 v161, v161
    v_exp_f32 v162, v162
    v_exp_f32 v163, v163
    v_exp_f32 v164, v164
    v_exp_f32 v165, v165
    v_exp_f32 v166, v166
    v_exp_f32 v167, v167
    v_pk_mul_f32 v[80:81], v[80:81], v[112:113]
    v_pk_mul_f32 v[82:83], v[82:83], v[114:115]
    v_pk_mul_f32 v[84:85], v[84:85], v[116:117]
    v_pk_mul_f32 v[86:87], v[86:87], v[118:119]
    v_pk_add_f32 v[160:161], v[160:161], 1.0 op_sel_hi:[1,0]
    v_pk_add_f32 v[162:163], v[162:163], 1.0 op_sel_hi:[1,0]
    v_pk_add_f32 v[164:165], v[164:165], 1.0 op_sel_hi:[1,0]
    v_pk_add_f32 v[166:167], v[166:167], 1.0 op_sel_hi:[1,0]
    v_rcp_f32 v160, v160
    v_rcp_f32 v161, v161
    v_rcp_f32 v162, v162
    v_rcp_f32 v163, v163
    v_rcp_f32 v164, v164
    v_rcp_f32 v165, v165
    v_rcp_f32 v166, v166
    v_rcp_f32 v167, v167
    s_nop 0
    v_pk_mul_f32 v[80:81], v[80:81], v[160:161]
    v_pk_mul_f32 v[82:83], v[82:83], v[162:163]
    v_pk_mul_f32 v[84:85], v[84:85], v[164:165]
    v_pk_mul_f32 v[86:87], v[86:87], v[166:167]
    v_cvt_pk_bf16_f32 v184, v80, v81
    v_cvt_pk_bf16_f32 v185, v82, v83
    v_cvt_pk_bf16_f32 v186, v84, v85
    v_cvt_pk_bf16_f32 v187, v86, v87
    buffer_store_dwordx4 v[184:187], v220, s[12:15], s45 offen offset:2048 sc1
    v_pk_mul_f32 v[168:169], v[88:89], v[88:89]
    v_pk_mul_f32 v[170:171], v[90:91], v[90:91]
    v_pk_mul_f32 v[172:173], v[92:93], v[92:93]
    v_pk_mul_f32 v[174:175], v[94:95], v[94:95]
    v_pk_fma_f32 v[168:169], v[168:169], v[240:241], v[242:243]
    v_pk_fma_f32 v[170:171], v[170:171], v[240:241], v[242:243]
    v_pk_fma_f32 v[172:173], v[172:173], v[240:241], v[242:243]
    v_pk_fma_f32 v[174:175], v[174:175], v[240:241], v[242:243]
    v_pk_mul_f32 v[168:169], v[168:169], v[88:89]
    v_pk_mul_f32 v[170:171], v[170:171], v[90:91]
    v_pk_mul_f32 v[172:173], v[172:173], v[92:93]
    v_pk_mul_f32 v[174:175], v[174:175], v[94:95]
    v_exp_f32 v168, v168
    v_exp_f32 v169, v169
    v_exp_f32 v170, v170
    v_exp_f32 v171, v171
    v_exp_f32 v172, v172
    v_exp_f32 v173, v173
    v_exp_f32 v174, v174
    v_exp_f32 v175, v175
    v_pk_mul_f32 v[88:89], v[88:89], v[120:121]
    v_pk_mul_f32 v[90:91], v[90:91], v[122:123]
    v_pk_mul_f32 v[92:93], v[92:93], v[124:125]
    v_pk_mul_f32 v[94:95], v[94:95], v[126:127]
    v_pk_add_f32 v[168:169], v[168:169], 1.0 op_sel_hi:[1,0]
    v_pk_add_f32 v[170:171], v[170:171], 1.0 op_sel_hi:[1,0]
    v_pk_add_f32 v[172:173], v[172:173], 1.0 op_sel_hi:[1,0]
    v_pk_add_f32 v[174:175], v[174:175], 1.0 op_sel_hi:[1,0]
    v_rcp_f32 v168, v168
    v_rcp_f32 v169, v169
    v_rcp_f32 v170, v170
    v_rcp_f32 v171, v171
    v_rcp_f32 v172, v172
    v_rcp_f32 v173, v173
    v_rcp_f32 v174, v174
    v_rcp_f32 v175, v175
    s_nop 0
    v_pk_mul_f32 v[88:89], v[88:89], v[168:169]
    v_pk_mul_f32 v[90:91], v[90:91], v[170:171]
    v_pk_mul_f32 v[92:93], v[92:93], v[172:173]
    v_pk_mul_f32 v[94:95], v[94:95], v[174:175]
    v_cvt_pk_bf16_f32 v188, v88, v89
    v_cvt_pk_bf16_f32 v189, v90, v91
    v_cvt_pk_bf16_f32 v190, v92, v93
    v_cvt_pk_bf16_f32 v191, v94, v95
    buffer_store_dwordx4 v[188:191], v220, s[12:15], s45 offen offset:3072 sc1
    s_lshl_b32 s46, s54, 12
    s_lshl_b32 s47, s55, 7
    s_add_u32 s46, s46, s47
    s_add_u32 s46, s46, 0x30000
    s_waitcnt vmcnt(0) lgkmcnt(0)
    s_barrier
    s_cmp_lg_u32 s20, 0
    s_cbranch_scc1 KD_PUB
    v_mov_b32 v245, 0
    v_mov_b32 v246, s4
    v_mov_b32 v247, s5
    s_mov_b64 exec, 1
    buffer_store_dwordx2 v[246:247], v245, s[12:15], s46 offen sc1
    s_mov_b64 exec, -1
KD_PUB:
    s_branch KD_DONE
KD_SKIP:
    s_cmp_lg_u32 s2, 255
    s_cbranch_scc1 KD_NOEP
    s_lshl_b32 s44, s20, 9
    s_add_u32 s44, s44, 0x38000
    v_lshrrev_b32 v245, 1, v220
    v_min_u32 v245, 504, v245
    s_mov_b32 s47, 32768
KEP_POLL:
    buffer_load_dwordx2 v[246:247], v245, s[12:15], s44 offen sc1
    s_sub_u32 s47, s47, 1
    s_waitcnt vmcnt(0)
    v_cmp_ne_u64 vcc, s[4:5], v[246:247]
    s_cbranch_vccz KEP_GO
    s_cmp_eq_u32 s47, 0
    s_cbranch_scc1 KEP_GO
    s_branch KEP_POLL
KEP_GO:
    s_barrier
    s_mov_b32 s44, 0x3c000
    s_cmp_lg_u32 s20, 0
    s_cbranch_scc1 KEP_PUB
    v_mov_b32 v245, 0
    v_mov_b32 v246, s4
    v_mov_b32 v247, s5
    s_mov_b64 exec, 1
    buffer_store_dwordx2 v[246:247], v245, s[12:15], s44 offen sc1
    s_mov_b64 exec, -1
KEP_PUB:
KD_NOEP:
    s_add_u32 m0, s61, 131072
    s_nop 0
    buffer_load_dwordx4 v248, s[56:59], s60 offen offset:0 lds
    buffer_load_dwordx4 v249, s[56:59], s60 offen offset:1024 lds
    buffer_load_dwordx4 v250, s[56:59], s60 offen offset:2048 lds
    buffer_load_dwordx4 v251, s[56:59], s60 offen offset:3072 lds
    s_add_u32 s60, s60, 32768
    s_add_u32 m0, s61, 135168
    s_nop 0
    buffer_load_dwordx4 v248, s[56:59], s60 offen offset:0 lds
    buffer_load_dwordx4 v249, s[56:59], s60 offen offset:1024 lds
    buffer_load_dwordx4 v250, s[56:59], s60 offen offset:2048 lds
    buffer_load_dwordx4 v251, s[56:59], s60 offen offset:3072 lds
    s_add_u32 s60, s60, 32768
    s_add_u32 m0, s62, 0
    s_nop 0
    buffer_load_dwordx4 v248, s[56:59], s60 offen offset:0 lds
    buffer_load_dwordx4 v249, s[56:59], s60 offen offset:1024 lds
    buffer_load_dwordx4 v250, s[56:59], s60 offen offset:2048 lds
    buffer_load_dwordx4 v251, s[56:59], s60 offen offset:3072 lds
    s_add_u32 s60, s60, 32768
    s_add_u32 m0, s62, 4096
    s_nop 0
    buffer_load_dwordx4 v248, s[56:59], s60 offen offset:0 lds
    buffer_load_dwordx4 v249, s[56:59], s60 offen offset:1024 lds
    buffer_load_dwordx4 v250, s[56:59], s60 offen offset:2048 lds
    buffer_load_dwordx4 v251, s[56:59], s60 offen offset:3072 lds
    s_add_u32 s60, s60, 32768
    s_add_u32 m0, s62, 8192
    s_nop 0
    buffer_load_dwordx4 v248, s[56:59], s60 offen offset:0 lds
    buffer_load_dwordx4 v249, s[56:59], s60 offen offset:1024 lds
    buffer_load_dwordx4 v250, s[56:59], s60 offen offset:2048 lds
    buffer_load_dwordx4 v251, s[56:59], s60 offen offset:3072 lds
    s_add_u32 s60, s60, 32768
    s_add_u32 m0, s62, 12288
    s_nop 0
    buffer_load_dwordx4 v248, s[56:59], s60 offen offset:0 lds
    buffer_load_dwordx4 v249, s[56:59], s60 offen offset:1024 lds
    buffer_load_dwordx4 v250, s[56:59], s60 offen offset:2048 lds
    buffer_load_dwordx4 v251, s[56:59], s60 offen offset:3072 lds
    s_add_u32 s60, s60, 32768
    s_waitcnt vmcnt(0)
    ds_read_b64_tr_b16 a[0:1], v208 offset:0
    ds_read_b64_tr_b16 a[2:3], v208 offset:2048
    ds_read_b64_tr_b16 a[4:5], v209 offset:0
    ds_read_b64_tr_b16 a[6:7], v209 offset:2048
    ds_read_b64_tr_b16 a[8:9], v210 offset:0
    ds_read_b64_tr_b16 a[10:11], v210 offset:2048
    ds_read_b64_tr_b16 a[12:13], v211 offset:0
    ds_read_b64_tr_b16 a[14:15], v211 offset:2048
    ds_read_b64_tr_b16 a[16:17], v208 offset:4096
    ds_read_b64_tr_b16 a[18:19], v208 offset:6144
    ds_read_b64_tr_b16 a[20:21], v209 offset:4096
    ds_read_b64_tr_b16 a[22:23], v209 offset:6144
    ds_read_b64_tr_b16 a[24:25], v210 offset:4096
    ds_read_b64_tr_b16 a[26:27], v210 offset:6144
    ds_read_b64_tr_b16 a[28:29], v211 offset:4096
    ds_read_b64_tr_b16 a[30:31], v211 offset:6144
    ds_read_b64_tr_b16 a[32:33], v212 offset:0
    ds_read_b64_tr_b16 a[34:35], v212 offset:2048
    ds_read_b64_tr_b16 a[36:37], v213 offset:0
    ds_read_b64_tr_b16 a[38:39], v213 offset:2048
    ds_read_b64_tr_b16 a[40:41], v214 offset:0
    ds_read_b64_tr_b16 a[42:43], v214 offset:2048
    ds_read_b64_tr_b16 a[44:45], v215 offset:0
    ds_read_b64_tr_b16 a[46:47], v215 offset:2048
    ds_read_b64_tr_b16 a[48:49], v212 offset:4096
    ds_read_b64_tr_b16 a[50:51], v212 offset:6144
    ds_read_b64_tr_b16 a[52:53], v213 offset:4096
    ds_read_b64_tr_b16 a[54:55], v213 offset:6144
    ds_read_b64_tr_b16 a[56:57], v214 offset:4096
    ds_read_b64_tr_b16 a[58:59], v214 offset:6144
    ds_read_b64_tr_b16 a[60:61], v215 offset:4096
    ds_read_b64_tr_b16 a[62:63], v215 offset:6144
    ds_read_b64_tr_b16 a[64:65], v212 offset:8192
    ds_read_b64_tr_b16 a[66:67], v212 offset:10240
    ds_read_b64_tr_b16 a[68:69], v213 offset:8192
    ds_read_b64_tr_b16 a[70:71], v213 offset:10240
    ds_read_b64_tr_b16 a[72:73], v214 offset:8192
    ds_read_b64_tr_b16 a[74:75], v214 offset:10240
    ds_read_b64_tr_b16 a[76:77], v215 offset:8192
    ds_read_b64_tr_b16 a[78:79], v215 offset:10240
    ds_read_b64_tr_b16 a[80:81], v212 offset:12288
    ds_read_b64_tr_b16 a[82:83], v212 offset:14336
    ds_read_b64_tr_b16 a[84:85], v213 offset:12288
    ds_read_b64_tr_b16 a[86:87], v213 offset:14336
    ds_read_b64_tr_b16 a[88:89], v214 offset:12288
    ds_read_b64_tr_b16 a[90:91], v214 offset:14336
    ds_read_b64_tr_b16 a[92:93], v215 offset:12288
    ds_read_b64_tr_b16 a[94:95], v215 offset:14336
    s_waitcnt lgkmcnt(0)
    s_add_u32 m0, s61, 131072
    s_nop 0
    buffer_load_dwordx4 v248, s[56:59], s60 offen offset:0 lds
    buffer_load_dwordx4 v249, s[56:59], s60 offen offset:1024 lds
    buffer_load_dwordx4 v250, s[56:59], s60 offen offset:2048 lds
    buffer_load_dwordx4 v251, s[56:59], s60 offen offset:3072 lds
    s_add_u32 s60, s60, 32768
    s_add_u32 m0, s61, 135168
    s_nop 0
    buffer_load_dwordx4 v248, s[56:59], s60 offen offset:0 lds
    buffer_load_dwordx4 v249, s[56:59], s60 offen offset:1024 lds
    buffer_load_dwordx4 v250, s[56:59], s60 offen offset:2048 lds
    buffer_load_dwordx4 v251, s[56:59], s60 offen offset:3072 lds
    s_add_u32 s60, s60, 32768
    s_add_u32 m0, s62, 0
    s_nop 0
    buffer_load_dwordx4 v248, s[56:59], s60 offen offset:0 lds
    buffer_load_dwordx4 v249, s[56:59], s60 offen offset:1024 lds
    buffer_load_dwordx4 v250, s[56:59], s60 offen offset:2048 lds
    buffer_load_dwordx4 v251, s[56:59], s60 offen offset:3072 lds
    s_add_u32 s60, s60, 32768
    s_add_u32 m0, s62, 4096
    s_nop 0
    buffer_load_dwordx4 v248, s[56:59], s60 offen offset:0 lds
    buffer_load_dwordx4 v249, s[56:59], s60 offen offset:1024 lds
    buffer_load_dwordx4 v250, s[56:59], s60 offen offset:2048 lds
    buffer_load_dwordx4 v251, s[56:59], s60 offen offset:3072 lds
    s_add_u32 s60, s60, 32768
    s_add_u32 m0, s62, 8192
    s_nop 0
    buffer_load_dwordx4 v248, s[56:59], s60 offen offset:0 lds
    buffer_load_dwordx4 v249, s[56:59], s60 offen offset:1024 lds
    buffer_load_dwordx4 v250, s[56:59], s60 offen offset:2048 lds
    buffer_load_dwordx4 v251, s[56:59], s60 offen offset:3072 lds
    s_add_u32 s60, s60, 32768
    s_add_u32 m0, s62, 12288
    s_nop 0
    buffer_load_dwordx4 v248, s[56:59], s60 offen offset:0 lds
    buffer_load_dwordx4 v249, s[56:59], s60 offen offset:1024 lds
    buffer_load_dwordx4 v250, s[56:59], s60 offen offset:2048 lds
    buffer_load_dwordx4 v251, s[56:59], s60 offen offset:3072 lds
    s_add_u32 s60, s60, 32768
    s_waitcnt vmcnt(16)
    ds_read_b64_tr_b16 a[96:97], v208 offset:0
    ds_read_b64_tr_b16 a[98:99], v208 offset:2048
    ds_read_b64_tr_b16 a[100:101], v209 offset:0
    ds_read_b64_tr_b16 a[102:103], v209 offset:2048
    ds_read_b64_tr_b16 a[104:105], v210 offset:0
    ds_read_b64_tr_b16 a[106:107], v210 offset:2048
    ds_read_b64_tr_b16 a[108:109], v211 offset:0
    ds_read_b64_tr_b16 a[110:111], v211 offset:2048
    ds_read_b64_tr_b16 a[112:113], v208 offset:4096
    ds_read_b64_tr_b16 a[114:115], v208 offset:6144
    ds_read_b64_tr_b16 a[116:117], v209 offset:4096
    ds_read_b64_tr_b16 a[118:119], v209 offset:6144
    ds_read_b64_tr_b16 a[120:121], v210 offset:4096
    ds_read_b64_tr_b16 a[122:123], v210 offset:6144
    ds_read_b64_tr_b16 a[124:125], v211 offset:4096
    ds_read_b64_tr_b16 a[126:127], v211 offset:6144
    s_waitcnt lgkmcnt(0)
    s_add_u32 m0, s61, 131072
    s_nop 0
    buffer_load_dwordx4 v248, s[56:59], s60 offen offset:0 lds
    buffer_load_dwordx4 v249, s[56:59], s60 offen offset:1024 lds
    buffer_load_dwordx4 v250, s[56:59], s60 offen offset:2048 lds
    buffer_load_dwordx4 v251, s[56:59], s60 offen offset:3072 lds
    s_add_u32 s60, s60, 32768
    s_add_u32 m0, s61, 135168
    s_nop 0
    buffer_load_dwordx4 v248, s[56:59], s60 offen offset:0 lds
    buffer_load_dwordx4 v249, s[56:59], s60 offen offset:1024 lds
    buffer_load_dwordx4 v250, s[56:59], s60 offen offset:2048 lds
    buffer_load_dwordx4 v251, s[56:59], s60 offen offset:3072 lds
    s_add_u32 s60, s60, 32768
    s_mov_b32 s16, s86
    s_mov_b32 s17, s87
    s_mov_b32 s18, 0x200000
    s_mov_b32 s19, 0x20000
    s_lshl_b32 s40, s38, 2
    s_and_b32 s30, s39, 3
    s_add_u32 s40, s40, s30
    s_lshr_b32 s41, s39, 2
    s_mul_i32 s42, s40, 229376
    s_mul_i32 s30, s20, 57344
    s_add_u32 s42, s42, s30
    s_add_u32 s42, s42, 0x900000
    s_lshl_b32 s43, s38, 12
    s_mul_i32 s30, s20, 896
    s_add_u32 s43, s43, s30
    s_add_u32 s43, s43, 0x30000
    v_bfe_u32 v234, v220, 4, 4
    v_lshlrev_b32 v234, 10, v234
    v_lshrrev_b32 v235, 8, v220
    v_lshl_add_u32 v234, v235, 3, v234
    v_lshlrev_b32 v235, 4, v235
    s_lshl_b32 s32, s40, 16
    s_lshl_b32 s33, s20, 14
    s_add_u32 s32, s32, s33
    s_lshl_b32 s34, s41, 10
    s_add_u32 s34, s34, s32
    s_add_u32 s34, s34, 0x500000
    s_lshl_b32 s33, s41, 7
    s_add_u32 s32, s32, s33
    s_lshl_b32 s33, s33, 1
    s_add_u32 s33, s33, 10240
    buffer_load_dwordx4 v[192:195], v235, s[12:15], s33 offen sc1
    buffer_load_dwordx4 v[196:199], v235, s[12:15], s33 offen offset:64 sc1
    buffer_load_dwordx4 v[200:203], v235, s[12:15], s33 offen offset:128 sc1
    buffer_load_dwordx4 v[204:207], v235, s[12:15], s33 offen offset:192 sc1
KD_DONE:
    v_lshlrev_b32 v245, 3, v220
    v_min_u32 v245, 768, v245
    s_mov_b32 s47, 32768
KE_POLL:
    buffer_load_dwordx2 v[246:247], v245, s[12:15], s43 offen sc1
    s_sub_u32 s47, s47, 1
    s_waitcnt vmcnt(0)
    v_cmp_ne_u64 vcc, s[4:5], v[246:247]
    s_cbranch_vccz KE_GO
    s_cmp_eq_u32 s47, 0
    s_cbranch_scc1 KE_GO
    s_branch KE_POLL
KE_GO:
    buffer_load_dwordx4 a[128:131], v220, s[12:15], s42 offen offset:0 sc1
    buffer_load_dwordx4 a[132:135], v220, s[12:15], s42 offen offset:1024 sc1
    buffer_load_dwordx4 a[136:139], v220, s[12:15], s42 offen offset:2048 sc1
    buffer_load_dwordx4 a[140:143], v220, s[12:15], s42 offen offset:3072 sc1
    s_add_u32 s42, s42, 4096
    buffer_load_dwordx4 a[144:147], v220, s[12:15], s42 offen offset:0 sc1
    buffer_load_dwordx4 a[148:151], v220, s[12:15], s42 offen offset:1024 sc1
    buffer_load_dwordx4 a[152:155], v220, s[12:15], s42 offen offset:2048 sc1
    buffer_load_dwordx4 a[156:159], v220, s[12:15], s42 offen offset:3072 sc1
    s_add_u32 s42, s42, 4096
    buffer_load_dwordx4 a[160:163], v220, s[12:15], s42 offen offset:0 sc1
    buffer_load_dwordx4 a[164:167], v220, s[12:15], s42 offen offset:1024 sc1
    buffer_load_dwordx4 a[168:171], v220, s[12:15], s42 offen offset:2048 sc1
    buffer_load_dwordx4 a[172:175], v220, s[12:15], s42 offen offset:3072 sc1
    s_add_u32 s42, s42, 4096
    buffer_load_dwordx4 a[176:179], v220, s[12:15], s42 offen offset:0 sc1
    buffer_load_dwordx4 a[180:183], v220, s[12:15], s42 offen offset:1024 sc1
    buffer_load_dwordx4 a[184:187], v220, s[12:15], s42 offen offset:2048 sc1
    buffer_load_dwordx4 a[188:191], v220, s[12:15], s42 offen offset:3072 sc1
    s_add_u32 s42, s42, 4096
    buffer_load_dwordx4 a[192:195], v220, s[12:15], s42 offen offset:0 sc1
    buffer_load_dwordx4 a[196:199], v220, s[12:15], s42 offen offset:1024 sc1
    buffer_load_dwordx4 a[200:203], v220, s[12:15], s42 offen offset:2048 sc1
    buffer_load_dwordx4 a[204:207], v220, s[12:15], s42 offen offset:3072 sc1
    s_add_u32 s42, s42, 4096
    buffer_load_dwordx4 a[208:211], v220, s[12:15], s42 offen offset:0 sc1
    buffer_load_dwordx4 a[212:215], v220, s[12:15], s42 offen offset:1024 sc1
    buffer_load_dwordx4 a[216:219], v220, s[12:15], s42 offen offset:2048 sc1
    buffer_load_dwordx4 a[220:223], v220, s[12:15], s42 offen offset:3072 sc1
    s_add_u32 s42, s42, 4096
    ds_read_b64_tr_b16 v[128:129], v212 offset:0
    ds_read_b64_tr_b16 v[130:131], v212 offset:2048
    ds_read_b64_tr_b16 v[132:133], v213 offset:0
    ds_read_b64_tr_b16 v[134:135], v213 offset:2048
    ds_read_b64_tr_b16 v[136:137], v214 offset:0
    ds_read_b64_tr_b16 v[138:139], v214 offset:2048
    ds_read_b64_tr_b16 v[140:141], v215 offset:0
    ds_read_b64_tr_b16 v[142:143], v215 offset:2048
    ds_read_b64_tr_b16 v[144:145], v212 offset:4096
    ds_read_b64_tr_b16 v[146:147], v212 offset:6144
    ds_read_b64_tr_b16 v[148:149], v213 offset:4096
    ds_read_b64_tr_b16 v[150:151], v213 offset:6144
    ds_read_b64_tr_b16 v[152:153], v214 offset:4096
    ds_read_b64_tr_b16 v[154:155], v214 offset:6144
    ds_read_b64_tr_b16 v[156:157], v215 offset:4096
    ds_read_b64_tr_b16 v[158:159], v215 offset:6144
    s_waitcnt vmcnt(22)
    v_mfma_f32_16x16x32_bf16 v[0:3], a[0:3], a[128:131], 0
    v_mfma_f32_16x16x32_bf16 v[4:7], a[4:7], a[128:131], 0
    buffer_load_dwordx4 a[224:227], v220, s[12:15], s42 offen offset:0 sc1
    v_mfma_f32_16x16x32_bf16 v[32:35], a[8:11], a[128:131], 0
    v_mfma_f32_16x16x32_bf16 v[36:39], a[12:15], a[128:131], 0
    buffer_load_dwordx4 a[228:231], v220, s[12:15], s42 offen offset:1024 sc1
    v_mfma_f32_16x16x32_bf16 v[8:11], a[0:3], a[132:135], 0
    v_mfma_f32_16x16x32_bf16 v[12:15], a[4:7], a[132:135], 0
    buffer_load_dwordx4 a[232:235], v220, s[12:15], s42 offen offset:2048 sc1
    v_mfma_f32_16x16x32_bf16 v[40:43], a[8:11], a[132:135], 0
    v_mfma_f32_16x16x32_bf16 v[44:47], a[12:15], a[132:135], 0
    buffer_load_dwordx4 a[236:239], v220, s[12:15], s42 offen offset:3072 sc1
    s_add_u32 s42, s42, 4096
    s_waitcnt vmcnt(24)
    v_mfma_f32_16x16x32_bf16 v[16:19], a[0:3], a[136:139], 0
    v_mfma_f32_16x16x32_bf16 v[20:23], a[4:7], a[136:139], 0
    v_mfma_f32_16x16x32_bf16 v[48:51], a[8:11], a[136:139], 0
    v_mfma_f32_16x16x32_bf16 v[52:55], a[12:15], a[136:139], 0
    v_mfma_f32_16x16x32_bf16 v[24:27], a[0:3], a[140:143], 0
    v_mfma_f32_16x16x32_bf16 v[28:31], a[4:7], a[140:143], 0
    v_mfma_f32_16x16x32_bf16 v[56:59], a[8:11], a[140:143], 0
    v_mfma_f32_16x16x32_bf16 v[60:63], a[12:15], a[140:143], 0
    s_waitcnt vmcnt(22)
    v_mfma_f32_16x16x32_bf16 v[0:3], a[16:19], a[144:147], v[0:3]
    v_mfma_f32_16x16x32_bf16 v[4:7], a[20:23], a[144:147], v[4:7]
    buffer_load_dwordx4 a[240:243], v220, s[12:15], s42 offen offset:0 sc1
    v_mfma_f32_16x16x32_bf16 v[32:35], a[24:27], a[144:147], v[32:35]
    v_mfma_f32_16x16x32_bf16 v[36:39], a[28:31], a[144:147], v[36:39]
    buffer_load_dwordx4 a[244:247], v220, s[12:15], s42 offen offset:1024 sc1
    v_mfma_f32_16x16x32_bf16 v[8:11], a[16:19], a[148:151], v[8:11]
    v_mfma_f32_16x16x32_bf16 v[12:15], a[20:23], a[148:151], v[12:15]
    buffer_load_dwordx4 a[248:251], v220, s[12:15], s42 offen offset:2048 sc1
    v_mfma_f32_16x16x32_bf16 v[40:43], a[24:27], a[148:151], v[40:43]
    v_mfma_f32_16x16x32_bf16 v[44:47], a[28:31], a[148:151], v[44:47]
    buffer_load_dwordx4 a[252:255], v220, s[12:15], s42 offen offset:3072 sc1
    s_add_u32 s42, s42, 4096
    s_waitcnt vmcnt(24)
    v_mfma_f32_16x16x32_bf16 v[16:19], a[16:19], a[152:155], v[16:19]
    v_mfma_f32_16x16x32_bf16 v[20:23], a[20:23], a[152:155], v[20:23]
    v_mfma_f32_16x16x32_bf16 v[48:51], a[24:27], a[152:155], v[48:51]
    v_mfma_f32_16x16x32_bf16 v[52:55], a[28:31], a[152:155], v[52:55]
    v_mfma_f32_16x16x32_bf16 v[24:27], a[16:19], a[156:159], v[24:27]
    v_mfma_f32_16x16x32_bf16 v[28:31], a[20:23], a[156:159], v[28:31]
    v_mfma_f32_16x16x32_bf16 v[56:59], a[24:27], a[156:159], v[56:59]
    v_mfma_f32_16x16x32_bf16 v[60:63], a[28:31], a[156:159], v[60:63]
    s_waitcnt vmcnt(22)
    v_mfma_f32_16x16x32_bf16 v[0:3], a[32:35], a[160:163], v[0:3]
    v_mfma_f32_16x16x32_bf16 v[4:7], a[36:39], a[160:163], v[4:7]
    buffer_load_dwordx4 v[64:67], v220, s[12:15], s42 offen offset:0 sc1
    v_mfma_f32_16x16x32_bf16 v[32:35], a[40:43], a[160:163], v[32:35]
    v_mfma_f32_16x16x32_bf16 v[36:39], a[44:47], a[160:163], v[36:39]
    buffer_load_dwordx4 v[68:71], v220, s[12:15], s42 offen offset:1024 sc1
    v_mfma_f32_16x16x32_bf16 v[8:11], a[32:35], a[164:167], v[8:11]
    v_mfma_f32_16x16x32_bf16 v[12:15], a[36:39], a[164:167], v[12:15]
    buffer_load_dwordx4 v[72:75], v220, s[12:15], s42 offen offset:2048 sc1
    v_mfma_f32_16x16x32_bf16 v[40:43], a[40:43], a[164:167], v[40:43]
    v_mfma_f32_16x16x32_bf16 v[44:47], a[44:47], a[164:167], v[44:47]
    buffer_load_dwordx4 v[76:79], v220, s[12:15], s42 offen offset:3072 sc1
    s_add_u32 s42, s42, 4096
    s_waitcnt vmcnt(24)
    v_mfma_f32_16x16x32_bf16 v[16:19], a[32:35], a[168:171], v[16:19]
    v_mfma_f32_16x16x32_bf16 v[20:23], a[36:39], a[168:171], v[20:23]
    v_mfma_f32_16x16x32_bf16 v[48:51], a[40:43], a[168:171], v[48:51]
    v_mfma_f32_16x16x32_bf16 v[52:55], a[44:47], a[168:171], v[52:55]
    v_mfma_f32_16x16x32_bf16 v[24:27], a[32:35], a[172:175], v[24:27]
    v_mfma_f32_16x16x32_bf16 v[28:31], a[36:39], a[172:175], v[28:31]
    v_mfma_f32_16x16x32_bf16 v[56:59], a[40:43], a[172:175], v[56:59]
    v_mfma_f32_16x16x32_bf16 v[60:63], a[44:47], a[172:175], v[60:63]
    s_waitcnt vmcnt(22)
    v_mfma_f32_16x16x32_bf16 v[0:3], a[48:51], a[176:179], v[0:3]
    v_mfma_f32_16x16x32_bf16 v[4:7], a[52:55], a[176:179], v[4:7]
    buffer_load_dwordx4 v[80:83], v220, s[12:15], s42 offen offset:0 sc1
    v_mfma_f32_16x16x32_bf16 v[32:35], a[56:59], a[176:179], v[32:35]
    v_mfma_f32_16x16x32_bf16 v[36:39], a[60:63], a[176:179], v[36:39]
    buffer_load_dwordx4 v[84:87], v220, s[12:15], s42 offen offset:1024 sc1
    v_mfma_f32_16x16x32_bf16 v[8:11], a[48:51], a[180:183], v[8:11]
    v_mfma_f32_16x16x32_bf16 v[12:15], a[52:55], a[180:183], v[12:15]
    buffer_load_dwordx4 v[88:91], v220, s[12:15], s42 offen offset:2048 sc1
    v_mfma_f32_16x16x32_bf16 v[40:43], a[56:59], a[180:183], v[40:43]
    v_mfma_f32_16x16x32_bf16 v[44:47], a[60:63], a[180:183], v[44:47]
    buffer_load_dwordx4 v[92:95], v220, s[12:15], s42 offen offset:3072 sc1
    s_add_u32 s42, s42, 4096
    s_waitcnt vmcnt(24)
    v_mfma_f32_16x16x32_bf16 v[16:19], a[48:51], a[184:187], v[16:19]
    v_mfma_f32_16x16x32_bf16 v[20:23], a[52:55], a[184:187], v[20:23]
    v_mfma_f32_16x16x32_bf16 v[48:51], a[56:59], a[184:187], v[48:51]
    v_mfma_f32_16x16x32_bf16 v[52:55], a[60:63], a[184:187], v[52:55]
    v_mfma_f32_16x16x32_bf16 v[24:27], a[48:51], a[188:191], v[24:27]
    v_mfma_f32_16x16x32_bf16 v[28:31], a[52:55], a[188:191], v[28:31]
    v_mfma_f32_16x16x32_bf16 v[56:59], a[56:59], a[188:191], v[56:59]
    v_mfma_f32_16x16x32_bf16 v[60:63], a[60:63], a[188:191], v[60:63]
    s_waitcnt vmcnt(22)
    v_mfma_f32_16x16x32_bf16 v[0:3], a[64:67], a[192:195], v[0:3]
    v_mfma_f32_16x16x32_bf16 v[4:7], a[68:71], a[192:195], v[4:7]
    buffer_load_dwordx4 v[96:99], v220, s[12:15], s42 offen offset:0 sc1
    v_mfma_f32_16x16x32_bf16 v[32:35], a[72:75], a[192:195], v[32:35]
    v_mfma_f32_16x16x32_bf16 v[36:39], a[76:79], a[192:195], v[36:39]
    buffer_load_dwordx4 v[100:103], v220, s[12:15], s42 offen offset:1024 sc1
    v_mfma_f32_16x16x32_bf16 v[8:11], a[64:67], a[196:199], v[8:11]
    v_mfma_f32_16x16x32_bf16 v[12:15], a[68:71], a[196:199], v[12:15]
    buffer_load_dwordx4 v[104:107], v220, s[12:15], s42 offen offset:2048 sc1
    v_mfma_f32_16x16x32_bf16 v[40:43], a[72:75], a[196:199], v[40:43]
    v_mfma_f32_16x16x32_bf16 v[44:47], a[76:79], a[196:199], v[44:47]
    buffer_load_dwordx4 v[108:111], v220, s[12:15], s42 offen offset:3072 sc1
    s_add_u32 s42, s42, 4096
    s_waitcnt vmcnt(24)
    v_mfma_f32_16x16x32_bf16 v[16:19], a[64:67], a[200:203], v[16:19]
    v_mfma_f32_16x16x32_bf16 v[20:23], a[68:71], a[200:203], v[20:23]
    v_mfma_f32_16x16x32_bf16 v[48:51], a[72:75], a[200:203], v[48:51]
    v_mfma_f32_16x16x32_bf16 v[52:55], a[76:79], a[200:203], v[52:55]
    v_mfma_f32_16x16x32_bf16 v[24:27], a[64:67], a[204:207], v[24:27]
    v_mfma_f32_16x16x32_bf16 v[28:31], a[68:71], a[204:207], v[28:31]
    v_mfma_f32_16x16x32_bf16 v[56:59], a[72:75], a[204:207], v[56:59]
    v_mfma_f32_16x16x32_bf16 v[60:63], a[76:79], a[204:207], v[60:63]
    s_waitcnt vmcnt(22)
    v_mfma_f32_16x16x32_bf16 v[0:3], a[80:83], a[208:211], v[0:3]
    v_mfma_f32_16x16x32_bf16 v[4:7], a[84:87], a[208:211], v[4:7]
    buffer_load_dwordx4 v[112:115], v220, s[12:15], s42 offen offset:0 sc1
    v_mfma_f32_16x16x32_bf16 v[32:35], a[88:91], a[208:211], v[32:35]
    v_mfma_f32_16x16x32_bf16 v[36:39], a[92:95], a[208:211], v[36:39]
    buffer_load_dwordx4 v[116:119], v220, s[12:15], s42 offen offset:1024 sc1
    v_mfma_f32_16x16x32_bf16 v[8:11], a[80:83], a[212:215], v[8:11]
    v_mfma_f32_16x16x32_bf16 v[12:15], a[84:87], a[212:215], v[12:15]
    buffer_load_dwordx4 v[120:123], v220, s[12:15], s42 offen offset:2048 sc1
    v_mfma_f32_16x16x32_bf16 v[40:43], a[88:91], a[212:215], v[40:43]
    v_mfma_f32_16x16x32_bf16 v[44:47], a[92:95], a[212:215], v[44:47]
    buffer_load_dwordx4 v[124:127], v220, s[12:15], s42 offen offset:3072 sc1
    s_add_u32 s42, s42, 4096
    s_waitcnt vmcnt(24)
    v_mfma_f32_16x16x32_bf16 v[16:19], a[80:83], a[216:219], v[16:19]
    v_mfma_f32_16x16x32_bf16 v[20:23], a[84:87], a[216:219], v[20:23]
    v_mfma_f32_16x16x32_bf16 v[48:51], a[88:91], a[216:219], v[48:51]
    v_mfma_f32_16x16x32_bf16 v[52:55], a[92:95], a[216:219], v[52:55]
    v_mfma_f32_16x16x32_bf16 v[24:27], a[80:83], a[220:223], v[24:27]
    v_mfma_f32_16x16x32_bf16 v[28:31], a[84:87], a[220:223], v[28:31]
    v_mfma_f32_16x16x32_bf16 v[56:59], a[88:91], a[220:223], v[56:59]
    v_mfma_f32_16x16x32_bf16 v[60:63], a[92:95], a[220:223], v[60:63]
    s_waitcnt vmcnt(22)
    v_mfma_f32_16x16x32_bf16 v[0:3], a[96:99], a[224:227], v[0:3]
    v_mfma_f32_16x16x32_bf16 v[4:7], a[100:103], a[224:227], v[4:7]
    buffer_load_dwordx4 v[160:163], v220, s[12:15], s42 offen offset:0 sc1
    v_mfma_f32_16x16x32_bf16 v[32:35], a[104:107], a[224:227], v[32:35]
    v_mfma_f32_16x16x32_bf16 v[36:39], a[108:111], a[224:227], v[36:39]
    buffer_load_dwordx4 v[164:167], v220, s[12:15], s42 offen offset:1024 sc1
    v_mfma_f32_16x16x32_bf16 v[8:11], a[96:99], a[228:231], v[8:11]
    v_mfma_f32_16x16x32_bf16 v[12:15], a[100:103], a[228:231], v[12:15]
    buffer_load_dwordx4 v[168:171], v220, s[12:15], s42 offen offset:2048 sc1
    v_mfma_f32_16x16x32_bf16 v[40:43], a[104:107], a[228:231], v[40:43]
    v_mfma_f32_16x16x32_bf16 v[44:47], a[108:111], a[228:231], v[44:47]
    buffer_load_dwordx4 v[172:175], v220, s[12:15], s42 offen offset:3072 sc1
    s_add_u32 s42, s42, 4096
    s_waitcnt vmcnt(24)
    v_mfma_f32_16x16x32_bf16 v[16:19], a[96:99], a[232:235], v[16:19]
    v_mfma_f32_16x16x32_bf16 v[20:23], a[100:103], a[232:235], v[20:23]
    v_mfma_f32_16x16x32_bf16 v[48:51], a[104:107], a[232:235], v[48:51]
    v_mfma_f32_16x16x32_bf16 v[52:55], a[108:111], a[232:235], v[52:55]
    v_mfma_f32_16x16x32_bf16 v[24:27], a[96:99], a[236:239], v[24:27]
    v_mfma_f32_16x16x32_bf16 v[28:31], a[100:103], a[236:239], v[28:31]
    v_mfma_f32_16x16x32_bf16 v[56:59], a[104:107], a[236:239], v[56:59]
    v_mfma_f32_16x16x32_bf16 v[60:63], a[108:111], a[236:239], v[60:63]
    s_waitcnt vmcnt(22)
    v_mfma_f32_16x16x32_bf16 v[0:3], a[112:115], a[240:243], v[0:3]
    v_mfma_f32_16x16x32_bf16 v[4:7], a[116:119], a[240:243], v[4:7]
    buffer_load_dwordx4 v[176:179], v220, s[12:15], s42 offen offset:0 sc1
    v_mfma_f32_16x16x32_bf16 v[32:35], a[120:123], a[240:243], v[32:35]
    v_mfma_f32_16x16x32_bf16 v[36:39], a[124:127], a[240:243], v[36:39]
    buffer_load_dwordx4 v[180:183], v220, s[12:15], s42 offen offset:1024 sc1
    v_mfma_f32_16x16x32_bf16 v[8:11], a[112:115], a[244:247], v[8:11]
    v_mfma_f32_16x16x32_bf16 v[12:15], a[116:119], a[244:247], v[12:15]
    buffer_load_dwordx4 v[184:187], v220, s[12:15], s42 offen offset:2048 sc1
    v_mfma_f32_16x16x32_bf16 v[40:43], a[120:123], a[244:247], v[40:43]
    v_mfma_f32_16x16x32_bf16 v[44:47], a[124:127], a[244:247], v[44:47]
    buffer_load_dwordx4 v[188:191], v220, s[12:15], s42 offen offset:3072 sc1
    s_add_u32 s42, s42, 4096
    s_waitcnt vmcnt(24)
    v_mfma_f32_16x16x32_bf16 v[16:19], a[112:115], a[248:251], v[16:19]
    v_mfma_f32_16x16x32_bf16 v[20:23], a[116:119], a[248:251], v[20:23]
    v_mfma_f32_16x16x32_bf16 v[48:51], a[120:123], a[248:251], v[48:51]
    v_mfma_f32_16x16x32_bf16 v[52:55], a[124:127], a[248:251], v[52:55]
    v_mfma_f32_16x16x32_bf16 v[24:27], a[112:115], a[252:255], v[24:27]
    v_mfma_f32_16x16x32_bf16 v[28:31], a[116:119], a[252:255], v[28:31]
    v_mfma_f32_16x16x32_bf16 v[56:59], a[120:123], a[252:255], v[56:59]
    v_mfma_f32_16x16x32_bf16 v[60:63], a[124:127], a[252:255], v[60:63]
    s_waitcnt vmcnt(22) lgkmcnt(0)
    v_mfma_f32_16x16x32_bf16 v[0:3], v[128:131], v[64:67], v[0:3]
    v_mfma_f32_16x16x32_bf16 v[4:7], v[132:135], v[64:67], v[4:7]
    buffer_load_dwordx4 v[236:239], v253, s[12:15], s34 offen sc1
    v_mfma_f32_16x16x32_bf16 v[32:35], v[136:139], v[64:67], v[32:35]
    v_mfma_f32_16x16x32_bf16 v[36:39], v[140:143], v[64:67], v[36:39]
    buffer_load_dwordx4 v[240:243], v253, s[12:15], s34 offen offset:512 sc1
    v_mfma_f32_16x16x32_bf16 v[8:11], v[128:131], v[68:71], v[8:11]
    v_mfma_f32_16x16x32_bf16 v[12:15], v[132:135], v[68:71], v[12:15]
    v_mfma_f32_16x16x32_bf16 v[40:43], v[136:139], v[68:71], v[40:43]
    v_mfma_f32_16x16x32_bf16 v[44:47], v[140:143], v[68:71], v[44:47]
    s_waitcnt vmcnt(22)
    v_mfma_f32_16x16x32_bf16 v[16:19], v[128:131], v[72:75], v[16:19]
    v_mfma_f32_16x16x32_bf16 v[20:23], v[132:135], v[72:75], v[20:23]
    v_mfma_f32_16x16x32_bf16 v[48:51], v[136:139], v[72:75], v[48:51]
    v_mfma_f32_16x16x32_bf16 v[52:55], v[140:143], v[72:75], v[52:55]
    v_mfma_f32_16x16x32_bf16 v[24:27], v[128:131], v[76:79], v[24:27]
    v_mfma_f32_16x16x32_bf16 v[28:31], v[132:135], v[76:79], v[28:31]
    v_mfma_f32_16x16x32_bf16 v[56:59], v[136:139], v[76:79], v[56:59]
    v_mfma_f32_16x16x32_bf16 v[60:63], v[140:143], v[76:79], v[60:63]
    ds_read_b64_tr_b16 v[128:129], v212 offset:8192
    ds_read_b64_tr_b16 v[130:131], v212 offset:10240
    ds_read_b64_tr_b16 v[132:133], v213 offset:8192
    ds_read_b64_tr_b16 v[134:135], v213 offset:10240
    ds_read_b64_tr_b16 v[136:137], v214 offset:8192
    ds_read_b64_tr_b16 v[138:139], v214 offset:10240
    ds_read_b64_tr_b16 v[140:141], v215 offset:8192
    ds_read_b64_tr_b16 v[142:143], v215 offset:10240
    s_waitcnt vmcnt(20) lgkmcnt(0)
    v_mfma_f32_16x16x32_bf16 v[0:3], v[144:147], v[80:83], v[0:3]
    v_mfma_f32_16x16x32_bf16 v[4:7], v[148:151], v[80:83], v[4:7]
    v_mfma_f32_16x16x32_bf16 v[32:35], v[152:155], v[80:83], v[32:35]
    v_mfma_f32_16x16x32_bf16 v[36:39], v[156:159], v[80:83], v[36:39]
    v_mfma_f32_16x16x32_bf16 v[8:11], v[144:147], v[84:87], v[8:11]
    v_mfma_f32_16x16x32_bf16 v[12:15], v[148:151], v[84:87], v[12:15]
    v_mfma_f32_16x16x32_bf16 v[40:43], v[152:155], v[84:87], v[40:43]
    v_mfma_f32_16x16x32_bf16 v[44:47], v[156:159], v[84:87], v[44:47]
    s_waitcnt vmcnt(18)
    v_mfma_f32_16x16x32_bf16 v[16:19], v[144:147], v[88:91], v[16:19]
    v_mfma_f32_16x16x32_bf16 v[20:23], v[148:151], v[88:91], v[20:23]
    v_mfma_f32_16x16x32_bf16 v[48:51], v[152:155], v[88:91], v[48:51]
    v_mfma_f32_16x16x32_bf16 v[52:55], v[156:159], v[88:91], v[52:55]
    v_mfma_f32_16x16x32_bf16 v[24:27], v[144:147], v[92:95], v[24:27]
    v_mfma_f32_16x16x32_bf16 v[28:31], v[148:151], v[92:95], v[28:31]
    v_mfma_f32_16x16x32_bf16 v[56:59], v[152:155], v[92:95], v[56:59]
    v_mfma_f32_16x16x32_bf16 v[60:63], v[156:159], v[92:95], v[60:63]
    ds_read_b64_tr_b16 v[144:145], v212 offset:12288
    ds_read_b64_tr_b16 v[146:147], v212 offset:14336
    ds_read_b64_tr_b16 v[148:149], v213 offset:12288
    ds_read_b64_tr_b16 v[150:151], v213 offset:14336
    ds_read_b64_tr_b16 v[152:153], v214 offset:12288
    ds_read_b64_tr_b16 v[154:155], v214 offset:14336
    ds_read_b64_tr_b16 v[156:157], v215 offset:12288
    ds_read_b64_tr_b16 v[158:159], v215 offset:14336
    s_waitcnt vmcnt(16) lgkmcnt(0)
    v_mfma_f32_16x16x32_bf16 v[0:3], v[128:131], v[96:99], v[0:3]
    v_mfma_f32_16x16x32_bf16 v[4:7], v[132:135], v[96:99], v[4:7]
    v_mfma_f32_16x16x32_bf16 v[32:35], v[136:139], v[96:99], v[32:35]
    v_mfma_f32_16x16x32_bf16 v[36:39], v[140:143], v[96:99], v[36:39]
    v_mfma_f32_16x16x32_bf16 v[8:11], v[128:131], v[100:103], v[8:11]
    v_mfma_f32_16x16x32_bf16 v[12:15], v[132:135], v[100:103], v[12:15]
    v_mfma_f32_16x16x32_bf16 v[40:43], v[136:139], v[100:103], v[40:43]
    v_mfma_f32_16x16x32_bf16 v[44:47], v[140:143], v[100:103], v[44:47]
    s_waitcnt vmcnt(14)
    v_mfma_f32_16x16x32_bf16 v[16:19], v[128:131], v[104:107], v[16:19]
    v_mfma_f32_16x16x32_bf16 v[20:23], v[132:135], v[104:107], v[20:23]
    v_mfma_f32_16x16x32_bf16 v[48:51], v[136:139], v[104:107], v[48:51]
    v_mfma_f32_16x16x32_bf16 v[52:55], v[140:143], v[104:107], v[52:55]
    v_mfma_f32_16x16x32_bf16 v[24:27], v[128:131], v[108:111], v[24:27]
    v_mfma_f32_16x16x32_bf16 v[28:31], v[132:135], v[108:111], v[28:31]
    v_mfma_f32_16x16x32_bf16 v[56:59], v[136:139], v[108:111], v[56:59]
    v_mfma_f32_16x16x32_bf16 v[60:63], v[140:143], v[108:111], v[60:63]
    ds_read_b64_tr_b16 v[128:129], v208 offset:0
    ds_read_b64_tr_b16 v[130:131], v208 offset:2048
    ds_read_b64_tr_b16 v[132:133], v209 offset:0
    ds_read_b64_tr_b16 v[134:135], v209 offset:2048
    ds_read_b64_tr_b16 v[136:137], v210 offset:0
    ds_read_b64_tr_b16 v[138:139], v210 offset:2048
    ds_read_b64_tr_b16 v[140:141], v211 offset:0
    ds_read_b64_tr_b16 v[142:143], v211 offset:2048
    s_waitcnt vmcnt(12) lgkmcnt(0)
    v_mfma_f32_16x16x32_bf16 v[0:3], v[144:147], v[112:115], v[0:3]
    v_mfma_f32_16x16x32_bf16 v[4:7], v[148:151], v[112:115], v[4:7]
    v_mfma_f32_16x16x32_bf16 v[32:35], v[152:155], v[112:115], v[32:35]
    v_mfma_f32_16x16x32_bf16 v[36:39], v[156:159], v[112:115], v[36:39]
    v_mfma_f32_16x16x32_bf16 v[8:11], v[144:147], v[116:119], v[8:11]
    v_mfma_f32_16x16x32_bf16 v[12:15], v[148:151], v[116:119], v[12:15]
    v_mfma_f32_16x16x32_bf16 v[40:43], v[152:155], v[116:119], v[40:43]
    v_mfma_f32_16x16x32_bf16 v[44:47], v[156:159], v[116:119], v[44:47]
    s_waitcnt vmcnt(10)
    v_mfma_f32_16x16x32_bf16 v[16:19], v[144:147], v[120:123], v[16:19]
    v_mfma_f32_16x16x32_bf16 v[20:23], v[148:151], v[120:123], v[20:23]
    v_mfma_f32_16x16x32_bf16 v[48:51], v[152:155], v[120:123], v[48:51]
    v_mfma_f32_16x16x32_bf16 v[52:55], v[156:159], v[120:123], v[52:55]
    v_mfma_f32_16x16x32_bf16 v[24:27], v[144:147], v[124:127], v[24:27]
    v_mfma_f32_16x16x32_bf16 v[28:31], v[148:151], v[124:127], v[28:31]
    v_mfma_f32_16x16x32_bf16 v[56:59], v[152:155], v[124:127], v[56:59]
    v_mfma_f32_16x16x32_bf16 v[60:63], v[156:159], v[124:127], v[60:63]
    ds_read_b64_tr_b16 v[144:145], v208 offset:4096
    ds_read_b64_tr_b16 v[146:147], v208 offset:6144
    ds_read_b64_tr_b16 v[148:149], v209 offset:4096
    ds_read_b64_tr_b16 v[150:151], v209 offset:6144
    ds_read_b64_tr_b16 v[152:153], v210 offset:4096
    ds_read_b64_tr_b16 v[154:155], v210 offset:6144
    ds_read_b64_tr_b16 v[156:157], v211 offset:4096
    ds_read_b64_tr_b16 v[158:159], v211 offset:6144
    s_waitcnt vmcnt(8) lgkmcnt(0)
    v_mfma_f32_16x16x32_bf16 v[0:3], v[128:131], v[160:163], v[0:3]
    v_mfma_f32_16x16x32_bf16 v[4:7], v[132:135], v[160:163], v[4:7]
    v_mfma_f32_16x16x32_bf16 v[32:35], v[136:139], v[160:163], v[32:35]
    v_mfma_f32_16x16x32_bf16 v[36:39], v[140:143], v[160:163], v[36:39]
    v_mfma_f32_16x16x32_bf16 v[8:11], v[128:131], v[164:167], v[8:11]
    v_mfma_f32_16x16x32_bf16 v[12:15], v[132:135], v[164:167], v[12:15]
    v_mfma_f32_16x16x32_bf16 v[40:43], v[136:139], v[164:167], v[40:43]
    v_mfma_f32_16x16x32_bf16 v[44:47], v[140:143], v[164:167], v[44:47]
    s_waitcnt vmcnt(6)
    v_mfma_f32_16x16x32_bf16 v[16:19], v[128:131], v[168:171], v[16:19]
    v_mfma_f32_16x16x32_bf16 v[20:23], v[132:135], v[168:171], v[20:23]
    v_mfma_f32_16x16x32_bf16 v[48:51], v[136:139], v[168:171], v[48:51]
    v_mfma_f32_16x16x32_bf16 v[52:55], v[140:143], v[168:171], v[52:55]
    v_mfma_f32_16x16x32_bf16 v[24:27], v[128:131], v[172:175], v[24:27]
    v_mfma_f32_16x16x32_bf16 v[28:31], v[132:135], v[172:175], v[28:31]
    v_mfma_f32_16x16x32_bf16 v[56:59], v[136:139], v[172:175], v[56:59]
    v_mfma_f32_16x16x32_bf16 v[60:63], v[140:143], v[172:175], v[60:63]
    s_waitcnt vmcnt(4) lgkmcnt(0)
    v_mfma_f32_16x16x32_bf16 v[0:3], v[144:147], v[176:179], v[0:3]
    v_mfma_f32_16x16x32_bf16 v[4:7], v[148:151], v[176:179], v[4:7]
    v_mfma_f32_16x16x32_bf16 v[32:35], v[152:155], v[176:179], v[32:35]
    v_mfma_f32_16x16x32_bf16 v[36:39], v[156:159], v[176:179], v[36:39]
    v_mfma_f32_16x16x32_bf16 v[8:11], v[144:147], v[180:183], v[8:11]
    v_mfma_f32_16x16x32_bf16 v[12:15], v[148:151], v[180:183], v[12:15]
    v_mfma_f32_16x16x32_bf16 v[40:43], v[152:155], v[180:183], v[40:43]
    v_mfma_f32_16x16x32_bf16 v[44:47], v[156:159], v[180:183], v[44:47]
    s_waitcnt vmcnt(2)
    v_mfma_f32_16x16x32_bf16 v[16:19], v[144:147], v[184:187], v[16:19]
    v_mfma_f32_16x16x32_bf16 v[20:23], v[148:151], v[184:187], v[20:23]
    v_mfma_f32_16x16x32_bf16 v[48:51], v[152:155], v[184:187], v[48:51]
    v_mfma_f32_16x16x32_bf16 v[52:55], v[156:159], v[184:187], v[52:55]
    v_mfma_f32_16x16x32_bf16 v[24:27], v[144:147], v[188:191], v[24:27]
    v_mfma_f32_16x16x32_bf16 v[28:31], v[148:151], v[188:191], v[28:31]
    v_mfma_f32_16x16x32_bf16 v[56:59], v[152:155], v[188:191], v[56:59]
    v_mfma_f32_16x16x32_bf16 v[60:63], v[156:159], v[188:191], v[60:63]
    v_add_u32 v232, s62, v220
    s_lshl_b32 s50, s20, 11
    v_add_u32 v233, s50, v220
    s_nop 7
    s_nop 1
    ds_write_b128 v232, v[0:3] offset:0
    ds_write_b128 v232, v[4:7] offset:1024
    ds_write_b128 v232, v[8:11] offset:2048
    ds_write_b128 v232, v[12:15] offset:3072
    ds_write_b128 v232, v[16:19] offset:4096
    ds_write_b128 v232, v[20:23] offset:5120
    ds_write_b128 v232, v[24:27] offset:6144
    ds_write_b128 v232, v[28:31] offset:7168
    ds_write_b128 v232, v[32:35] offset:8192
    ds_write_b128 v232, v[36:39] offset:9216
    ds_write_b128 v232, v[40:43] offset:10240
    ds_write_b128 v232, v[44:47] offset:11264
    ds_write_b128 v232, v[48:51] offset:12288
    ds_write_b128 v232, v[52:55] offset:13312
    ds_write_b128 v232, v[56:59] offset:14336
    ds_write_b128 v232, v[60:63] offset:15360
    s_waitcnt lgkmcnt(0)
    s_barrier
    ds_read_b128 v[0:3], v233 offset:0
    ds_read_b128 v[4:7], v233 offset:1024
    ds_read_b128 v[8:11], v233 offset:8192
    ds_read_b128 v[12:15], v233 offset:9216
    ds_read_b128 v[16:19], v233 offset:16384
    ds_read_b128 v[20:23], v233 offset:17408
    ds_read_b128 v[24:27], v233 offset:24576
    ds_read_b128 v[28:31], v233 offset:25600
    ds_read_b128 v[32:35], v233 offset:32768
    ds_read_b128 v[36:39], v233 offset:33792
    ds_read_b128 v[40:43], v233 offset:40960
    ds_read_b128 v[44:47], v233 offset:41984
    ds_read_b128 v[48:51], v233 offset:49152
    ds_read_b128 v[52:55], v233 offset:50176
    ds_read_b128 v[56:59], v233 offset:57344
    ds_read_b128 v[60:63], v233 offset:58368
    s_waitcnt vmcnt(0)
    v_lshlrev_b32 v104, 16, v236
    v_and_b32 v105, 0xffff0000, v236
    v_lshlrev_b32 v106, 16, v237
    v_and_b32 v107, 0xffff0000, v237
    v_lshlrev_b32 v108, 16, v238
    v_and_b32 v109, 0xffff0000, v238
    v_lshlrev_b32 v110, 16, v239
    v_and_b32 v111, 0xffff0000, v239
    v_lshlrev_b32 v112, 16, v240
    v_and_b32 v113, 0xffff0000, v240
    v_lshlrev_b32 v114, 16, v241
    v_and_b32 v115, 0xffff0000, v241
    v_lshlrev_b32 v116, 16, v242
    v_and_b32 v117, 0xffff0000, v242
    v_lshlrev_b32 v118, 16, v243
    v_and_b32 v119, 0xffff0000, v243
    s_waitcnt lgkmcnt(0)
    v_pk_add_f32 v[0:1], v[0:1], v[16:17]
    v_pk_add_f32 v[32:33], v[32:33], v[48:49]
    v_pk_add_f32 v[2:3], v[2:3], v[18:19]
    v_pk_add_f32 v[34:35], v[34:35], v[50:51]
    v_pk_add_f32 v[4:5], v[4:5], v[20:21]
    v_pk_add_f32 v[36:37], v[36:37], v[52:53]
    v_pk_add_f32 v[6:7], v[6:7], v[22:23]
    v_pk_add_f32 v[38:39], v[38:39], v[54:55]
    v_pk_add_f32 v[8:9], v[8:9], v[24:25]
    v_pk_add_f32 v[40:41], v[40:41], v[56:57]
    v_pk_add_f32 v[10:11], v[10:11], v[26:27]
    v_pk_add_f32 v[42:43], v[42:43], v[58:59]
    v_pk_add_f32 v[12:13], v[12:13], v[28:29]
    v_pk_add_f32 v[44:45], v[44:45], v[60:61]
    v_pk_add_f32 v[14:15], v[14:15], v[30:31]
    v_pk_add_f32 v[46:47], v[46:47], v[62:63]
    v_pk_add_f32 v[0:1], v[0:1], v[32:33]
    v_pk_add_f32 v[2:3], v[2:3], v[34:35]
    v_pk_add_f32 v[4:5], v[4:5], v[36:37]
    v_pk_add_f32 v[6:7], v[6:7], v[38:39]
    v_pk_add_f32 v[8:9], v[8:9], v[40:41]
    v_pk_add_f32 v[10:11], v[10:11], v[42:43]
    v_pk_add_f32 v[12:13], v[12:13], v[44:45]
    v_pk_add_f32 v[14:15], v[14:15], v[46:47]
    v_pk_fma_f32 v[0:1], v[0:1], v[192:193], v[104:105]
    v_pk_fma_f32 v[2:3], v[2:3], v[194:195], v[106:107]
    v_pk_fma_f32 v[4:5], v[4:5], v[196:197], v[108:109]
    v_pk_fma_f32 v[6:7], v[6:7], v[198:199], v[110:111]
    v_pk_fma_f32 v[8:9], v[8:9], v[200:201], v[112:113]
    v_pk_fma_f32 v[10:11], v[10:11], v[202:203], v[114:115]
    v_pk_fma_f32 v[12:13], v[12:13], v[204:205], v[116:117]
    v_pk_fma_f32 v[14:15], v[14:15], v[206:207], v[118:119]
    v_cvt_pk_bf16_f32 v32, v0, v1
    v_cvt_pk_bf16_f32 v33, v2, v3
    v_cvt_pk_bf16_f32 v34, v4, v5
    v_cvt_pk_bf16_f32 v35, v6, v7
    v_cvt_pk_bf16_f32 v36, v8, v9
    v_cvt_pk_bf16_f32 v37, v10, v11
    v_cvt_pk_bf16_f32 v38, v12, v13
    v_cvt_pk_bf16_f32 v39, v14, v15
    buffer_store_dwordx2 v[32:33], v234, s[16:19], s32 offen
    buffer_store_dwordx2 v[34:35], v234, s[16:19], s32 offen offset:32
    buffer_store_dwordx2 v[36:37], v234, s[16:19], s32 offen offset:64
    buffer_store_dwordx2 v[38:39], v234, s[16:19], s32 offen offset:96
KM_END:
    s_endpgm
KQ_SLOW:
    v_lshlrev_b32 v245, 2, v220
    v_min_u32 v245, 448, v245
    s_mov_b32 s47, 32768
KQ1_POLL:
    buffer_load_dwordx2 v[246:247], v245, s[12:15], s34 offen sc1
    s_sub_u32 s47, s47, 1
    s_waitcnt vmcnt(0)
    v_cmp_ne_u64 vcc, s[4:5], v[246:247]
    s_cbranch_vccz KQ1_GO
    s_cmp_eq_u32 s47, 0
    s_cbranch_scc1 KQ1_GO
    s_branch KQ1_POLL
KQ1_GO:
    v_lshrrev_b32 v245, 1, v220
    v_min_u32 v245, 504, v245
    s_mov_b32 s47, 32768
KQ2_POLL:
    buffer_load_dwordx2 v[246:247], v245, s[12:15], s35 offen sc1
    s_sub_u32 s47, s47, 1
    s_waitcnt vmcnt(0)
    v_cmp_ne_u64 vcc, s[4:5], v[246:247]
    s_cbranch_vccz KQ2_GO
    s_cmp_eq_u32 s47, 0
    s_cbranch_scc1 KQ2_GO
    s_branch KQ2_POLL
KQ2_GO:
    v_lshrrev_b32 v245, 1, v220
    v_min_u32 v245, 504, v245
    s_mov_b32 s47, 32768
KQ3_POLL:
    buffer_load_dwordx2 v[246:247], v245, s[12:15], s36 offen sc1
    s_sub_u32 s47, s47, 1
    s_waitcnt vmcnt(0)
    v_cmp_ne_u64 vcc, s[4:5], v[246:247]
    s_cbranch_vccz KQ3_GO
    s_cmp_eq_u32 s47, 0
    s_cbranch_scc1 KQ3_GO
    s_branch KQ3_POLL
KQ3_GO:
    s_branch KQ_RET
KA_TR1:
    s_mov_b32 s28, 1
    s_branch KA_SLOW0
KA_TR3:
    s_mov_b32 s28, 3
    s_branch KA_SLOW0
KA_TR5:
    s_mov_b32 s28, 5
    s_branch KA_SLOW0
KA_TR7:
    s_mov_b32 s28, 7
    s_branch KA_SLOW0
KA_TR9:
    s_mov_b32 s28, 9
    s_branch KA_SLOW0
KA_TR11:
    s_mov_b32 s28, 11
    s_branch KA_SLOW0
KA_TR13:
    s_mov_b32 s28, 13
    s_branch KA_SLOW0
KA_TR15:
    s_mov_b32 s28, 15
    s_branch KA_SLOW0
KA_TR17:
    s_mov_b32 s28, 17
    s_branch KA_SLOW0
KA_TR19:
    s_mov_b32 s28, 19
    s_branch KA_SLOW0
KA_TR21:
    s_mov_b32 s28, 21
    s_branch KA_SLOW0
KA_TR23:
    s_mov_b32 s28, 23
    s_branch KA_SLOW0
KA_TR25:
    s_mov_b32 s28, 25
    s_branch KA_SLOW0
KA_TR27:
    s_mov_b32 s28, 27
    s_branch KA_SLOW0
KA_TR29:
    s_mov_b32 s28, 29
    s_branch KA_SLOW0
KA_TR0:
    s_mov_b32 s28, 0
    s_branch KA_SLOW1
KA_TR2:
    s_mov_b32 s28, 2
    s_branch KA_SLOW1
KA_TR4:
    s_mov_b32 s28, 4
    s_branch KA_SLOW1
KA_TR6:
    s_mov_b32 s28, 6
    s_branch KA_SLOW1
KA_TR8:
    s_mov_b32 s28, 8
    s_branch KA_SLOW1
KA_TR10:
    s_mov_b32 s28, 10
    s_branch KA_SLOW1
KA_TR12:
    s_mov_b32 s28, 12
    s_branch KA_SLOW1
KA_TR14:
    s_mov_b32 s28, 14
    s_branch KA_SLOW1
KA_TR16:
    s_mov_b32 s28, 16
    s_branch KA_SLOW1
KA_TR18:
    s_mov_b32 s28, 18
    s_branch KA_SLOW1
KA_TR20:
    s_mov_b32 s28, 20
    s_branch KA_SLOW1
KA_TR22:
    s_mov_b32 s28, 22
    s_branch KA_SLOW1
KA_TR24:
    s_mov_b32 s28, 24
    s_branch KA_SLOW1
KA_TR26:
    s_mov_b32 s28, 26
    s_branch KA_SLOW1
KA_TR28:
    s_mov_b32 s28, 28
    s_branch KA_SLOW1
KA_TR30:
    s_mov_b32 s28, 30
    s_branch KA_SLOW1
KA_SLOW0:
    s_nop 7
    s_nop 7
    v_max3_f32 v232, v128, v129, v130
    v_max3_f32 v232, v232, v131, v132
    v_max3_f32 v232, v232, v133, v134
    v_max3_f32 v232, v232, v135, v136
    v_max3_f32 v232, v232, v137, v138
    v_max3_f32 v232, v232, v139, v140
    v_max3_f32 v232, v232, v141, v142
    v_max_f32 v232, v232, v143
    v_mov_b32 v233, v232
    s_nop 1
    v_permlane32_swap_b32 v232, v233
    s_nop 0
    v_max_f32 v232, v232, v233
    v_add_f32 v232, 0x42800000, v232
    v_max_f32 v232, 0, v232
    v_ceil_f32 v232, v232
    v_cvt_i32_f32 v233, -v232
    v_sub_f32 v128, v128, v232
    v_sub_f32 v129, v129, v232
    v_sub_f32 v130, v130, v232
    v_sub_f32 v131, v131, v232
    v_sub_f32 v132, v132, v232
    v_sub_f32 v133, v133, v232
    v_sub_f32 v134, v134, v232
    v_sub_f32 v135, v135, v232
    v_sub_f32 v136, v136, v232
    v_sub_f32 v137, v137, v232
    v_sub_f32 v138, v138, v232
    v_sub_f32 v139, v139, v232
    v_sub_f32 v140, v140, v232
    v_sub_f32 v141, v141, v232
    v_sub_f32 v142, v142, v232
    v_sub_f32 v143, v143, v232
    v_sub_f32 v160, v160, v232
    v_sub_f32 v161, v161, v232
    v_sub_f32 v162, v162, v232
    v_sub_f32 v163, v163, v232
    v_sub_f32 v164, v164, v232
    v_sub_f32 v165, v165, v232
    v_sub_f32 v166, v166, v232
    v_sub_f32 v167, v167, v232
    v_sub_f32 v168, v168, v232
    v_sub_f32 v169, v169, v232
    v_sub_f32 v170, v170, v232
    v_sub_f32 v171, v171, v232
    v_sub_f32 v172, v172, v232
    v_sub_f32 v173, v173, v232
    v_sub_f32 v174, v174, v232
    v_sub_f32 v175, v175, v232
    v_ldexp_f32 v216, v216, v233
    v_ldexp_f32 v0, v0, v233
    v_ldexp_f32 v1, v1, v233
    v_ldexp_f32 v2, v2, v233
    v_ldexp_f32 v3, v3, v233
    v_ldexp_f32 v4, v4, v233
    v_ldexp_f32 v5, v5, v233
    v_ldexp_f32 v6, v6, v233
    v_ldexp_f32 v7, v7, v233
    v_ldexp_f32 v8, v8, v233
    v_ldexp_f32 v9, v9, v233
    v_ldexp_f32 v10, v10, v233
    v_ldexp_f32 v11, v11, v233
    v_ldexp_f32 v12, v12, v233
    v_ldexp_f32 v13, v13, v233
    v_ldexp_f32 v14, v14, v233
    v_ldexp_f32 v15, v15, v233
    v_ldexp_f32 v32, v32, v233
    v_ldexp_f32 v33, v33, v233
    v_ldexp_f32 v34, v34, v233
    v_ldexp_f32 v35, v35, v233
    v_ldexp_f32 v36, v36, v233
    v_ldexp_f32 v37, v37, v233
    v_ldexp_f32 v38, v38, v233
    v_ldexp_f32 v39, v39, v233
    v_ldexp_f32 v40, v40, v233
    v_ldexp_f32 v41, v41, v233
    v_ldexp_f32 v42, v42, v233
    v_ldexp_f32 v43, v43, v233
    v_ldexp_f32 v44, v44, v233
    v_ldexp_f32 v45, v45, v233
    v_ldexp_f32 v46, v46, v233
    v_ldexp_f32 v47, v47, v233
    v_ldexp_f32 v64, v64, v233
    v_ldexp_f32 v65, v65, v233
    v_ldexp_f32 v66, v66, v233
    v_ldexp_f32 v67, v67, v233
    v_ldexp_f32 v68, v68, v233
    v_ldexp_f32 v69, v69, v233
    v_ldexp_f32 v70, v70, v233
    v_ldexp_f32 v71, v71, v233
    v_ldexp_f32 v72, v72, v233
    v_ldexp_f32 v73, v73, v233
    v_ldexp_f32 v74, v74, v233
    v_ldexp_f32 v75, v75, v233
    v_ldexp_f32 v76, v76, v233
    v_ldexp_f32 v77, v77, v233
    v_ldexp_f32 v78, v78, v233
    v_ldexp_f32 v79, v79, v233
    v_ldexp_f32 v96, v96, v233
    v_ldexp_f32 v97, v97, v233
    v_ldexp_f32 v98, v98, v233
    v_ldexp_f32 v99, v99, v233
    v_ldexp_f32 v100, v100, v233
    v_ldexp_f32 v101, v101, v233
    v_ldexp_f32 v102, v102, v233
    v_ldexp_f32 v103, v103, v233
    v_ldexp_f32 v104, v104, v233
    v_ldexp_f32 v105, v105, v233
    v_ldexp_f32 v106, v106, v233
    v_ldexp_f32 v107, v107, v233
    v_ldexp_f32 v108, v108, v233
    v_ldexp_f32 v109, v109, v233
    v_ldexp_f32 v110, v110, v233
    v_ldexp_f32 v111, v111, v233
    v_exp_f32 v234, v128
    v_exp_f32 v235, v129
    s_nop 0
    v_add_f32 v218, v234, v235
    v_cvt_pk_bf16_f32 v192, v234, v235
    v_exp_f32 v234, v130
    v_exp_f32 v235, v131
    s_nop 0
    v_add_f32 v218, v218, v234
    v_add_f32 v218, v218, v235
    v_cvt_pk_bf16_f32 v193, v234, v235
    v_exp_f32 v234, v132
    v_exp_f32 v235, v133
    s_nop 0
    v_add_f32 v218, v218, v234
    v_add_f32 v218, v218, v235
    v_cvt_pk_bf16_f32 v194, v234, v235
    v_exp_f32 v234, v134
    v_exp_f32 v235, v135
    s_nop 0
    v_add_f32 v218, v218, v234
    v_add_f32 v218, v218, v235
    v_cvt_pk_bf16_f32 v195, v234, v235
    v_exp_f32 v234, v136
    v_exp_f32 v235, v137
    s_nop 0
    v_add_f32 v218, v218, v234
    v_add_f32 v218, v218, v235
    v_cvt_pk_bf16_f32 v196, v234, v235
    v_exp_f32 v234, v138
    v_exp_f32 v235, v139
    s_nop 0
    v_add_f32 v218, v218, v234
    v_add_f32 v218, v218, v235
    v_cvt_pk_bf16_f32 v197, v234, v235
    v_exp_f32 v234, v140
    v_exp_f32 v235, v141
    s_nop 0
    v_add_f32 v218, v218, v234
    v_add_f32 v218, v218, v235
    v_cvt_pk_bf16_f32 v198, v234, v235
    v_exp_f32 v234, v142
    v_exp_f32 v235, v143
    s_nop 0
    v_add_f32 v218, v218, v234
    v_add_f32 v218, v218, v235
    v_cvt_pk_bf16_f32 v199, v234, v235
    s_nop 1
    s_cmp_eq_u32 s28, 1
    s_cbranch_scc1 KA_RET1
    s_cmp_eq_u32 s28, 3
    s_cbranch_scc1 KA_RET3
    s_cmp_eq_u32 s28, 5
    s_cbranch_scc1 KA_RET5
    s_cmp_eq_u32 s28, 7
    s_cbranch_scc1 KA_RET7
    s_cmp_eq_u32 s28, 9
    s_cbranch_scc1 KA_RET9
    s_cmp_eq_u32 s28, 11
    s_cbranch_scc1 KA_RET11
    s_cmp_eq_u32 s28, 13
    s_cbranch_scc1 KA_RET13
    s_cmp_eq_u32 s28, 15
    s_cbranch_scc1 KA_RET15
    s_cmp_eq_u32 s28, 17
    s_cbranch_scc1 KA_RET17
    s_cmp_eq_u32 s28, 19
    s_cbranch_scc1 KA_RET19
    s_cmp_eq_u32 s28, 21
    s_cbranch_scc1 KA_RET21
    s_cmp_eq_u32 s28, 23
    s_cbranch_scc1 KA_RET23
    s_cmp_eq_u32 s28, 25
    s_cbranch_scc1 KA_RET25
    s_cmp_eq_u32 s28, 27
    s_cbranch_scc1 KA_RET27
    s_branch KA_RET29
KA_SLOW1:
    s_nop 7
    s_nop 7
    v_max3_f32 v232, v144, v145, v146
    v_max3_f32 v232, v232, v147, v148
    v_max3_f32 v232, v232, v149, v150
    v_max3_f32 v232, v232, v151, v152
    v_max3_f32 v232, v232, v153, v154
    v_max3_f32 v232, v232, v155, v156
    v_max3_f32 v232, v232, v157, v158
    v_max_f32 v232, v232, v159
    v_mov_b32 v233, v232
    s_nop 1
    v_permlane32_swap_b32 v232, v233
    s_nop 0
    v_max_f32 v232, v232, v233
    v_add_f32 v232, 0x42800000, v232
    v_max_f32 v232, 0, v232
    v_ceil_f32 v232, v232
    v_cvt_i32_f32 v233, -v232
    v_sub_f32 v144, v144, v232
    v_sub_f32 v145, v145, v232
    v_sub_f32 v146, v146, v232
    v_sub_f32 v147, v147, v232
    v_sub_f32 v148, v148, v232
    v_sub_f32 v149, v149, v232
    v_sub_f32 v150, v150, v232
    v_sub_f32 v151, v151, v232
    v_sub_f32 v152, v152, v232
    v_sub_f32 v153, v153, v232
    v_sub_f32 v154, v154, v232
    v_sub_f32 v155, v155, v232
    v_sub_f32 v156, v156, v232
    v_sub_f32 v157, v157, v232
    v_sub_f32 v158, v158, v232
    v_sub_f32 v159, v159, v232
    v_sub_f32 v176, v176, v232
    v_sub_f32 v177, v177, v232
    v_sub_f32 v178, v178, v232
    v_sub_f32 v179, v179, v232
    v_sub_f32 v180, v180, v232
    v_sub_f32 v181, v181, v232
    v_sub_f32 v182, v182, v232
    v_sub_f32 v183, v183, v232
    v_sub_f32 v184, v184, v232
    v_sub_f32 v185, v185, v232
    v_sub_f32 v186, v186, v232
    v_sub_f32 v187, v187, v232
    v_sub_f32 v188, v188, v232
    v_sub_f32 v189, v189, v232
    v_sub_f32 v190, v190, v232
    v_sub_f32 v191, v191, v232
    v_ldexp_f32 v217, v217, v233
    v_ldexp_f32 v16, v16, v233
    v_ldexp_f32 v17, v17, v233
    v_ldexp_f32 v18, v18, v233
    v_ldexp_f32 v19, v19, v233
    v_ldexp_f32 v20, v20, v233
    v_ldexp_f32 v21, v21, v233
    v_ldexp_f32 v22, v22, v233
    v_ldexp_f32 v23, v23, v233
    v_ldexp_f32 v24, v24, v233
    v_ldexp_f32 v25, v25, v233
    v_ldexp_f32 v26, v26, v233
    v_ldexp_f32 v27, v27, v233
    v_ldexp_f32 v28, v28, v233
    v_ldexp_f32 v29, v29, v233
    v_ldexp_f32 v30, v30, v233
    v_ldexp_f32 v31, v31, v233
    v_ldexp_f32 v48, v48, v233
    v_ldexp_f32 v49, v49, v233
    v_ldexp_f32 v50, v50, v233
    v_ldexp_f32 v51, v51, v233
    v_ldexp_f32 v52, v52, v233
    v_ldexp_f32 v53, v53, v233
    v_ldexp_f32 v54, v54, v233
    v_ldexp_f32 v55, v55, v233
    v_ldexp_f32 v56, v56, v233
    v_ldexp_f32 v57, v57, v233
    v_ldexp_f32 v58, v58, v233
    v_ldexp_f32 v59, v59, v233
    v_ldexp_f32 v60, v60, v233
    v_ldexp_f32 v61, v61, v233
    v_ldexp_f32 v62, v62, v233
    v_ldexp_f32 v63, v63, v233
    v_ldexp_f32 v80, v80, v233
    v_ldexp_f32 v81, v81, v233
    v_ldexp_f32 v82, v82, v233
    v_ldexp_f32 v83, v83, v233
    v_ldexp_f32 v84, v84, v233
    v_ldexp_f32 v85, v85, v233
    v_ldexp_f32 v86, v86, v233
    v_ldexp_f32 v87, v87, v233
    v_ldexp_f32 v88, v88, v233
    v_ldexp_f32 v89, v89, v233
    v_ldexp_f32 v90, v90, v233
    v_ldexp_f32 v91, v91, v233
    v_ldexp_f32 v92, v92, v233
    v_ldexp_f32 v93, v93, v233
    v_ldexp_f32 v94, v94, v233
    v_ldexp_f32 v95, v95, v233
    v_ldexp_f32 v112, v112, v233
    v_ldexp_f32 v113, v113, v233
    v_ldexp_f32 v114, v114, v233
    v_ldexp_f32 v115, v115, v233
    v_ldexp_f32 v116, v116, v233
    v_ldexp_f32 v117, v117, v233
    v_ldexp_f32 v118, v118, v233
    v_ldexp_f32 v119, v119, v233
    v_ldexp_f32 v120, v120, v233
    v_ldexp_f32 v121, v121, v233
    v_ldexp_f32 v122, v122, v233
    v_ldexp_f32 v123, v123, v233
    v_ldexp_f32 v124, v124, v233
    v_ldexp_f32 v125, v125, v233
    v_ldexp_f32 v126, v126, v233
    v_ldexp_f32 v127, v127, v233
    v_exp_f32 v234, v144
    v_exp_f32 v235, v145
    s_nop 0
    v_add_f32 v219, v234, v235
    v_cvt_pk_bf16_f32 v200, v234, v235
    v_exp_f32 v234, v146
    v_exp_f32 v235, v147
    s_nop 0
    v_add_f32 v219, v219, v234
    v_add_f32 v219, v219, v235
    v_cvt_pk_bf16_f32 v201, v234, v235
    v_exp_f32 v234, v148
    v_exp_f32 v235, v149
    s_nop 0
    v_add_f32 v219, v219, v234
    v_add_f32 v219, v219, v235
    v_cvt_pk_bf16_f32 v202, v234, v235
    v_exp_f32 v234, v150
    v_exp_f32 v235, v151
    s_nop 0
    v_add_f32 v219, v219, v234
    v_add_f32 v219, v219, v235
    v_cvt_pk_bf16_f32 v203, v234, v235
    v_exp_f32 v234, v152
    v_exp_f32 v235, v153
    s_nop 0
    v_add_f32 v219, v219, v234
    v_add_f32 v219, v219, v235
    v_cvt_pk_bf16_f32 v204, v234, v235
    v_exp_f32 v234, v154
    v_exp_f32 v235, v155
    s_nop 0
    v_add_f32 v219, v219, v234
    v_add_f32 v219, v219, v235
    v_cvt_pk_bf16_f32 v205, v234, v235
    v_exp_f32 v234, v156
    v_exp_f32 v235, v157
    s_nop 0
    v_add_f32 v219, v219, v234
    v_add_f32 v219, v219, v235
    v_cvt_pk_bf16_f32 v206, v234, v235
    v_exp_f32 v234, v158
    v_exp_f32 v235, v159
    s_nop 0
    v_add_f32 v219, v219, v234
    v_add_f32 v219, v219, v235
    v_cvt_pk_bf16_f32 v207, v234, v235
    s_nop 1
    s_cmp_eq_u32 s28, 0
    s_cbranch_scc1 KA_RET0
    s_cmp_eq_u32 s28, 2
    s_cbranch_scc1 KA_RET2
    s_cmp_eq_u32 s28, 4
    s_cbranch_scc1 KA_RET4
    s_cmp_eq_u32 s28, 6
    s_cbranch_scc1 KA_RET6
    s_cmp_eq_u32 s28, 8
    s_cbranch_scc1 KA_RET8
    s_cmp_eq_u32 s28, 10
    s_cbranch_scc1 KA_RET10
    s_cmp_eq_u32 s28, 12
    s_cbranch_scc1 KA_RET12
    s_cmp_eq_u32 s28, 14
    s_cbranch_scc1 KA_RET14
    s_cmp_eq_u32 s28, 16
    s_cbranch_scc1 KA_RET16
    s_cmp_eq_u32 s28, 18
    s_cbranch_scc1 KA_RET18
    s_cmp_eq_u32 s28, 20
    s_cbranch_scc1 KA_RET20
    s_cmp_eq_u32 s28, 22
    s_cbranch_scc1 KA_RET22
    s_cmp_eq_u32 s28, 24
    s_cbranch_scc1 KA_RET24
    s_cmp_eq_u32 s28, 26
    s_cbranch_scc1 KA_RET26
    s_cmp_eq_u32 s28, 28
    s_cbranch_scc1 KA_RET28
    s_branch KA_RET30
CODE_END:
    s_endpgm

.section .rodata,"a"
.p2align 6
.amdhsa_kernel adaLN_cond__sliding_block_cached__geglu_ffn__prompt_kernel
  .amdhsa_next_free_vgpr 512
  .amdhsa_next_free_sgpr 102
  .amdhsa_accum_offset 256
  .amdhsa_group_segment_fixed_size 0
  .amdhsa_kernarg_size 112
  .amdhsa_user_sgpr_count 2
  .amdhsa_user_sgpr_kernarg_segment_ptr 1
  .amdhsa_system_sgpr_workgroup_id_x 1
.end_amdhsa_kernel
```
